```python
import torch

def _softmax(x, axis=-1):
    return torch.softmax(x, dim=axis)
def _gelu(x):
    return torch.nn.functional.gelu(x, approximate="tanh")
def _silu(x):
    return torch.nn.functional.silu(x)
def _sigmoid(x):
    return torch.sigmoid(x)
def _layernorm(x, axis=-1, eps=1e-5):
    m = x.mean(dim=axis, keepdim=True)
    v = x.var(dim=axis, keepdim=True, unbiased=False)
    return (x - m) / torch.sqrt(v + eps)
def _scatter_add(tgt, idx, src, axis=0):
    return tgt.clone().index_add_(axis, idx, src)
def _segment_sum(src, seg, n):
    out = torch.zeros((n,) + src.shape[1:], dtype=src.dtype)
    return out.index_add_(0, seg, src)
def _pad(x, pw):
    flat = tuple(v for pair in reversed(pw) for v in pair)
    return torch.nn.functional.pad(x, flat)

kernel_name = 'sequential_preLN__linear_attn_block__glu_gated_swiglu__prompt'

def setup_inputs():

    _w = (lambda a: (lambda t: t.to(torch.bfloat16) if t.is_floating_point() else t)(torch.as_tensor(a)))
    def _A_setup():
        B, S, D = 1, 2048, 640
        return {
            "x": _w((lambda *s: torch.randn(*s, dtype=torch.bfloat16) * 0.05)(B, S, D)),
            "wqkv": _w((lambda *s: torch.randn(*s, dtype=torch.bfloat16) * 0.05)(D, 3 * D)),
            "wo": _w((lambda *s: torch.randn(*s, dtype=torch.bfloat16) * 0.05)(D, D)),
        }
    _A_in = _A_setup()

    def _B_setup():
        B, S, D, F = 1, 2048, 640, 1536
        return {
            "x": _w((lambda *s: torch.randn(*s, dtype=torch.bfloat16) * 0.05)(B, S, D)),
            "w1": _w((lambda *s: torch.randn(*s, dtype=torch.bfloat16) * 0.2)(D, F) * (2.0 / D) ** 0.5),
            "w3": _w((lambda *s: torch.randn(*s, dtype=torch.bfloat16) * 0.2)(D, F) * (2.0 / D) ** 0.5),
            "w2": _w((lambda *s: torch.randn(*s, dtype=torch.bfloat16) * 0.2)(F, D) * (2.0 / F) ** 0.5),
        }
    _B_in = _B_setup()

    return {
        "A_x": _A_in["x"],
        "A_wqkv": _A_in["wqkv"],
        "A_wo": _A_in["wo"],
        "B_x": _B_in["x"],
        "B_w1": _B_in["w1"],
        "B_w3": _B_in["w3"],
        "B_w2": _B_in["w2"],
    }

def reference(A_x, A_wqkv, A_wo, B_x, B_w1, B_w3, B_w2):
    def _A_ref(x, wqkv, wo):
        B, S, D = x.shape
        H = 32; Dh = D // H
        qkv = (lambda x, *d: x.permute(*d))((x @ wqkv).reshape(B, S, 3, H, Dh), 2, 0, 3, 1, 4)
        q, k, v = qkv[0], qkv[1], qkv[2]
        phi = lambda t: torch.where(t > 0, t + 1, torch.exp(t)) + 1e-6
        pq, pk = phi(q), phi(k)
        kv = torch.einsum("bhsd,bhse->bhde", pk, v)
        z = torch.einsum("bhsd->bhd", pk)
        num = torch.einsum("bhqd,bhde->bhqe", pq, kv)
        den = torch.einsum("bhqd,bhd->bhq", pq, z)[..., None] + 1e-6
        o = num / den
        return (lambda x, *d: x.permute(*d))(o, 0, 2, 1, 3).reshape(B, S, D) @ wo

    def _B_ref(x, w1, w3, w2):
        gate = torch.einsum("bsd,df->bsf", x, w1)
        up = torch.einsum("bsd,df->bsf", x, w3)
        h = _silu(gate) * up
        out = torch.einsum("bsf,fd->bsd", h, w2)
        return out

    x = A_x
    h = x + _A_ref(_layernorm(x, axis=-1), A_wqkv, A_wo)
    h2 = h + _B_ref(_layernorm(h, axis=-1), B_w1, B_w3, B_w2)
    return h2
```

```asm
; @launch grid=(256,1,1) block=(256,1,1) lds=163840
.amdgcn_target "amdgcn-amd-amdhsa--gfx950"
.text
.p2align 12
.globl sequential_preLN__linear_attn_block__glu_gated_swiglu__prompt_kernel
.p2align 8
.type sequential_preLN__linear_attn_block__glu_gated_swiglu__prompt_kernel,@function
sequential_preLN__linear_attn_block__glu_gated_swiglu__prompt_kernel:
    s_load_dwordx16 s[24:39], s[0:1], 0
    s_load_dwordx4 s[40:43], s[0:1], 64
    s_cmp_ge_u32 s2, 256
    s_cbranch_scc1 Lend
    v_lshrrev_b32 v1, 6, v0
    v_and_b32 v0, 63, v0
    v_readfirstlane_b32 s22, v1
    s_and_b32 s55, s2, 7
    s_lshr_b32 s56, s2, 3
    s_cmp_ge_u32 s56, 24
    s_cbranch_scc1 Lroleh_2
    s_lshr_b32 s44, s55, 1
    s_lshl_b32 s44, s44, 2
    s_and_b32 s57, s56, 3
    s_add_u32 s44, s44, s57
    s_and_b32 s55, s55, 1
    s_lshr_b32 s56, s56, 2
    s_add_u32 s52, s56, s57
    s_and_b32 s52, s52, 3
    s_cmp_ge_u32 s56, 4
    s_cbranch_scc1 Lroleq_1
    s_lshl_b32 s45, s55, 2
    s_add_u32 s45, s45, s56
    s_mul_i32 s46, s45, 160
    s_add_u32 s46, s46, 1280
    s_add_u32 s47, s46, 1280
    s_branch Lgemm_3
Lroleq_1:
    s_lshl_b32 s45, s55, 1
    s_add_u32 s45, s45, s56
    s_add_u32 s45, s45, 4
    s_sub_u32 s46, s45, 8
    s_mul_i32 s46, s46, 320
    s_add_u32 s47, s46, 160
    s_mov_b32 s52, 4
Lgemm_3:
    s_mov_b32 s58, 2253603344
    s_mov_b32 s59, 151
    s_cmp_eq_u32 s52, 1
    s_cselect_b32 s58, 1984246273, s58
    s_cselect_b32 s59, 137, s59
    s_cmp_eq_u32 s52, 2
    s_cselect_b32 s58, 1969500448, s58
    s_cselect_b32 s59, 152, s59
    s_cmp_eq_u32 s52, 3
    s_cselect_b32 s58, 1733567233, s58
    s_cselect_b32 s59, 152, s59
    s_cmp_eq_u32 s52, 4
    s_cselect_b32 s58, 1985229328, s58
    s_cselect_b32 s59, 152, s59
    s_lshl_b32 s55, s44, 7
    s_lshl_b32 s56, s22, 5
    s_add_u32 s55, s55, s56
    s_mul_i32 s55, s55, 1280
    v_lshrrev_b32 v224, 3, v0
    v_and_b32 v225, 7, v0
    v_lshrrev_b32 v226, 4, v0
    v_mul_u32_u24 v224, 1280, v224
    v_add_u32 v224, s55, v224
    v_add_u32 v227, 2, v226
    v_and_b32 v227, 7, v227
    v_xor_b32 v227, v225, v227
    v_lshl_add_u32 v227, v227, 4, v224
    v_add_u32 v2, 0, v227
    v_add_u32 v4, 18432, v227
    v_add_u32 v227, 6, v226
    v_and_b32 v227, 7, v227
    v_xor_b32 v227, v225, v227
    v_lshl_add_u32 v227, v227, 4, v224
    v_add_u32 v3, 9216, v227
    v_add_u32 v5, 27648, v227
    s_lshl_b32 s53, s22, 12
    s_add_u32 s53, s53, 73984
    s_mul_i32 s55, s22, 61440
    s_add_u32 s55, s55, s46
    s_sub_u32 s56, s47, s46
    s_sub_u32 s56, s56, 160
    v_mov_b32 v228, s56
    v_add_u32 v224, 0, v0
    v_mul_u32_u24 v225, 3277, v224
    v_lshrrev_b32 v225, 16, v225
    v_mul_u32_u24 v226, 20, v225
    v_sub_u32_e64 v226, v224, v226
    v_cmp_lt_u32 vcc, 9, v226
    v_mul_u32_u24 v225, 3840, v225
    v_lshl_add_u32 v225, v226, 4, v225
    v_cndmask_b32 v227, 0, v228, vcc
    v_add3_u32 v6, v225, v227, s55
    v_add_u32 v224, 64, v0
    v_mul_u32_u24 v225, 3277, v224
    v_lshrrev_b32 v225, 16, v225
    v_mul_u32_u24 v226, 20, v225
    v_sub_u32 v226, v224, v226
    v_cmp_lt_u32 vcc, 9, v226
    v_mul_u32_u24 v225, 3840, v225
    v_lshl_add_u32 v225, v226, 4, v225
    v_cndmask_b32 v227, 0, v228, vcc
    v_add3_u32 v7, v225, v227, s55
    v_subrev_u32 v7, 1024, v7
    v_add_u32 v224, 128, v0
    v_mul_u32_u24 v225, 3277, v224
    v_lshrrev_b32 v225, 16, v225
    v_mul_u32_u24 v226, 20, v225
    v_sub_u32_e64 v226, v224, v226
    v_cmp_lt_u32 vcc, 9, v226
    v_mul_u32_u24 v225, 3840, v225
    v_lshl_add_u32 v225, v226, 4, v225
    v_cndmask_b32 v227, 0, v228, vcc
    v_add3_u32 v8, v225, v227, s55
    v_subrev_u32 v8, 2048, v8
    v_add_u32 v224, 192, v0
    v_mul_u32_u24 v225, 3277, v224
    v_lshrrev_b32 v225, 16, v225
    v_mul_u32_u24 v226, 20, v225
    v_sub_u32_e64 v226, v224, v226
    v_cmp_lt_u32 vcc, 9, v226
    v_mul_u32_u24 v225, 3840, v225
    v_lshl_add_u32 v225, v226, 4, v225
    v_cndmask_b32 v227, 0, v228, vcc
    v_add3_u32 v9, v225, v227, s55
    v_subrev_u32 v9, 3072, v9
    v_add_u32 v224, 256, v0
    v_mul_u32_u24 v225, 3277, v224
    v_lshrrev_b32 v225, 16, v225
    v_mul_u32_u24 v226, 20, v225
    v_sub_u32_e64 v226, v224, v226
    v_cmp_lt_u32 vcc, 9, v226
    v_mul_u32_u24 v225, 3840, v225
    v_lshl_add_u32 v225, v226, 4, v225
    v_cndmask_b32 v227, 0, v228, vcc
    v_add3_u32 v10, v225, v227, s55
    s_mul_i32 s54, s22, 5152
    s_add_u32 s54, s54, 90368
    s_and_b32 s55, s58, 15
    s_lshr_b64 s[58:59], s[58:59], 4
    s_lshl_b32 s49, s55, 7
    s_mul_i32 s50, s55, 245760
    s_waitcnt lgkmcnt(0)
    s_mov_b32 s8, s24
    s_mov_b32 s9, s25
    s_mov_b32 s10, 2621440
    s_mov_b32 s11, 0x20000
    s_mov_b32 s4, s42
    s_mov_b32 s5, s43
    s_mov_b32 s6, 26214400
    s_mov_b32 s7, 0x20000
    s_mov_b32 s20, s40
    s_mov_b32 s21, s41
    s_mov_b32 s12, s26
    s_mov_b32 s13, s27
    s_mov_b32 s14, 2457600
    s_mov_b32 s15, 0x20000
    s_cmp_ge_u32 s45, 8
    s_cbranch_scc1 Lrevx_6
    s_cmp_ge_u32 s52, 2
    s_cbranch_scc1 Lrev_5
    s_mov_b32 m0, s53
    s_nop 0
    buffer_load_dwordx4 v2, s[8:11], s49 offen offset:0 lds
    buffer_load_dwordx4 v3, s[8:11], s49 offen offset:1024 lds
    buffer_load_dwordx4 v4, s[8:11], s49 offen offset:2048 lds
    buffer_load_dwordx4 v5, s[8:11], s49 offen offset:3072 lds
    s_mov_b32 m0, s54
    s_nop 0
    buffer_load_dwordx4 v6, s[12:15], s50 offen offset:0 lds
    buffer_load_dwordx4 v7, s[12:15], s50 offen offset:1024 lds
    buffer_load_dwordx4 v8, s[12:15], s50 offen offset:2048 lds
    buffer_load_dwordx4 v9, s[12:15], s50 offen offset:3072 lds
    s_add_u32 m0, s54, 4096
    s_nop 0
    buffer_load_dwordx4 v10, s[12:15], s50 offen lds
    s_branch Lrevx_6
Lrev_5:
    s_add_u32 m0, s54, 4096
    s_nop 0
    buffer_load_dwordx4 v10, s[12:15], s50 offen lds
    s_mov_b32 m0, s54
    s_nop 0
    buffer_load_dwordx4 v9, s[12:15], s50 offen offset:3072 lds
    buffer_load_dwordx4 v8, s[12:15], s50 offen offset:2048 lds
    buffer_load_dwordx4 v7, s[12:15], s50 offen offset:1024 lds
    buffer_load_dwordx4 v6, s[12:15], s50 offen offset:0 lds
    s_mov_b32 m0, s53
    s_nop 0
    buffer_load_dwordx4 v5, s[8:11], s49 offen offset:3072 lds
    buffer_load_dwordx4 v4, s[8:11], s49 offen offset:2048 lds
    buffer_load_dwordx4 v3, s[8:11], s49 offen offset:1024 lds
    buffer_load_dwordx4 v2, s[8:11], s49 offen offset:0 lds
Lrevx_6:
    s_lshr_b32 s72, s22, 1
    s_and_b32 s73, s22, 1
    s_xor_b32 s57, s72, s73
    v_and_b32 v224, 15, v0
    v_lshrrev_b32 v225, 4, v0
    v_and_b32 v226, 1, v225
    v_lshrrev_b32 v227, 1, v225
    v_lshl_or_b32 v228, v226, 1, v227
    v_lshrrev_b32 v229, 1, v224
    v_add_u32 v229, 2, v229
    v_and_b32 v229, 7, v229
    v_xor_b32 v229, v228, v229
    v_lshlrev_b32 v229, 4, v229
    v_lshl_add_u32 v229, v224, 7, v229
    s_lshl_b32 s55, s72, 13
    s_add_u32 s55, s55, 73984
    s_lshl_b32 s56, s57, 6
    v_xor_b32 v229, s56, v229
    v_add_u32 v12, s55, v229
    v_xor_b32_e64 v13, 64, v12
    v_bfe_u32 v229, v0, 2, 2
    v_lshl_add_u32 v229, v227, 3, v229
    v_mul_u32_u24 v229, 320, v229
    v_mul_u32_u24 v230, 5152, v226
    v_add_u32 v229, v229, v230
    s_cmp_ge_u32 s45, 8
    s_cselect_b32 s55, 2, 1
    s_cselect_b32 s56, 1, 2
    s_mul_i32 s55, s55, 80
    s_mul_i32 s56, s56, 80
    s_mul_i32 s55, s55, s73
    s_add_u32 s55, s55, 90368
    v_add_u32 v229, s55, v229
    v_and_b32 v230, 3, v0
    v_lshl_add_u32 v231, v230, 3, v229
    v_and_b32 v232, 1, v0
    v_mul_u32_u24 v232, 40, v232
    v_bfe_u32 v230, v0, 1, 1
    v_mul_u32_u24 v230, s56, v230
    v_add3_u32 v232, v232, v230, 32
    v_add_u32_e64 v232, v232, v229
    s_mul_i32 s55, s57, 10304
    s_sub_u32 s56, 10304, s55
    v_add_u32 v14, s55, v231
    v_add_u32 v15, s56, v231
    v_add_u32 v16, s55, v232
    v_add_u32 v17, s56, v232
    s_and_b32 s55, s2, 7
    s_lshr_b32 s56, s2, 3
    s_lshr_b32 s24, s55, 1
    s_lshl_b32 s24, s24, 2
    s_and_b32 s57, s56, 3
    s_add_u32 s24, s24, s57
    s_and_b32 s25, s55, 1
    s_lshl_b32 s25, s25, 3
    s_lshr_b32 s56, s56, 2
    s_add_u32 s25, s25, s56
    s_and_b32 s30, s25, 1
    s_lshr_b32 s31, s25, 1
    s_lshr_b32 s3, s25, 2
    s_and_b32 s23, s25, 3
    s_lshl_b32 s3, s3, 1
    s_and_b32 s55, s22, 1
    s_add_u32 s3, s3, s55
    s_lshl_b32 s23, s23, 1
    s_lshr_b32 s55, s22, 1
    s_add_u32 s23, s23, s55
    s_and_b32 s55, s2, 7
    s_lshr_b32 s56, s2, 3
    s_lshr_b32 s26, s55, 2
    s_lshl_b32 s26, s26, 3
    s_and_b32 s57, s56, 7
    s_add_u32 s26, s26, s57
    s_and_b32 s25, s55, 3
    s_lshl_b32 s25, s25, 2
    s_lshr_b32 s56, s56, 3
    s_add_u32 s25, s25, s56
    v_lshlrev_b32 v1, 4, v0
    s_cmp_lg_u32 s22, 3
    s_cbranch_scc1 Lwm_1
    s_call_b64 s[0:1], Lpg_entry_1
Lwm_1:
    s_cmp_lg_u32 s22, 2
    s_cbranch_scc1 Lwm_2
    s_call_b64 s[0:1], Lpg_entry_2
Lwm_2:
    s_cmp_lg_u32 s22, 1
    s_cbranch_scc1 Lwm_3
    s_call_b64 s[0:1], Lpg_q
Lwm_3:
    s_cmp_lg_u32 s22, 0
    s_cbranch_scc1 Lwm_4
    s_call_b64 s[0:1], Lpg_q_1
Lwm_4:
    s_cmp_ge_u32 s45, 8
    s_cbranch_scc0 Lonly_7
    s_mov_b32 m0, s53
    s_nop 0
    buffer_load_dwordx4 v2, s[8:11], s49 offen offset:0 lds
    buffer_load_dwordx4 v3, s[8:11], s49 offen offset:1024 lds
    buffer_load_dwordx4 v4, s[8:11], s49 offen offset:2048 lds
    buffer_load_dwordx4 v5, s[8:11], s49 offen offset:3072 lds
    s_mov_b32 m0, s54
    s_nop 0
    buffer_load_dwordx4 v6, s[12:15], s50 offen offset:0 lds
    buffer_load_dwordx4 v7, s[12:15], s50 offen offset:1024 lds
    buffer_load_dwordx4 v8, s[12:15], s50 offen offset:2048 lds
    buffer_load_dwordx4 v9, s[12:15], s50 offen offset:3072 lds
    s_add_u32 m0, s54, 4096
    s_nop 0
    buffer_load_dwordx4 v10, s[12:15], s50 offen lds
Lonly_7:
    s_add_u32 s53, s53, 36992
    s_add_u32 s54, s54, 36992
    s_and_b32 s55, s58, 15
    s_lshr_b64 s[58:59], s[58:59], 4
    s_lshl_b32 s49, s55, 7
    s_mul_i32 s50, s55, 245760
    s_mov_b32 m0, s53
    s_nop 0
    buffer_load_dwordx4 v2, s[8:11], s49 offen offset:0 lds
    buffer_load_dwordx4 v3, s[8:11], s49 offen offset:1024 lds
    buffer_load_dwordx4 v4, s[8:11], s49 offen offset:2048 lds
    buffer_load_dwordx4 v5, s[8:11], s49 offen offset:3072 lds
    s_mov_b32 m0, s54
    s_nop 0
    buffer_load_dwordx4 v6, s[12:15], s50 offen offset:0 lds
    buffer_load_dwordx4 v7, s[12:15], s50 offen offset:1024 lds
    buffer_load_dwordx4 v8, s[12:15], s50 offen offset:2048 lds
    buffer_load_dwordx4 v9, s[12:15], s50 offen offset:3072 lds
    s_add_u32 m0, s54, 4096
    s_nop 0
    buffer_load_dwordx4 v10, s[12:15], s50 offen lds
    s_sub_u32 s53, s53, 110976
    s_sub_u32 s54, s54, 110976
    s_cmp_ge_u32 s45, 8
    s_cbranch_scc1 Lgq_4
    s_waitcnt vmcnt(9)
    s_barrier
    ds_read_b128 v[32:35], v12 offset:0
    ds_read_b128 v[36:39], v12 offset:2048
    ds_read_b128 v[40:43], v12 offset:4096
    ds_read_b128 v[44:47], v12 offset:6144
    ds_read_b64_tr_b16 v[64:65], v14 offset:0
    ds_read_b64_tr_b16 v[66:67], v14 offset:1280
    ds_read_b64_tr_b16 v[68:69], v14 offset:40
    ds_read_b64_tr_b16 v[70:71], v14 offset:1320
    ds_read_b64_tr_b16 v[72:73], v14 offset:160
    ds_read_b64_tr_b16 v[74:75], v14 offset:1440
    ds_read_b64_tr_b16 v[76:77], v14 offset:200
    ds_read_b64_tr_b16 v[78:79], v14 offset:1480
    ds_read_b64_tr_b16 v[80:81], v16 offset:0
    ds_read_b64_tr_b16 v[82:83], v16 offset:1280
    s_and_b32 s55, s58, 15
    s_lshr_b64 s[58:59], s[58:59], 4
    s_lshl_b32 s49, s55, 7
    s_mul_i32 s50, s55, 245760
    s_mov_b32 m0, s53
    s_nop 0
    buffer_load_dwordx4 v2, s[8:11], s49 offen offset:0 lds
    buffer_load_dwordx4 v3, s[8:11], s49 offen offset:1024 lds
    buffer_load_dwordx4 v4, s[8:11], s49 offen offset:2048 lds
    buffer_load_dwordx4 v5, s[8:11], s49 offen offset:3072 lds
    s_mov_b32 s48, 7
    s_mov_b32 s51, 2
    s_mov_b32 s56, 4294856320
    s_mov_b32 s57, 36992
    s_waitcnt lgkmcnt(0)
    v_mfma_f32_16x16x32_bf16 v[104:107], v[32:35], v[64:67], 0
    ds_read_b128 v[48:51], v13 offset:0
    s_mov_b32 m0, s54
    v_mfma_f32_16x16x32_bf16 v[124:127], v[36:39], v[64:67], 0
    ds_read_b128 v[52:55], v13 offset:2048
    v_mfma_f32_16x16x32_bf16 v[144:147], v[40:43], v[64:67], 0
    ds_read_b128 v[56:59], v13 offset:4096
    buffer_load_dwordx4 v6, s[12:15], s50 offen offset:0 lds
    v_mfma_f32_16x16x32_bf16 v[164:167], v[44:47], v[64:67], 0
    ds_read_b128 v[60:63], v13 offset:6144
    v_mfma_f32_16x16x32_bf16 v[108:111], v[32:35], v[68:71], 0
    ds_read_b64_tr_b16 v[84:85], v15 offset:0
    buffer_load_dwordx4 v7, s[12:15], s50 offen offset:1024 lds
    v_mfma_f32_16x16x32_bf16 v[128:131], v[36:39], v[68:71], 0
    ds_read_b64_tr_b16 v[86:87], v15 offset:1280
    v_mfma_f32_16x16x32_bf16 v[148:151], v[40:43], v[68:71], 0
    ds_read_b64_tr_b16 v[88:89], v15 offset:40
    buffer_load_dwordx4 v8, s[12:15], s50 offen offset:2048 lds
    v_mfma_f32_16x16x32_bf16 v[168:171], v[44:47], v[68:71], 0
    ds_read_b64_tr_b16 v[90:91], v15 offset:1320
    v_mfma_f32_16x16x32_bf16 v[112:115], v[32:35], v[72:75], 0
    ds_read_b64_tr_b16 v[92:93], v15 offset:160
    buffer_load_dwordx4 v9, s[12:15], s50 offen offset:3072 lds
    v_mfma_f32_16x16x32_bf16 v[132:135], v[36:39], v[72:75], 0
    ds_read_b64_tr_b16 v[94:95], v15 offset:1440
    v_mfma_f32_16x16x32_bf16 v[152:155], v[40:43], v[72:75], 0
    ds_read_b64_tr_b16 v[96:97], v15 offset:200
    s_add_u32 m0, s54, 4096
    v_mfma_f32_16x16x32_bf16 v[172:175], v[44:47], v[72:75], 0
    ds_read_b64_tr_b16 v[98:99], v15 offset:1480
    v_mfma_f32_16x16x32_bf16 v[116:119], v[32:35], v[76:79], 0
    ds_read_b64_tr_b16 v[100:101], v17 offset:0
    buffer_load_dwordx4 v10, s[12:15], s50 offen lds
    v_mfma_f32_16x16x32_bf16 v[136:139], v[36:39], v[76:79], 0
    ds_read_b64_tr_b16 v[102:103], v17 offset:1280
    s_add_u32 s51, s51, 1
    s_and_b32 s51, s51, 3
    v_mfma_f32_16x16x32_bf16 v[156:159], v[40:43], v[76:79], 0
    s_cselect_b32 s52, s57, s56
    v_add_u32 v12, s52, v12
    v_add_u32 v13, s52, v13
    v_mfma_f32_16x16x32_bf16 v[176:179], v[44:47], v[76:79], 0
    s_cmp_eq_u32 s51, 2
    v_add_u32 v14, s52, v14
    v_add_u32 v15, s52, v15
    v_mfma_f32_16x16x32_bf16 v[120:123], v[32:35], v[80:83], 0
    s_cselect_b32 s55, s56, s57
    v_add_u32 v16, s52, v16
    v_add_u32 v17, s52, v17
    v_mfma_f32_16x16x32_bf16 v[140:143], v[36:39], v[80:83], 0
    s_add_u32 s53, s53, s55
    s_add_u32 s54, s54, s55
    s_and_b32 s55, s58, 15
    v_mfma_f32_16x16x32_bf16 v[160:163], v[40:43], v[80:83], 0
    s_lshr_b64 s[58:59], s[58:59], 4
    s_lshl_b32 s49, s55, 7
    s_mul_i32 s50, s55, 245760
    v_mfma_f32_16x16x32_bf16 v[180:183], v[44:47], v[80:83], 0
    s_sub_u32 s48, s48, 1
.p2align 3
Lp1loop_8:
    s_waitcnt vmcnt(9) lgkmcnt(0)
    s_barrier
    v_mfma_f32_16x16x32_bf16 v[104:107], v[48:51], v[84:87], v[104:107]
    ds_read_b128 v[32:35], v12 offset:0
    s_mov_b32 m0, s53
    v_mfma_f32_16x16x32_bf16 v[124:127], v[52:55], v[84:87], v[124:127]
    ds_read_b128 v[36:39], v12 offset:2048
    v_mfma_f32_16x16x32_bf16 v[144:147], v[56:59], v[84:87], v[144:147]
    ds_read_b128 v[40:43], v12 offset:4096
    v_mfma_f32_16x16x32_bf16 v[164:167], v[60:63], v[84:87], v[164:167]
    ds_read_b128 v[44:47], v12 offset:6144
    v_mfma_f32_16x16x32_bf16 v[108:111], v[48:51], v[88:91], v[108:111]
    ds_read_b64_tr_b16 v[64:65], v14 offset:0
    buffer_load_dwordx4 v2, s[8:11], s49 offen offset:0 lds
    v_mfma_f32_16x16x32_bf16 v[128:131], v[52:55], v[88:91], v[128:131]
    ds_read_b64_tr_b16 v[66:67], v14 offset:1280
    v_mfma_f32_16x16x32_bf16 v[148:151], v[56:59], v[88:91], v[148:151]
    ds_read_b64_tr_b16 v[68:69], v14 offset:40
    v_mfma_f32_16x16x32_bf16 v[168:171], v[60:63], v[88:91], v[168:171]
    ds_read_b64_tr_b16 v[70:71], v14 offset:1320
    v_mfma_f32_16x16x32_bf16 v[112:115], v[48:51], v[92:95], v[112:115]
    ds_read_b64_tr_b16 v[72:73], v14 offset:160
    buffer_load_dwordx4 v3, s[8:11], s49 offen offset:1024 lds
    v_mfma_f32_16x16x32_bf16 v[132:135], v[52:55], v[92:95], v[132:135]
    ds_read_b64_tr_b16 v[74:75], v14 offset:1440
    v_mfma_f32_16x16x32_bf16 v[152:155], v[56:59], v[92:95], v[152:155]
    ds_read_b64_tr_b16 v[76:77], v14 offset:200
    v_mfma_f32_16x16x32_bf16 v[172:175], v[60:63], v[92:95], v[172:175]
    ds_read_b64_tr_b16 v[78:79], v14 offset:1480
    v_mfma_f32_16x16x32_bf16 v[116:119], v[48:51], v[96:99], v[116:119]
    ds_read_b64_tr_b16 v[80:81], v16 offset:0
    buffer_load_dwordx4 v4, s[8:11], s49 offen offset:2048 lds
    v_mfma_f32_16x16x32_bf16 v[136:139], v[52:55], v[96:99], v[136:139]
    ds_read_b64_tr_b16 v[82:83], v16 offset:1280
    v_mfma_f32_16x16x32_bf16 v[156:159], v[56:59], v[96:99], v[156:159]
    v_mfma_f32_16x16x32_bf16 v[176:179], v[60:63], v[96:99], v[176:179]
    v_mfma_f32_16x16x32_bf16 v[120:123], v[48:51], v[100:103], v[120:123]
    buffer_load_dwordx4 v5, s[8:11], s49 offen offset:3072 lds
    v_mfma_f32_16x16x32_bf16 v[140:143], v[52:55], v[100:103], v[140:143]
    v_mfma_f32_16x16x32_bf16 v[160:163], v[56:59], v[100:103], v[160:163]
    v_mfma_f32_16x16x32_bf16 v[180:183], v[60:63], v[100:103], v[180:183]
    s_waitcnt lgkmcnt(0)
    v_mfma_f32_16x16x32_bf16 v[104:107], v[32:35], v[64:67], v[104:107]
    ds_read_b128 v[48:51], v13 offset:0
    s_mov_b32 m0, s54
    v_mfma_f32_16x16x32_bf16 v[124:127], v[36:39], v[64:67], v[124:127]
    ds_read_b128 v[52:55], v13 offset:2048
    v_mfma_f32_16x16x32_bf16 v[144:147], v[40:43], v[64:67], v[144:147]
    ds_read_b128 v[56:59], v13 offset:4096
    buffer_load_dwordx4 v6, s[12:15], s50 offen offset:0 lds
    v_mfma_f32_16x16x32_bf16 v[164:167], v[44:47], v[64:67], v[164:167]
    ds_read_b128 v[60:63], v13 offset:6144
    v_mfma_f32_16x16x32_bf16 v[108:111], v[32:35], v[68:71], v[108:111]
    ds_read_b64_tr_b16 v[84:85], v15 offset:0
    buffer_load_dwordx4 v7, s[12:15], s50 offen offset:1024 lds
    v_mfma_f32_16x16x32_bf16 v[128:131], v[36:39], v[68:71], v[128:131]
    ds_read_b64_tr_b16 v[86:87], v15 offset:1280
    v_mfma_f32_16x16x32_bf16 v[148:151], v[40:43], v[68:71], v[148:151]
    ds_read_b64_tr_b16 v[88:89], v15 offset:40
    buffer_load_dwordx4 v8, s[12:15], s50 offen offset:2048 lds
    v_mfma_f32_16x16x32_bf16 v[168:171], v[44:47], v[68:71], v[168:171]
    ds_read_b64_tr_b16 v[90:91], v15 offset:1320
    v_mfma_f32_16x16x32_bf16 v[112:115], v[32:35], v[72:75], v[112:115]
    ds_read_b64_tr_b16 v[92:93], v15 offset:160
    buffer_load_dwordx4 v9, s[12:15], s50 offen offset:3072 lds
    v_mfma_f32_16x16x32_bf16 v[132:135], v[36:39], v[72:75], v[132:135]
    ds_read_b64_tr_b16 v[94:95], v15 offset:1440
    v_mfma_f32_16x16x32_bf16 v[152:155], v[40:43], v[72:75], v[152:155]
    ds_read_b64_tr_b16 v[96:97], v15 offset:200
    s_add_u32 m0, s54, 4096
    v_mfma_f32_16x16x32_bf16 v[172:175], v[44:47], v[72:75], v[172:175]
    ds_read_b64_tr_b16 v[98:99], v15 offset:1480
    v_mfma_f32_16x16x32_bf16 v[116:119], v[32:35], v[76:79], v[116:119]
    ds_read_b64_tr_b16 v[100:101], v17 offset:0
    buffer_load_dwordx4 v10, s[12:15], s50 offen lds
    v_mfma_f32_16x16x32_bf16 v[136:139], v[36:39], v[76:79], v[136:139]
    ds_read_b64_tr_b16 v[102:103], v17 offset:1280
    s_add_u32 s51, s51, 1
    s_and_b32 s51, s51, 3
    v_mfma_f32_16x16x32_bf16 v[156:159], v[40:43], v[76:79], v[156:159]
    s_cselect_b32 s52, s57, s56
    v_add_u32 v12, s52, v12
    v_add_u32 v13, s52, v13
    v_mfma_f32_16x16x32_bf16 v[176:179], v[44:47], v[76:79], v[176:179]
    s_cmp_eq_u32 s51, 2
    v_add_u32 v14, s52, v14
    v_add_u32 v15, s52, v15
    v_mfma_f32_16x16x32_bf16 v[120:123], v[32:35], v[80:83], v[120:123]
    s_cselect_b32 s55, s56, s57
    v_add_u32 v16, s52, v16
    v_add_u32 v17, s52, v17
    v_mfma_f32_16x16x32_bf16 v[140:143], v[36:39], v[80:83], v[140:143]
    s_add_u32 s53, s53, s55
    s_add_u32 s54, s54, s55
    s_and_b32 s55, s58, 15
    v_mfma_f32_16x16x32_bf16 v[160:163], v[40:43], v[80:83], v[160:163]
    s_lshr_b64 s[58:59], s[58:59], 4
    s_lshl_b32 s49, s55, 7
    s_mul_i32 s50, s55, 245760
    v_mfma_f32_16x16x32_bf16 v[180:183], v[44:47], v[80:83], v[180:183]
    s_sub_u32 s48, s48, 1
    s_cbranch_scc0 Lp1loop_8
    s_waitcnt vmcnt(9) lgkmcnt(0)
    s_barrier
    v_mov_b32 v30, 0
    global_load_dword v28, v30, s[20:21] offset:8 sc1
    v_mfma_f32_16x16x32_bf16 v[104:107], v[48:51], v[84:87], v[104:107]
    s_lshl_b32 s58, s44, 1
    ds_read_b128 v[32:35], v12 offset:0
    s_add_u32 s58, s58, s72
    v_mfma_f32_16x16x32_bf16 v[124:127], v[52:55], v[84:87], v[124:127]
    s_lshl_b32 s58, s58, 8
    ds_read_b128 v[36:39], v12 offset:2048
    s_add_u32 s58, s58, 262144
    v_mfma_f32_16x16x32_bf16 v[144:147], v[56:59], v[84:87], v[144:147]
    s_mul_i32 s59, s73, 80
    ds_read_b128 v[40:43], v12 offset:4096
    s_add_u32 s59, s59, s46
    v_mfma_f32_16x16x32_bf16 v[164:167], v[60:63], v[84:87], v[164:167]
    s_lshl_b32 s59, s59, 1
    ds_read_b128 v[44:47], v12 offset:6144
    s_add_u32 s59, s59, 294912
    v_mfma_f32_16x16x32_bf16 v[108:111], v[48:51], v[88:91], v[108:111]
    s_lshl_b32 s68, s22, 11
    ds_read_b64_tr_b16 v[64:65], v14 offset:0
    s_add_u32 s68, s68, 148480
    v_mfma_f32_16x16x32_bf16 v[128:131], v[52:55], v[88:91], v[128:131]
    ds_read_b64_tr_b16 v[66:67], v14 offset:1280
    v_lshlrev_b32_e64 v11, 2, v0
    v_mfma_f32_16x16x32_bf16 v[148:151], v[56:59], v[88:91], v[148:151]
    s_branch Lpg_entry_1_go
.p2align 12
Lpg_entry_1:
    s_setpc_b64 s[0:1]
.p2align 3
Lpg_entry_1_go:
    ds_read_b64_tr_b16 v[68:69], v14 offset:40
    v_and_b32_e64 v242, 15, v0
    v_mfma_f32_16x16x32_bf16 v[168:171], v[60:63], v[88:91], v[168:171]
    ds_read_b64_tr_b16 v[70:71], v14 offset:1320
    v_lshlrev_b32_e64 v242, 2, v242
    v_mfma_f32_16x16x32_bf16 v[112:115], v[48:51], v[92:95], v[112:115]
    ds_read_b64_tr_b16 v[72:73], v14 offset:160
    v_bfe_u32 v243, v0, 4, 1
    v_mfma_f32_16x16x32_bf16 v[132:135], v[52:55], v[92:95], v[132:135]
    ds_read_b64_tr_b16 v[74:75], v14 offset:1440
    v_mul_u32_u24 v243, 80, v243
    v_mfma_f32_16x16x32_bf16 v[152:155], v[56:59], v[92:95], v[152:155]
    ds_read_b64_tr_b16 v[76:77], v14 offset:200
    v_lshrrev_b32_e64 v244, 5, v0
    v_mfma_f32_16x16x32_bf16 v[172:175], v[60:63], v[92:95], v[172:175]
    ds_read_b64_tr_b16 v[78:79], v14 offset:1480
    v_mul_u32_u24 v244, 2560, v244
    v_mfma_f32_16x16x32_bf16 v[116:119], v[48:51], v[96:99], v[116:119]
    ds_read_b64_tr_b16 v[80:81], v16 offset:0
    v_add3_u32 v31, v242, v243, v244
    v_mfma_f32_16x16x32_bf16 v[136:139], v[52:55], v[96:99], v[136:139]
    ds_read_b64_tr_b16 v[82:83], v16 offset:1280
    v_and_b32 v242, 3, v0
    v_mfma_f32_16x16x32_bf16 v[156:159], v[56:59], v[96:99], v[156:159]
    v_lshlrev_b32 v242, 2, v242
    v_bfe_u32 v243, v0, 2, 1
    v_mfma_f32_16x16x32_bf16 v[176:179], v[60:63], v[96:99], v[176:179]
    v_mul_u32_u24 v243, 80, v243
    v_bfe_u32 v244, v0, 3, 1
    v_mfma_f32_16x16x32_bf16 v[120:123], v[48:51], v[100:103], v[120:123]
    v_mul_u32_u24 v244, 2560, v244
    v_add3_u32 v242, v242, v243, v244
    v_mfma_f32_16x16x32_bf16 v[140:143], v[52:55], v[100:103], v[140:143]
    v_bfe_u32 v243, v0, 4, 1
    v_mul_u32_u24 v243, 7680, v243
    v_mfma_f32_16x16x32_bf16 v[160:163], v[56:59], v[100:103], v[160:163]
    v_add3_u32 v246, v242, v243, 64
    v_and_b32_e64 v242, 15, v0
    v_mfma_f32_16x16x32_bf16 v[180:183], v[60:63], v[100:103], v[180:183]
    v_lshl_add_u32 v3, v242, 2, s68
    v_add_u32 v3, 768, v3
    s_waitcnt lgkmcnt(0)
    v_mov_b32 v30, 0
    global_load_dword v29, v30, s[20:21] offset:8 sc1
    v_mfma_f32_16x16x32_bf16 v[104:107], v[32:35], v[64:67], v[104:107]
    ds_read_b128 v[48:51], v13 offset:0
    v_lshrrev_b32_e64 v242, 4, v0
    v_mfma_f32_16x16x32_bf16 v[124:127], v[36:39], v[64:67], v[124:127]
    ds_read_b128 v[52:55], v13 offset:2048
    v_lshl_add_u32 v2, v242, 4, s68
    v_mfma_f32_16x16x32_bf16 v[144:147], v[40:43], v[64:67], v[144:147]
    s_mov_b32 s60, 983055
    ds_read_b128 v[56:59], v13 offset:4096
    s_mov_b32 s61, 983055
    v_mfma_f32_16x16x32_bf16 v[164:167], v[44:47], v[64:67], v[164:167]
    s_mov_b32 s62, 15728880
    ds_read_b128 v[60:63], v13 offset:6144
    s_mov_b32 s63, 15728880
    v_mfma_f32_16x16x32_bf16 v[108:111], v[32:35], v[68:71], v[108:111]
    s_mov_b32 s64, 251662080
    ds_read_b64_tr_b16 v[84:85], v15 offset:0
    s_mov_b32 s65, 251662080
    v_mfma_f32_16x16x32_bf16 v[128:131], v[36:39], v[68:71], v[128:131]
    s_mov_b32 s66, 4026593280
    ds_read_b64_tr_b16 v[86:87], v15 offset:1280
    s_mov_b32 s67, 4026593280
    v_mfma_f32_16x16x32_bf16 v[148:151], v[40:43], v[68:71], v[148:151]
    s_mov_b32 s40, 901882528
    ds_read_b64_tr_b16 v[88:89], v15 offset:40
    s_or_b64 s[42:43], s[64:65], s[66:67]
    v_mfma_f32_16x16x32_bf16 v[168:171], v[44:47], v[68:71], v[168:171]
    ds_read_b64_tr_b16 v[90:91], v15 offset:1320
    v_mov_b32 v242, 0xff800000
    v_mfma_f32_16x16x32_bf16 v[112:115], v[32:35], v[72:75], v[112:115]
    ds_read_b64_tr_b16 v[92:93], v15 offset:160
    v_mov_b32 v243, 897988541
    v_mfma_f32_16x16x32_bf16 v[132:135], v[36:39], v[72:75], v[132:135]
    ds_read_b64_tr_b16 v[94:95], v15 offset:1440
    v_mov_b32 v244, 1065369472
    v_mfma_f32_16x16x32_bf16 v[152:155], v[40:43], v[72:75], v[152:155]
    ds_read_b64_tr_b16 v[96:97], v15 offset:200
    v_cndmask_b32 v247, 0, v242, s[42:43]
    v_mfma_f32_16x16x32_bf16 v[172:175], v[44:47], v[72:75], v[172:175]
    ds_read_b64_tr_b16 v[98:99], v15 offset:1480
    v_cndmask_b32 v22, v243, 0, s[42:43]
    v_mfma_f32_16x16x32_bf16 v[116:119], v[32:35], v[76:79], v[116:119]
    ds_read_b64_tr_b16 v[100:101], v17 offset:0
    v_cndmask_b32 v23, 0, v244, s[60:61]
    v_mfma_f32_16x16x32_bf16 v[136:139], v[36:39], v[76:79], v[136:139]
    ds_read_b64_tr_b16 v[102:103], v17 offset:1280
    v_cndmask_b32 v24, 0, v244, s[62:63]
    v_mfma_f32_16x16x32_bf16 v[156:159], v[40:43], v[76:79], v[156:159]
    s_lshl_b32 s55, s72, 13
    s_add_u32 s55, s55, 110976
    s_lshl_b32 s56, s73, 11
    v_mfma_f32_16x16x32_bf16 v[176:179], v[44:47], v[76:79], v[176:179]
    s_add_u32 s56, s56, s55
    v_lshl_add_u32 v25, v0, 4, s56
    v_and_b32_e64 v242, 3, v0
    v_mfma_f32_16x16x32_bf16 v[120:123], v[32:35], v[80:83], v[120:123]
    v_bfe_u32 v243, v0, 2, 1
    v_lshlrev_b32_e64 v242, 2, v242
    v_mfma_f32_16x16x32_bf16 v[140:143], v[36:39], v[80:83], v[140:143]
    v_lshl_add_u32 v242, v243, 1, v242
    v_bfe_u32 v243, v0, 3, 1
    v_mfma_f32_16x16x32_bf16 v[160:163], v[40:43], v[80:83], v[160:163]
    v_xor_b32 v243, 1, v243
    v_add_u32 v242, v242, v243
    v_mfma_f32_16x16x32_bf16 v[180:183], v[44:47], v[80:83], v[180:183]
    v_and_b32 v243, 48, v0
    v_add_u32 v243, v243, v242
    v_add_u32 v12, 36992, v12
    v_add_u32 v13, 36992, v13
    v_add_u32 v14, 36992, v14
    v_add_u32 v15, 36992, v15
    v_add_u32 v16, 36992, v16
    v_add_u32 v17, 36992, v17
    s_waitcnt vmcnt(2) lgkmcnt(0)
    s_waitcnt vmcnt(1)
    v_readfirstlane_b32 s70, v28
    s_mov_b32 s69, 1048576
    s_cmp_ge_u32 s70, 1
    s_cbranch_scc1 Linitx_11
    s_waitcnt vmcnt(0)
    v_readfirstlane_b32 s70, v29
    s_cmp_ge_u32 s70, 1
    s_cbranch_scc1 Linitx_11
Linit_10:
    s_sub_u32 s69, s69, 1
    s_cbranch_scc1 Linitx_11
    s_sleep 6
    global_load_dword v28, v30, s[20:21] offset:8 sc1
    s_waitcnt vmcnt(0)
    v_readfirstlane_b32 s70, v28
    s_cmp_lt_u32 s70, 1
    s_cbranch_scc1 Linit_10
Linitx_11:
    s_barrier
    v_mfma_f32_16x16x32_bf16 v[104:107], v[48:51], v[84:87], v[104:107]
    s_lshl_b32 s56, s73, 10
    ds_read_b128 v[32:35], v12 offset:0
    s_and_b32 s71, s23, 6
    s_lshl_b32 s71, s71, 8
    s_add_u32 s71, s71, 102400
    v_and_b32_e64 v30, 1, v0
    v_lshl_add_u32 v30, v30, 8, s71
    buffer_load_dword v28, v30, s[4:7], 0 offen sc1
    v_mfma_f32_16x16x32_bf16 v[124:127], v[52:55], v[84:87], v[124:127]
    s_add_u32 s56, s56, s55
    ds_read_b128 v[36:39], v12 offset:2048
    s_add_u32 m0, s68, 1280
    s_nop 0
    buffer_load_dword v246, s[4:7], s59 offen sc1 lds
    v_mfma_f32_16x16x32_bf16 v[144:147], v[56:59], v[84:87], v[144:147]
    ds_read_b128 v[40:43], v12 offset:4096
    s_add_u32 m0, s68, 768
    s_nop 0
    buffer_load_dword v31, s[4:7], s59 offen sc1 lds
    v_mfma_f32_16x16x32_bf16 v[164:167], v[60:63], v[84:87], v[164:167]
    ds_read_b128 v[44:47], v12 offset:6144
    s_add_u32 m0, s68, 1024
    s_add_u32 s59, s59, 7680
    buffer_load_dword v31, s[4:7], s59 offen sc1 lds
    v_mfma_f32_16x16x32_bf16 v[108:111], v[48:51], v[88:91], v[108:111]
    ds_read_b64_tr_b16 v[64:65], v14 offset:0
    s_add_u32 m0, s68, 0
    s_nop 0
    buffer_load_dword v11, s[4:7], s58 offen sc1 lds
    v_mfma_f32_16x16x32_bf16 v[128:131], v[52:55], v[88:91], v[128:131]
    ds_read_b64_tr_b16 v[66:67], v14 offset:1280
    s_add_u32 m0, s68, 256
    s_add_u32 s58, s58, 8192
    buffer_load_dword v11, s[4:7], s58 offen sc1 lds
    v_mfma_f32_16x16x32_bf16 v[148:151], v[56:59], v[88:91], v[148:151]
    ds_read_b64_tr_b16 v[68:69], v14 offset:40
    s_add_u32 m0, s68, 512
    s_add_u32 s58, s58, 8192
    buffer_load_dword v11, s[4:7], s58 offen sc1 lds
    v_mfma_f32_16x16x32_bf16 v[168:171], v[60:63], v[88:91], v[168:171]
    ds_read_b64_tr_b16 v[70:71], v14 offset:1320
    v_lshl_add_u32 v26, v243, 4, s56
    v_mfma_f32_16x16x32_bf16 v[112:115], v[48:51], v[92:95], v[112:115]
    ds_read_b64_tr_b16 v[72:73], v14 offset:160
    v_and_b32 v243, 16, v0
    v_mfma_f32_16x16x32_bf16 v[132:135], v[52:55], v[92:95], v[132:135]
    ds_read_b64_tr_b16 v[74:75], v14 offset:1440
    v_add_u32_e64 v242, v242, v243
    v_mfma_f32_16x16x32_bf16 v[152:155], v[56:59], v[92:95], v[152:155]
    ds_read_b64_tr_b16 v[76:77], v14 offset:200
    v_add_u32 v242, 192, v242
    v_mfma_f32_16x16x32_bf16 v[172:175], v[60:63], v[92:95], v[172:175]
    ds_read_b64_tr_b16 v[78:79], v14 offset:1480
    v_and_b32 v243, 31, v0
    v_mfma_f32_16x16x32_bf16 v[116:119], v[48:51], v[96:99], v[116:119]
    s_mov_b32 s42, 0
    ds_read_b64_tr_b16 v[80:81], v16 offset:0
    s_mov_b32 s43, -1
    v_mfma_f32_16x16x32_bf16 v[136:139], v[52:55], v[96:99], v[136:139]
    s_lshl_b32 s56, s73, 9
    ds_read_b64_tr_b16 v[82:83], v16 offset:1280
    s_add_u32 s56, s56, s55
    v_mfma_f32_16x16x32_bf16 v[156:159], v[56:59], v[96:99], v[156:159]
    v_cndmask_b32 v242, v243, v242, s[42:43]
    v_lshl_add_u32 v27, v242, 4, s56
    v_mfma_f32_16x16x32_bf16 v[176:179], v[60:63], v[96:99], v[176:179]
    s_mov_b32 s42, 1060205080
    s_lshl_b32 s55, s22, 11
    v_lshl_add_u32 v255, v0, 2, s55
    v_mfma_f32_16x16x32_bf16 v[120:123], v[48:51], v[100:103], v[120:123]
    s_lshl_b32 s49, s45, 2
    s_add_u32 s49, s49, s22
    s_mul_i32 s49, s49, 2048
    v_mfma_f32_16x16x32_bf16 v[140:143], v[52:55], v[100:103], v[140:143]
    s_add_u32 s49, s49, 23330816
    v_lshlrev_b32_e64 v254, 2, v0
    v_mfma_f32_16x16x32_bf16 v[160:163], v[56:59], v[100:103], v[160:163]
    v_mfma_f32_16x16x32_bf16 v[180:183], v[60:63], v[100:103], v[180:183]
    s_waitcnt lgkmcnt(0)
    v_mfma_f32_16x16x32_bf16 v[104:107], v[32:35], v[64:67], v[104:107]
    ds_read_b128 v[48:51], v13 offset:0
    v_mfma_f32_16x16x32_bf16 v[124:127], v[36:39], v[64:67], v[124:127]
    ds_read_b128 v[52:55], v13 offset:2048
    v_mfma_f32_16x16x32_bf16 v[144:147], v[40:43], v[64:67], v[144:147]
    ds_read_b128 v[56:59], v13 offset:4096
    v_mfma_f32_16x16x32_bf16 v[164:167], v[44:47], v[64:67], v[164:167]
    ds_read_b128 v[60:63], v13 offset:6144
    v_mfma_f32_16x16x32_bf16 v[108:111], v[32:35], v[68:71], v[108:111]
    ds_read_b64_tr_b16 v[84:85], v15 offset:0
    v_mfma_f32_16x16x32_bf16 v[128:131], v[36:39], v[68:71], v[128:131]
    ds_read_b64_tr_b16 v[86:87], v15 offset:1280
    v_mfma_f32_16x16x32_bf16 v[148:151], v[40:43], v[68:71], v[148:151]
    ds_read_b64_tr_b16 v[88:89], v15 offset:40
    v_mfma_f32_16x16x32_bf16 v[168:171], v[44:47], v[68:71], v[168:171]
    ds_read_b64_tr_b16 v[90:91], v15 offset:1320
    v_mfma_f32_16x16x32_bf16 v[112:115], v[32:35], v[72:75], v[112:115]
    ds_read_b64_tr_b16 v[92:93], v15 offset:160
    v_mfma_f32_16x16x32_bf16 v[132:135], v[36:39], v[72:75], v[132:135]
    ds_read_b64_tr_b16 v[94:95], v15 offset:1440
    v_mfma_f32_16x16x32_bf16 v[152:155], v[40:43], v[72:75], v[152:155]
    ds_read_b64_tr_b16 v[96:97], v15 offset:200
    v_mfma_f32_16x16x32_bf16 v[172:175], v[44:47], v[72:75], v[172:175]
    ds_read_b64_tr_b16 v[98:99], v15 offset:1480
    v_mfma_f32_16x16x32_bf16 v[116:119], v[32:35], v[76:79], v[116:119]
    ds_read_b64_tr_b16 v[100:101], v17 offset:0
    v_mfma_f32_16x16x32_bf16 v[136:139], v[36:39], v[76:79], v[136:139]
    ds_read_b64_tr_b16 v[102:103], v17 offset:1280
    v_mfma_f32_16x16x32_bf16 v[156:159], v[40:43], v[76:79], v[156:159]
    v_mfma_f32_16x16x32_bf16 v[176:179], v[44:47], v[76:79], v[176:179]
    v_mfma_f32_16x16x32_bf16 v[120:123], v[32:35], v[80:83], v[120:123]
    v_mfma_f32_16x16x32_bf16 v[140:143], v[36:39], v[80:83], v[140:143]
    v_mfma_f32_16x16x32_bf16 v[160:163], v[40:43], v[80:83], v[160:163]
    v_mfma_f32_16x16x32_bf16 v[180:183], v[44:47], v[80:83], v[180:183]
    s_waitcnt lgkmcnt(0)
    s_waitcnt vmcnt(6)
    v_cmp_ne_u32 vcc, 1, v28
    s_mov_b32 s69, 1048576
    s_cbranch_vccz Lpollx_13
Lpoll_12:
    s_sleep 8
    buffer_load_dword v28, v30, s[4:7], 0 offen sc1
    s_sub_u32 s69, s69, 1
    s_waitcnt vmcnt(0)
    s_cbranch_scc1 Lpollx_13
    v_cmp_ne_u32 vcc, 1, v28
    s_cbranch_vccnz Lpoll_12
Lpollx_13:
    s_waitcnt vmcnt(0)
    s_barrier
    v_mfma_f32_16x16x32_bf16 v[104:107], v[48:51], v[84:87], v[104:107]
    ds_read2_b32 v[232:233], v3 offset0:0 offset1:64
    v_mfma_f32_16x16x32_bf16 v[124:127], v[52:55], v[84:87], v[124:127]
    ds_read2_b32 v[234:235], v3 offset0:16 offset1:80
    v_mfma_f32_16x16x32_bf16 v[144:147], v[56:59], v[84:87], v[144:147]
    ds_read2_b32 v[236:237], v3 offset0:32 offset1:96
    s_xor_b32 s53, s23, 0
    s_lshl_b32 s53, s53, 2
    s_add_u32 s53, s53, s22
    s_mul_i32 s53, s53, 25600
    s_add_u32 s53, s53, 1048576
    buffer_load_dwordx4 a[156:159], v1, s[4:7], s53 offen offset:0 sc1
    v_mfma_f32_16x16x32_bf16 v[164:167], v[60:63], v[84:87], v[164:167]
    ds_read2_b32 v[238:239], v3 offset0:48 offset1:112
    v_mfma_f32_16x16x32_bf16 v[108:111], v[48:51], v[88:91], v[108:111]
    ds_read2_b32 v[240:241], v3 offset0:128 offset1:144
    v_mfma_f32_16x16x32_bf16 v[128:131], v[52:55], v[88:91], v[128:131]
    ds_read_b128 v[184:187], v2 offset:0
    buffer_load_dwordx4 a[160:163], v1, s[4:7], s53 offen offset:1024 sc1
    v_mfma_f32_16x16x32_bf16 v[148:151], v[56:59], v[88:91], v[148:151]
    ds_read_b128 v[200:203], v2 offset:256
    v_mfma_f32_16x16x32_bf16 v[168:171], v[60:63], v[88:91], v[168:171]
    ds_read_b128 v[216:219], v2 offset:512
    v_mfma_f32_16x16x32_bf16 v[112:115], v[48:51], v[92:95], v[112:115]
    ds_read_b128 v[188:191], v2 offset:64
    buffer_load_dwordx4 a[164:167], v1, s[4:7], s53 offen offset:2048 sc1
    v_mfma_f32_16x16x32_bf16 v[132:135], v[52:55], v[92:95], v[132:135]
    ds_read_b128 v[204:207], v2 offset:320
    v_mfma_f32_16x16x32_bf16 v[152:155], v[56:59], v[92:95], v[152:155]
    ds_read_b128 v[220:223], v2 offset:576
    v_mfma_f32_16x16x32_bf16 v[172:175], v[60:63], v[92:95], v[172:175]
    ds_read_b128 v[192:195], v2 offset:128
    buffer_load_dwordx4 a[168:171], v1, s[4:7], s53 offen offset:3072 sc1
    v_mfma_f32_16x16x32_bf16 v[116:119], v[48:51], v[96:99], v[116:119]
    ds_read_b128 v[208:211], v2 offset:384
    v_mfma_f32_16x16x32_bf16 v[136:139], v[52:55], v[96:99], v[136:139]
    ds_read_b128 v[224:227], v2 offset:640
    v_mfma_f32_16x16x32_bf16 v[156:159], v[56:59], v[96:99], v[156:159]
    ds_read_b128 v[196:199], v2 offset:192
    s_add_u32 s53, s53, 4096
    buffer_load_dwordx4 a[172:175], v1, s[4:7], s53 offen offset:0 sc1
    v_mfma_f32_16x16x32_bf16 v[176:179], v[60:63], v[96:99], v[176:179]
    ds_read_b128 v[212:215], v2 offset:448
    v_mfma_f32_16x16x32_bf16 v[120:123], v[48:51], v[100:103], v[120:123]
    ds_read_b128 v[228:231], v2 offset:704
    v_mfma_f32_16x16x32_bf16 v[140:143], v[52:55], v[100:103], v[140:143]
    buffer_load_dwordx4 a[176:179], v1, s[4:7], s53 offen offset:1024 sc1
    v_mfma_f32_16x16x32_bf16 v[160:163], v[56:59], v[100:103], v[160:163]
    v_mfma_f32_16x16x32_bf16 v[180:183], v[60:63], v[100:103], v[180:183]
    s_waitcnt lgkmcnt(9)
    v_add_f32 v232, v232, v233
    v_add_f32 v234, v234, v235
    v_add_f32 v236, v236, v237
    v_add_f32 v238, v238, v239
    v_add_f32 v240, v240, v241
    v_pk_fma_f32 v[104:105], v[184:185], v[232:233], v[104:105] op_sel:[0,0,0] op_sel_hi:[1,0,1] neg_lo:[1,0,0] neg_hi:[1,0,0]
    v_pk_fma_f32 v[106:107], v[186:187], v[232:233], v[106:107] op_sel:[0,0,0] op_sel_hi:[1,0,1] neg_lo:[1,0,0] neg_hi:[1,0,0]
    v_pk_fma_f32 v[104:105], v[104:105], v[216:217], s[40:41] op_sel:[0,0,0] op_sel_hi:[1,1,0]
    v_pk_fma_f32 v[106:107], v[106:107], v[218:219], s[40:41] op_sel:[0,0,0] op_sel_hi:[1,1,0]
    v_exp_f32_e64 v242, v104 clamp
    v_exp_f32_e64 v243, v105 clamp
    v_exp_f32_e64 v244, v106 clamp
    v_exp_f32_e64 v245, v107 clamp
    v_max_f32 v104, s40, v104
    v_max_f32 v105, s40, v105
    v_max_f32 v106, s40, v106
    v_max_f32 v107, s40, v107
    v_pk_fma_f32 v[104:105], v[104:105], s[42:43], v[242:243] op_sel:[0,0,0] op_sel_hi:[1,0,1]
    v_pk_fma_f32 v[106:107], v[106:107], s[42:43], v[244:245] op_sel:[0,0,0] op_sel_hi:[1,0,1]
    v_cvt_pk_bf16_f32 v64, v104, v105
    v_cvt_pk_bf16_f32 v65, v106, v107
    buffer_load_dwordx4 a[180:183], v1, s[4:7], s53 offen offset:2048 sc1
    v_pk_fma_f32 v[108:109], v[184:185], v[234:235], v[108:109] op_sel:[0,0,0] op_sel_hi:[1,0,1] neg_lo:[1,0,0] neg_hi:[1,0,0]
    v_pk_fma_f32 v[110:111], v[186:187], v[234:235], v[110:111] op_sel:[0,0,0] op_sel_hi:[1,0,1] neg_lo:[1,0,0] neg_hi:[1,0,0]
    v_pk_fma_f32 v[108:109], v[108:109], v[216:217], s[40:41] op_sel:[0,0,0] op_sel_hi:[1,1,0]
    v_pk_fma_f32 v[110:111], v[110:111], v[218:219], s[40:41] op_sel:[0,0,0] op_sel_hi:[1,1,0]
    v_exp_f32_e64 v242, v108 clamp
    v_exp_f32_e64 v243, v109 clamp
    v_exp_f32_e64 v244, v110 clamp
    v_exp_f32_e64 v245, v111 clamp
    v_max_f32 v108, s40, v108
    v_max_f32 v109, s40, v109
    v_max_f32 v110, s40, v110
    v_max_f32 v111, s40, v111
    v_pk_fma_f32 v[108:109], v[108:109], s[42:43], v[242:243] op_sel:[0,0,0] op_sel_hi:[1,0,1]
    v_pk_fma_f32 v[110:111], v[110:111], s[42:43], v[244:245] op_sel:[0,0,0] op_sel_hi:[1,0,1]
    v_cvt_pk_bf16_f32 v68, v108, v109
    v_cvt_pk_bf16_f32 v69, v110, v111
    buffer_load_dwordx4 a[184:187], v1, s[4:7], s53 offen offset:3072 sc1
    v_pk_fma_f32 v[112:113], v[184:185], v[236:237], v[112:113] op_sel:[0,0,0] op_sel_hi:[1,0,1] neg_lo:[1,0,0] neg_hi:[1,0,0]
    v_pk_fma_f32 v[114:115], v[186:187], v[236:237], v[114:115] op_sel:[0,0,0] op_sel_hi:[1,0,1] neg_lo:[1,0,0] neg_hi:[1,0,0]
    v_pk_mul_f32 v[112:113], v[112:113], v[200:201] op_sel:[0,0] op_sel_hi:[1,1]
    v_pk_mul_f32 v[114:115], v[114:115], v[202:203] op_sel:[0,0] op_sel_hi:[1,1]
    v_cvt_pk_bf16_f32 v72, v112, v113
    v_cvt_pk_bf16_f32 v73, v114, v115
    v_pk_fma_f32 v[116:117], v[184:185], v[238:239], v[116:117] op_sel:[0,0,0] op_sel_hi:[1,0,1] neg_lo:[1,0,0] neg_hi:[1,0,0]
    v_pk_fma_f32 v[118:119], v[186:187], v[238:239], v[118:119] op_sel:[0,0,0] op_sel_hi:[1,0,1] neg_lo:[1,0,0] neg_hi:[1,0,0]
    v_pk_mul_f32 v[116:117], v[116:117], v[200:201] op_sel:[0,0] op_sel_hi:[1,1]
    v_pk_mul_f32 v[118:119], v[118:119], v[202:203] op_sel:[0,0] op_sel_hi:[1,1]
    v_cvt_pk_bf16_f32 v76, v116, v117
    v_cvt_pk_bf16_f32 v77, v118, v119
    s_add_u32 s53, s53, 4096
    buffer_load_dwordx4 a[188:191], v1, s[4:7], s53 offen offset:0 sc1
    v_pk_fma_f32 v[120:121], v[184:185], v[240:241], v[120:121] op_sel:[0,0,0] op_sel_hi:[1,0,1] neg_lo:[1,0,0] neg_hi:[1,0,0]
    v_pk_fma_f32 v[122:123], v[186:187], v[240:241], v[122:123] op_sel:[0,0,0] op_sel_hi:[1,0,1] neg_lo:[1,0,0] neg_hi:[1,0,0]
    v_pk_fma_f32 v[242:243], v[120:121], v[216:217], v[246:247] op_sel:[0,0,1] op_sel_hi:[1,1,1]
    v_pk_fma_f32 v[244:245], v[122:123], v[218:219], v[246:247] op_sel:[0,0,1] op_sel_hi:[1,1,1]
    v_exp_f32_e64 v242, v242 clamp
    v_exp_f32_e64 v243, v243 clamp
    v_exp_f32_e64 v244, v244 clamp
    v_exp_f32_e64 v245, v245 clamp
    v_max_f32 v120, v247, v120
    v_max_f32 v121, v247, v121
    v_max_f32 v122, v247, v122
    v_max_f32 v123, v247, v123
    v_pk_add_f32 v[242:243], v[242:243], v[22:23] op_sel:[0,0] op_sel_hi:[1,0]
    v_pk_add_f32 v[244:245], v[244:245], v[22:23] op_sel:[0,0] op_sel_hi:[1,0]
    v_pk_fma_f32 v[120:121], v[120:121], v[200:201], v[242:243] op_sel:[0,0,0] op_sel_hi:[1,1,1]
    v_pk_fma_f32 v[122:123], v[122:123], v[202:203], v[244:245] op_sel:[0,0,0] op_sel_hi:[1,1,1]
    v_cvt_pk_bf16_f32 v80, v120, v121
    v_cvt_pk_bf16_f32 v81, v122, v123
    buffer_load_dwordx4 a[192:195], v1, s[4:7], s53 offen offset:1024 sc1
    s_waitcnt lgkmcnt(6)
    s_nop 0
    v_pk_fma_f32 v[124:125], v[188:189], v[232:233], v[124:125] op_sel:[0,0,0] op_sel_hi:[1,0,1] neg_lo:[1,0,0] neg_hi:[1,0,0]
    v_pk_fma_f32 v[126:127], v[190:191], v[232:233], v[126:127] op_sel:[0,0,0] op_sel_hi:[1,0,1] neg_lo:[1,0,0] neg_hi:[1,0,0]
    v_pk_fma_f32 v[124:125], v[124:125], v[220:221], s[40:41] op_sel:[0,0,0] op_sel_hi:[1,1,0]
    v_pk_fma_f32 v[126:127], v[126:127], v[222:223], s[40:41] op_sel:[0,0,0] op_sel_hi:[1,1,0]
    v_exp_f32_e64 v242, v124 clamp
    v_exp_f32_e64 v243, v125 clamp
    v_exp_f32_e64 v244, v126 clamp
    v_exp_f32_e64 v245, v127 clamp
    v_max_f32 v124, s40, v124
    v_max_f32 v125, s40, v125
    v_max_f32 v126, s40, v126
    v_max_f32 v127, s40, v127
    v_pk_fma_f32 v[124:125], v[124:125], s[42:43], v[242:243] op_sel:[0,0,0] op_sel_hi:[1,0,1]
    v_pk_fma_f32 v[126:127], v[126:127], s[42:43], v[244:245] op_sel:[0,0,0] op_sel_hi:[1,0,1]
    v_cvt_pk_bf16_f32 v66, v124, v125
    v_cvt_pk_bf16_f32 v67, v126, v127
    buffer_load_dwordx4 a[196:199], v1, s[4:7], s53 offen offset:2048 sc1
    v_pk_fma_f32 v[128:129], v[188:189], v[234:235], v[128:129] op_sel:[0,0,0] op_sel_hi:[1,0,1] neg_lo:[1,0,0] neg_hi:[1,0,0]
    v_pk_fma_f32 v[130:131], v[190:191], v[234:235], v[130:131] op_sel:[0,0,0] op_sel_hi:[1,0,1] neg_lo:[1,0,0] neg_hi:[1,0,0]
    v_pk_fma_f32 v[128:129], v[128:129], v[220:221], s[40:41] op_sel:[0,0,0] op_sel_hi:[1,1,0]
    v_pk_fma_f32 v[130:131], v[130:131], v[222:223], s[40:41] op_sel:[0,0,0] op_sel_hi:[1,1,0]
    v_exp_f32_e64 v242, v128 clamp
    v_exp_f32_e64 v243, v129 clamp
    v_exp_f32_e64 v244, v130 clamp
    v_exp_f32_e64 v245, v131 clamp
    v_max_f32 v128, s40, v128
    v_max_f32 v129, s40, v129
    v_max_f32 v130, s40, v130
    v_max_f32 v131, s40, v131
    v_pk_fma_f32 v[128:129], v[128:129], s[42:43], v[242:243] op_sel:[0,0,0] op_sel_hi:[1,0,1]
    v_pk_fma_f32 v[130:131], v[130:131], s[42:43], v[244:245] op_sel:[0,0,0] op_sel_hi:[1,0,1]
    v_cvt_pk_bf16_f32 v70, v128, v129
    v_cvt_pk_bf16_f32 v71, v130, v131
    buffer_load_dwordx4 a[200:203], v1, s[4:7], s53 offen offset:3072 sc1
    v_pk_fma_f32 v[132:133], v[188:189], v[236:237], v[132:133] op_sel:[0,0,0] op_sel_hi:[1,0,1] neg_lo:[1,0,0] neg_hi:[1,0,0]
    v_pk_fma_f32 v[134:135], v[190:191], v[236:237], v[134:135] op_sel:[0,0,0] op_sel_hi:[1,0,1] neg_lo:[1,0,0] neg_hi:[1,0,0]
    v_pk_mul_f32 v[132:133], v[132:133], v[204:205] op_sel:[0,0] op_sel_hi:[1,1]
    v_pk_mul_f32 v[134:135], v[134:135], v[206:207] op_sel:[0,0] op_sel_hi:[1,1]
    v_cvt_pk_bf16_f32 v74, v132, v133
    v_cvt_pk_bf16_f32 v75, v134, v135
    v_pk_fma_f32 v[136:137], v[188:189], v[238:239], v[136:137] op_sel:[0,0,0] op_sel_hi:[1,0,1] neg_lo:[1,0,0] neg_hi:[1,0,0]
    v_pk_fma_f32 v[138:139], v[190:191], v[238:239], v[138:139] op_sel:[0,0,0] op_sel_hi:[1,0,1] neg_lo:[1,0,0] neg_hi:[1,0,0]
    v_pk_mul_f32 v[136:137], v[136:137], v[204:205] op_sel:[0,0] op_sel_hi:[1,1]
    v_pk_mul_f32 v[138:139], v[138:139], v[206:207] op_sel:[0,0] op_sel_hi:[1,1]
    v_cvt_pk_bf16_f32 v78, v136, v137
    v_cvt_pk_bf16_f32 v79, v138, v139
    s_add_u32 s53, s53, 4096
    buffer_load_dwordx4 a[204:207], v1, s[4:7], s53 offen offset:0 sc1
    v_pk_fma_f32 v[140:141], v[188:189], v[240:241], v[140:141] op_sel:[0,0,0] op_sel_hi:[1,0,1] neg_lo:[1,0,0] neg_hi:[1,0,0]
    v_pk_fma_f32 v[142:143], v[190:191], v[240:241], v[142:143] op_sel:[0,0,0] op_sel_hi:[1,0,1] neg_lo:[1,0,0] neg_hi:[1,0,0]
    v_pk_fma_f32 v[242:243], v[140:141], v[220:221], v[246:247] op_sel:[0,0,1] op_sel_hi:[1,1,1]
    v_pk_fma_f32 v[244:245], v[142:143], v[222:223], v[246:247] op_sel:[0,0,1] op_sel_hi:[1,1,1]
    v_exp_f32_e64 v242, v242 clamp
    v_exp_f32_e64 v243, v243 clamp
    v_exp_f32_e64 v244, v244 clamp
    v_exp_f32_e64 v245, v245 clamp
    v_max_f32 v140, v247, v140
    v_max_f32 v141, v247, v141
    v_max_f32 v142, v247, v142
    v_max_f32 v143, v247, v143
    v_pk_add_f32 v[242:243], v[242:243], v[22:23] op_sel:[0,0] op_sel_hi:[1,0]
    v_pk_add_f32 v[244:245], v[244:245], v[22:23] op_sel:[0,0] op_sel_hi:[1,0]
    v_pk_fma_f32 v[140:141], v[140:141], v[204:205], v[242:243] op_sel:[0,0,0] op_sel_hi:[1,1,1]
    v_pk_fma_f32 v[142:143], v[142:143], v[206:207], v[244:245] op_sel:[0,0,0] op_sel_hi:[1,1,1]
    v_cvt_pk_bf16_f32 v82, v140, v141
    v_cvt_pk_bf16_f32 v83, v142, v143
    buffer_load_dwordx4 a[208:211], v1, s[4:7], s53 offen offset:1024 sc1
    s_waitcnt lgkmcnt(3)
    s_nop 0
    v_pk_fma_f32 v[144:145], v[192:193], v[232:233], v[144:145] op_sel:[0,0,0] op_sel_hi:[1,0,1] neg_lo:[1,0,0] neg_hi:[1,0,0]
    v_pk_fma_f32 v[146:147], v[194:195], v[232:233], v[146:147] op_sel:[0,0,0] op_sel_hi:[1,0,1] neg_lo:[1,0,0] neg_hi:[1,0,0]
    v_pk_fma_f32 v[144:145], v[144:145], v[224:225], s[40:41] op_sel:[0,0,0] op_sel_hi:[1,1,0]
    v_pk_fma_f32 v[146:147], v[146:147], v[226:227], s[40:41] op_sel:[0,0,0] op_sel_hi:[1,1,0]
    v_exp_f32_e64 v242, v144 clamp
    v_exp_f32_e64 v243, v145 clamp
    v_exp_f32_e64 v244, v146 clamp
    v_exp_f32_e64 v245, v147 clamp
    v_max_f32 v144, s40, v144
    v_max_f32 v145, s40, v145
    v_max_f32 v146, s40, v146
    v_max_f32 v147, s40, v147
    v_pk_fma_f32 v[144:145], v[144:145], s[42:43], v[242:243] op_sel:[0,0,0] op_sel_hi:[1,0,1]
    v_pk_fma_f32 v[146:147], v[146:147], s[42:43], v[244:245] op_sel:[0,0,0] op_sel_hi:[1,0,1]
    v_cvt_pk_bf16_f32 v84, v144, v145
    v_cvt_pk_bf16_f32 v85, v146, v147
    buffer_load_dwordx4 a[212:215], v1, s[4:7], s53 offen offset:2048 sc1
    v_pk_fma_f32 v[148:149], v[192:193], v[234:235], v[148:149] op_sel:[0,0,0] op_sel_hi:[1,0,1] neg_lo:[1,0,0] neg_hi:[1,0,0]
    v_pk_fma_f32 v[150:151], v[194:195], v[234:235], v[150:151] op_sel:[0,0,0] op_sel_hi:[1,0,1] neg_lo:[1,0,0] neg_hi:[1,0,0]
    v_pk_fma_f32 v[148:149], v[148:149], v[224:225], s[40:41] op_sel:[0,0,0] op_sel_hi:[1,1,0]
    v_pk_fma_f32 v[150:151], v[150:151], v[226:227], s[40:41] op_sel:[0,0,0] op_sel_hi:[1,1,0]
    v_exp_f32_e64 v242, v148 clamp
    v_exp_f32_e64 v243, v149 clamp
    v_exp_f32_e64 v244, v150 clamp
    v_exp_f32_e64 v245, v151 clamp
    v_max_f32 v148, s40, v148
    v_max_f32 v149, s40, v149
    v_max_f32 v150, s40, v150
    v_max_f32 v151, s40, v151
    v_pk_fma_f32 v[148:149], v[148:149], s[42:43], v[242:243] op_sel:[0,0,0] op_sel_hi:[1,0,1]
    v_pk_fma_f32 v[150:151], v[150:151], s[42:43], v[244:245] op_sel:[0,0,0] op_sel_hi:[1,0,1]
    v_cvt_pk_bf16_f32 v88, v148, v149
    v_cvt_pk_bf16_f32 v89, v150, v151
    buffer_load_dwordx4 a[216:219], v1, s[4:7], s53 offen offset:3072 sc1
    v_pk_fma_f32 v[152:153], v[192:193], v[236:237], v[152:153] op_sel:[0,0,0] op_sel_hi:[1,0,1] neg_lo:[1,0,0] neg_hi:[1,0,0]
    v_pk_fma_f32 v[154:155], v[194:195], v[236:237], v[154:155] op_sel:[0,0,0] op_sel_hi:[1,0,1] neg_lo:[1,0,0] neg_hi:[1,0,0]
    v_pk_mul_f32 v[152:153], v[152:153], v[208:209] op_sel:[0,0] op_sel_hi:[1,1]
    v_pk_mul_f32 v[154:155], v[154:155], v[210:211] op_sel:[0,0] op_sel_hi:[1,1]
    v_cvt_pk_bf16_f32 v92, v152, v153
    v_cvt_pk_bf16_f32 v93, v154, v155
    v_pk_fma_f32 v[156:157], v[192:193], v[238:239], v[156:157] op_sel:[0,0,0] op_sel_hi:[1,0,1] neg_lo:[1,0,0] neg_hi:[1,0,0]
    v_pk_fma_f32 v[158:159], v[194:195], v[238:239], v[158:159] op_sel:[0,0,0] op_sel_hi:[1,0,1] neg_lo:[1,0,0] neg_hi:[1,0,0]
    v_pk_mul_f32 v[156:157], v[156:157], v[208:209] op_sel:[0,0] op_sel_hi:[1,1]
    v_pk_mul_f32 v[158:159], v[158:159], v[210:211] op_sel:[0,0] op_sel_hi:[1,1]
    v_cvt_pk_bf16_f32 v96, v156, v157
    v_cvt_pk_bf16_f32 v97, v158, v159
    s_add_u32 s53, s53, 4096
    buffer_load_dwordx4 a[220:223], v1, s[4:7], s53 offen offset:0 sc1
    v_pk_fma_f32 v[160:161], v[192:193], v[240:241], v[160:161] op_sel:[0,0,0] op_sel_hi:[1,0,1] neg_lo:[1,0,0] neg_hi:[1,0,0]
    v_pk_fma_f32 v[162:163], v[194:195], v[240:241], v[162:163] op_sel:[0,0,0] op_sel_hi:[1,0,1] neg_lo:[1,0,0] neg_hi:[1,0,0]
    v_pk_fma_f32 v[242:243], v[160:161], v[224:225], v[246:247] op_sel:[0,0,1] op_sel_hi:[1,1,1]
    v_pk_fma_f32 v[244:245], v[162:163], v[226:227], v[246:247] op_sel:[0,0,1] op_sel_hi:[1,1,1]
    v_exp_f32_e64 v242, v242 clamp
    v_exp_f32_e64 v243, v243 clamp
    v_exp_f32_e64 v244, v244 clamp
    v_exp_f32_e64 v245, v245 clamp
    v_max_f32 v160, v247, v160
    v_max_f32 v161, v247, v161
    v_max_f32 v162, v247, v162
    v_max_f32 v163, v247, v163
    v_pk_add_f32 v[242:243], v[242:243], v[22:23] op_sel:[0,0] op_sel_hi:[1,0]
    v_pk_add_f32 v[244:245], v[244:245], v[22:23] op_sel:[0,0] op_sel_hi:[1,0]
    v_pk_fma_f32 v[160:161], v[160:161], v[208:209], v[242:243] op_sel:[0,0,0] op_sel_hi:[1,1,1]
    v_pk_fma_f32 v[162:163], v[162:163], v[210:211], v[244:245] op_sel:[0,0,0] op_sel_hi:[1,1,1]
    v_cvt_pk_bf16_f32 v100, v160, v161
    v_cvt_pk_bf16_f32 v101, v162, v163
    buffer_load_dwordx4 a[224:227], v1, s[4:7], s53 offen offset:1024 sc1
    s_waitcnt lgkmcnt(0)
    s_nop 0
    v_pk_fma_f32 v[164:165], v[196:197], v[232:233], v[164:165] op_sel:[0,0,0] op_sel_hi:[1,0,1] neg_lo:[1,0,0] neg_hi:[1,0,0]
    v_pk_fma_f32 v[166:167], v[198:199], v[232:233], v[166:167] op_sel:[0,0,0] op_sel_hi:[1,0,1] neg_lo:[1,0,0] neg_hi:[1,0,0]
    v_pk_fma_f32 v[164:165], v[164:165], v[228:229], s[40:41] op_sel:[0,0,0] op_sel_hi:[1,1,0]
    v_pk_fma_f32 v[166:167], v[166:167], v[230:231], s[40:41] op_sel:[0,0,0] op_sel_hi:[1,1,0]
    v_exp_f32_e64 v242, v164 clamp
    v_exp_f32_e64 v243, v165 clamp
    v_exp_f32_e64 v244, v166 clamp
    v_exp_f32_e64 v245, v167 clamp
    v_max_f32 v164, s40, v164
    v_max_f32 v165, s40, v165
    v_max_f32 v166, s40, v166
    v_max_f32 v167, s40, v167
    v_pk_fma_f32 v[164:165], v[164:165], s[42:43], v[242:243] op_sel:[0,0,0] op_sel_hi:[1,0,1]
    v_pk_fma_f32 v[166:167], v[166:167], s[42:43], v[244:245] op_sel:[0,0,0] op_sel_hi:[1,0,1]
    v_cvt_pk_bf16_f32 v86, v164, v165
    v_cvt_pk_bf16_f32 v87, v166, v167
    buffer_load_dwordx4 a[228:231], v1, s[4:7], s53 offen offset:2048 sc1
    v_pk_fma_f32 v[168:169], v[196:197], v[234:235], v[168:169] op_sel:[0,0,0] op_sel_hi:[1,0,1] neg_lo:[1,0,0] neg_hi:[1,0,0]
    v_pk_fma_f32 v[170:171], v[198:199], v[234:235], v[170:171] op_sel:[0,0,0] op_sel_hi:[1,0,1] neg_lo:[1,0,0] neg_hi:[1,0,0]
    v_pk_fma_f32 v[168:169], v[168:169], v[228:229], s[40:41] op_sel:[0,0,0] op_sel_hi:[1,1,0]
    v_pk_fma_f32 v[170:171], v[170:171], v[230:231], s[40:41] op_sel:[0,0,0] op_sel_hi:[1,1,0]
    v_exp_f32_e64 v242, v168 clamp
    v_exp_f32_e64 v243, v169 clamp
    v_exp_f32_e64 v244, v170 clamp
    v_exp_f32_e64 v245, v171 clamp
    v_max_f32 v168, s40, v168
    v_max_f32 v169, s40, v169
    v_max_f32 v170, s40, v170
    v_max_f32 v171, s40, v171
    v_pk_fma_f32 v[168:169], v[168:169], s[42:43], v[242:243] op_sel:[0,0,0] op_sel_hi:[1,0,1]
    v_pk_fma_f32 v[170:171], v[170:171], s[42:43], v[244:245] op_sel:[0,0,0] op_sel_hi:[1,0,1]
    v_cvt_pk_bf16_f32 v90, v168, v169
    v_cvt_pk_bf16_f32 v91, v170, v171
    buffer_load_dwordx4 a[232:235], v1, s[4:7], s53 offen offset:3072 sc1
    v_pk_fma_f32 v[172:173], v[196:197], v[236:237], v[172:173] op_sel:[0,0,0] op_sel_hi:[1,0,1] neg_lo:[1,0,0] neg_hi:[1,0,0]
    v_pk_fma_f32 v[174:175], v[198:199], v[236:237], v[174:175] op_sel:[0,0,0] op_sel_hi:[1,0,1] neg_lo:[1,0,0] neg_hi:[1,0,0]
    v_pk_mul_f32 v[172:173], v[172:173], v[212:213] op_sel:[0,0] op_sel_hi:[1,1]
    v_pk_mul_f32 v[174:175], v[174:175], v[214:215] op_sel:[0,0] op_sel_hi:[1,1]
    v_cvt_pk_bf16_f32 v94, v172, v173
    v_cvt_pk_bf16_f32 v95, v174, v175
    v_pk_fma_f32 v[176:177], v[196:197], v[238:239], v[176:177] op_sel:[0,0,0] op_sel_hi:[1,0,1] neg_lo:[1,0,0] neg_hi:[1,0,0]
    v_pk_fma_f32 v[178:179], v[198:199], v[238:239], v[178:179] op_sel:[0,0,0] op_sel_hi:[1,0,1] neg_lo:[1,0,0] neg_hi:[1,0,0]
    v_pk_mul_f32 v[176:177], v[176:177], v[212:213] op_sel:[0,0] op_sel_hi:[1,1]
    s_branch Lpg_entry_2_go
.p2align 12
Lpg_entry_2:
    s_setpc_b64 s[0:1]
.p2align 3
Lpg_entry_2_go:
    v_pk_mul_f32 v[178:179], v[178:179], v[214:215] op_sel:[0,0] op_sel_hi:[1,1]
    v_cvt_pk_bf16_f32 v98, v176, v177
    v_cvt_pk_bf16_f32 v99, v178, v179
    s_add_u32 s53, s53, 4096
    buffer_load_dwordx4 a[236:239], v1, s[4:7], s53 offen offset:0 sc1
    v_pk_fma_f32 v[180:181], v[196:197], v[240:241], v[180:181] op_sel:[0,0,0] op_sel_hi:[1,0,1] neg_lo:[1,0,0] neg_hi:[1,0,0]
    v_pk_fma_f32 v[182:183], v[198:199], v[240:241], v[182:183] op_sel:[0,0,0] op_sel_hi:[1,0,1] neg_lo:[1,0,0] neg_hi:[1,0,0]
    v_pk_fma_f32 v[242:243], v[180:181], v[228:229], v[246:247] op_sel:[0,0,1] op_sel_hi:[1,1,1]
    v_pk_fma_f32 v[244:245], v[182:183], v[230:231], v[246:247] op_sel:[0,0,1] op_sel_hi:[1,1,1]
    v_exp_f32_e64 v242, v242 clamp
    v_exp_f32_e64 v243, v243 clamp
    v_exp_f32_e64 v244, v244 clamp
    v_exp_f32_e64 v245, v245 clamp
    v_max_f32 v180, v247, v180
    v_max_f32 v181, v247, v181
    v_max_f32 v182, v247, v182
    v_max_f32 v183, v247, v183
    v_pk_add_f32 v[242:243], v[242:243], v[22:23] op_sel:[0,0] op_sel_hi:[1,0]
    v_pk_add_f32 v[244:245], v[244:245], v[22:23] op_sel:[0,0] op_sel_hi:[1,0]
    v_pk_fma_f32 v[180:181], v[180:181], v[212:213], v[242:243] op_sel:[0,0,0] op_sel_hi:[1,1,1]
    v_pk_fma_f32 v[182:183], v[182:183], v[214:215], v[244:245] op_sel:[0,0,0] op_sel_hi:[1,1,1]
    v_cvt_pk_bf16_f32 v102, v180, v181
    v_cvt_pk_bf16_f32 v103, v182, v183
    buffer_load_dwordx4 a[240:243], v1, s[4:7], s53 offen offset:1024 sc1
    v_mfma_f32_16x16x32_bf16 v[136:139], v[64:67], v[72:75], 0
    v_cndmask_b32 v120, v23, v80, s[64:65]
    v_cndmask_b32 v121, v23, v81, s[64:65]
    v_cndmask_b32 v122, v23, v82, s[64:65]
    v_mfma_f32_16x16x32_bf16 v[140:143], v[68:71], v[76:79], 0
    v_cndmask_b32 v123, v23, v83, s[64:65]
    v_cndmask_b32 v104, 0, v80, s[60:61]
    v_cndmask_b32 v105, 0, v81, s[60:61]
    v_mfma_f32_16x16x32_bf16 v[136:139], v[84:87], v[92:95], v[136:139]
    v_cndmask_b32 v106, 0, v82, s[60:61]
    v_cndmask_b32 v107, 0, v83, s[60:61]
    buffer_load_dwordx4 a[244:247], v1, s[4:7], s53 offen offset:2048 sc1
    v_mfma_f32_16x16x32_bf16 v[140:143], v[88:91], v[96:99], v[140:143]
    v_cndmask_b32 v124, v24, v80, s[66:67]
    v_cndmask_b32 v125, v24, v81, s[66:67]
    v_cndmask_b32 v126, v24, v82, s[66:67]
    v_mfma_f32_16x16x32_bf16 v[144:147], v[64:67], v[120:123], 0
    v_cndmask_b32 v127, v24, v83, s[66:67]
    v_cndmask_b32 v108, 0, v80, s[62:63]
    v_cndmask_b32 v109, 0, v81, s[62:63]
    v_mfma_f32_16x16x32_bf16 v[148:151], v[104:107], v[72:75], 0
    v_cndmask_b32 v110, 0, v82, s[62:63]
    v_cndmask_b32 v111, 0, v83, s[62:63]
    buffer_load_dwordx4 a[248:251], v1, s[4:7], s53 offen offset:3072 sc1
    v_mfma_f32_16x16x32_bf16 v[152:155], v[104:107], v[120:123], 0
    v_cndmask_b32 v128, v23, v100, s[64:65]
    v_cndmask_b32 v129, v23, v101, s[64:65]
    v_cndmask_b32 v130, v23, v102, s[64:65]
    v_mfma_f32_16x16x32_bf16 v[144:147], v[68:71], v[124:127], v[144:147]
    v_cndmask_b32 v131, v23, v103, s[64:65]
    v_cndmask_b32 v112, 0, v100, s[60:61]
    v_cndmask_b32 v113, 0, v101, s[60:61]
    v_mfma_f32_16x16x32_bf16 v[148:151], v[108:111], v[76:79], v[148:151]
    v_cndmask_b32 v114, 0, v102, s[60:61]
    v_cndmask_b32 v115, 0, v103, s[60:61]
    s_add_u32 s53, s53, 4096
    buffer_load_dwordx4 a[252:255], v1, s[4:7], s53 offen offset:0 sc1
    v_mfma_f32_16x16x32_bf16 v[152:155], v[108:111], v[124:127], v[152:155]
    v_cndmask_b32 v132, v24, v100, s[66:67]
    v_cndmask_b32 v133, v24, v101, s[66:67]
    v_cndmask_b32 v134, v24, v102, s[66:67]
    v_mfma_f32_16x16x32_bf16 v[144:147], v[84:87], v[128:131], v[144:147]
    v_cndmask_b32 v135, v24, v103, s[66:67]
    v_cndmask_b32 v116, 0, v100, s[62:63]
    v_cndmask_b32 v117, 0, v101, s[62:63]
    v_mfma_f32_16x16x32_bf16 v[148:151], v[112:115], v[92:95], v[148:151]
    v_cndmask_b32 v118, 0, v102, s[62:63]
    v_cndmask_b32 v119, 0, v103, s[62:63]
    s_xor_b32 s53, s23, 1
    s_lshl_b32 s53, s53, 2
    s_add_u32 s53, s53, s22
    s_mul_i32 s53, s53, 25600
    s_add_u32 s53, s53, 1048576
    s_mul_i32 s52, s22, 25600
    s_add_u32 m0, s52, 0
    s_nop 0
    buffer_load_dwordx4 v1, s[4:7], s53 offen offset:0 sc1 lds
    v_mfma_f32_16x16x32_bf16 v[152:155], v[112:115], v[128:131], v[152:155]
    v_add_u32 v242, 110976, v255
    ds_write_b128 v25, v[136:139]
    ds_write_b128 v25, v[140:143] offset:1024
    v_mfma_f32_16x16x32_bf16 v[144:147], v[88:91], v[132:135], v[144:147]
    v_mfma_f32_16x16x32_bf16 v[148:151], v[116:119], v[96:99], v[148:151]
    v_mfma_f32_16x16x32_bf16 v[152:155], v[116:119], v[132:135], v[152:155]
    s_nop 5
    ds_write_b128 v26, v[144:147] offset:5120
    s_nop 0
    v_permlane32_swap_b32 v148, v152
    v_permlane32_swap_b32 v149, v153
    v_permlane32_swap_b32 v150, v154
    v_permlane32_swap_b32 v151, v155
    ds_write_b128 v27, v[148:151] offset:4096
    s_waitcnt lgkmcnt(0)
    s_barrier
    s_nop 0
    ds_read2st64_b32 v[184:185], v242 offset0:0 offset1:32
    ds_read2st64_b32 v[186:187], v242 offset0:1 offset1:33
    ds_read2st64_b32 v[188:189], v242 offset0:2 offset1:34
    ds_read2st64_b32 v[190:191], v242 offset0:3 offset1:35
    ds_read2st64_b32 v[192:193], v242 offset0:4 offset1:36
    ds_read2st64_b32 v[194:195], v242 offset0:5 offset1:37
    ds_read2st64_b32 v[196:197], v242 offset0:6 offset1:38
    ds_read2st64_b32 v[198:199], v242 offset0:7 offset1:39
    s_waitcnt lgkmcnt(7)
    v_add_f32 v184, v184, v185
    buffer_atomic_add_f32 v184, v254, s[4:7], s49 offen
    s_add_u32 s49, s49, 256
    s_waitcnt lgkmcnt(6)
    v_add_f32 v186, v186, v187
    buffer_atomic_add_f32 v186, v254, s[4:7], s49 offen
    s_add_u32 s49, s49, 256
    s_waitcnt lgkmcnt(5)
    v_add_f32 v188, v188, v189
    buffer_atomic_add_f32 v188, v254, s[4:7], s49 offen
    s_add_u32 s49, s49, 256
    s_waitcnt lgkmcnt(4)
    v_add_f32 v190, v190, v191
    buffer_atomic_add_f32 v190, v254, s[4:7], s49 offen
    s_add_u32 s49, s49, 256
    s_waitcnt lgkmcnt(3)
    v_add_f32 v192, v192, v193
    buffer_atomic_add_f32 v192, v254, s[4:7], s49 offen
    s_add_u32 s49, s49, 256
    s_waitcnt lgkmcnt(2)
    v_add_f32 v194, v194, v195
    buffer_atomic_add_f32 v194, v254, s[4:7], s49 offen
    s_add_u32 s49, s49, 256
    s_waitcnt lgkmcnt(1)
    v_add_f32 v196, v196, v197
    buffer_atomic_add_f32 v196, v254, s[4:7], s49 offen
    s_add_u32 s49, s49, 256
    s_waitcnt lgkmcnt(0)
    v_add_f32 v198, v198, v199
    buffer_atomic_add_f32 v198, v254, s[4:7], s49 offen
    s_lshl_b32 s55, s45, 8
    s_nop 0
    s_add_u32 s55, s55, 65536
    buffer_load_dwordx4 v1, s[4:7], s53 offen offset:1024 sc1 lds
    buffer_load_dwordx4 v1, s[4:7], s53 offen offset:2048 sc1 lds
    buffer_load_dwordx4 v1, s[4:7], s53 offen offset:3072 sc1 lds
    s_add_u32 m0, s52, 4096
    s_add_u32 s53, s53, 4096
    buffer_load_dwordx4 v1, s[4:7], s53 offen offset:0 sc1 lds
    buffer_load_dwordx4 v1, s[4:7], s53 offen offset:1024 sc1 lds
    buffer_load_dwordx4 v1, s[4:7], s53 offen offset:2048 sc1 lds
    buffer_load_dwordx4 v1, s[4:7], s53 offen offset:3072 sc1 lds
    s_add_u32 m0, s52, 8192
    s_add_u32 s53, s53, 4096
    buffer_load_dwordx4 v1, s[4:7], s53 offen offset:0 sc1 lds
    s_cmp_lg_u32 s22, 3
    s_cbranch_scc1 Lwm_5
    s_call_b64 s[0:1], Lpg_join
Lwm_5:
    s_waitcnt vmcnt(8)
    s_barrier
    s_add_u32 s56, s55, 40960
    s_mul_i32 s70, s22, 4096
    s_add_u32 s70, s70, s56
    s_add_u32 s42, s4, s70
    s_addc_u32 s43, s5, 0
    s_mov_b32 s70, 1
    s_atomic_add s70, s[42:43], 0
    s_atomic_add s70, s[42:43], 2048
Lsig_14:
    buffer_load_dwordx4 v1, s[4:7], s53 offen offset:1024 sc1 lds
    buffer_load_dwordx4 v1, s[4:7], s53 offen offset:2048 sc1 lds
    buffer_load_dwordx4 v1, s[4:7], s53 offen offset:3072 sc1 lds
    s_add_u32 m0, s52, 12288
    s_add_u32 s53, s53, 4096
    buffer_load_dwordx4 v1, s[4:7], s53 offen offset:0 sc1 lds
    buffer_load_dwordx4 v1, s[4:7], s53 offen offset:1024 sc1 lds
    buffer_load_dwordx4 v1, s[4:7], s53 offen offset:2048 sc1 lds
    buffer_load_dwordx4 v1, s[4:7], s53 offen offset:3072 sc1 lds
    s_add_u32 m0, s52, 16384
    s_add_u32 s53, s53, 4096
    buffer_load_dwordx4 v1, s[4:7], s53 offen offset:0 sc1 lds
    s_lshl_b32 s71, s24, 2
    s_add_u32 s71, s71, s22
    s_lshl_b32 s71, s71, 8
    s_add_u32 s71, s71, 81920
    v_mov_b32 v246, s71
    buffer_load_dword v245, v246, s[4:7], 0 offen sc1
    buffer_load_dwordx4 v1, s[4:7], s53 offen offset:1024 sc1 lds
    buffer_load_dwordx4 v1, s[4:7], s53 offen offset:2048 sc1 lds
    buffer_load_dwordx4 v1, s[4:7], s53 offen offset:3072 sc1 lds
    s_add_u32 m0, s52, 20480
    s_add_u32 s53, s53, 4096
    buffer_load_dwordx4 v1, s[4:7], s53 offen offset:0 sc1 lds
    buffer_load_dwordx4 v1, s[4:7], s53 offen offset:1024 sc1 lds
    buffer_load_dwordx4 v1, s[4:7], s53 offen offset:2048 sc1 lds
    buffer_load_dwordx4 v1, s[4:7], s53 offen offset:3072 sc1 lds
    s_add_u32 m0, s52, 24576
    s_add_u32 s53, s53, 4096
    buffer_load_dwordx4 v1, s[4:7], s53 offen offset:0 sc1 lds
    s_branch Ljoin
.p2align 12
Lpg_q:
    s_setpc_b64 s[0:1]
.p2align 3
Lpg_q_go:
Lgq_4:
    s_waitcnt vmcnt(9)
    s_barrier
    s_nop 0
    ds_read_b128 v[32:35], v12 offset:0
    ds_read_b128 v[36:39], v12 offset:2048
    ds_read_b128 v[40:43], v12 offset:4096
    ds_read_b128 v[44:47], v12 offset:6144
    ds_read_b64_tr_b16 v[64:65], v14 offset:0
    ds_read_b64_tr_b16 v[66:67], v14 offset:1280
    ds_read_b64_tr_b16 v[68:69], v14 offset:40
    ds_read_b64_tr_b16 v[70:71], v14 offset:1320
    ds_read_b64_tr_b16 v[72:73], v14 offset:80
    ds_read_b64_tr_b16 v[74:75], v14 offset:1360
    ds_read_b64_tr_b16 v[76:77], v14 offset:120
    ds_read_b64_tr_b16 v[78:79], v14 offset:1400
    ds_read_b64_tr_b16 v[80:81], v16 offset:0
    ds_read_b64_tr_b16 v[82:83], v16 offset:1280
    s_and_b32 s55, s58, 15
    s_lshr_b64 s[58:59], s[58:59], 4
    s_lshl_b32 s49, s55, 7
    s_mul_i32 s50, s55, 245760
    s_mov_b32 m0, s53
    s_nop 0
    buffer_load_dwordx4 v2, s[8:11], s49 offen offset:0 lds
    buffer_load_dwordx4 v3, s[8:11], s49 offen offset:1024 lds
    buffer_load_dwordx4 v4, s[8:11], s49 offen offset:2048 lds
    buffer_load_dwordx4 v5, s[8:11], s49 offen offset:3072 lds
    s_mov_b32 s48, 7
    s_mov_b32 s51, 2
    s_mov_b32 s56, 4294856320
    s_mov_b32 s57, 36992
    s_waitcnt lgkmcnt(0)
    v_mfma_f32_16x16x32_bf16 v[104:107], v[64:67], v[32:35], 0
    ds_read_b128 v[48:51], v13 offset:0
    s_mov_b32 m0, s54
    v_mfma_f32_16x16x32_bf16 v[124:127], v[64:67], v[36:39], 0
    ds_read_b128 v[52:55], v13 offset:2048
    v_mfma_f32_16x16x32_bf16 v[144:147], v[64:67], v[40:43], 0
    ds_read_b128 v[56:59], v13 offset:4096
    buffer_load_dwordx4 v6, s[12:15], s50 offen offset:0 lds
    v_mfma_f32_16x16x32_bf16 v[164:167], v[64:67], v[44:47], 0
    ds_read_b128 v[60:63], v13 offset:6144
    v_mfma_f32_16x16x32_bf16 v[108:111], v[68:71], v[32:35], 0
    ds_read_b64_tr_b16 v[84:85], v15 offset:0
    buffer_load_dwordx4 v7, s[12:15], s50 offen offset:1024 lds
    v_mfma_f32_16x16x32_bf16 v[128:131], v[68:71], v[36:39], 0
    ds_read_b64_tr_b16 v[86:87], v15 offset:1280
    v_mfma_f32_16x16x32_bf16 v[148:151], v[68:71], v[40:43], 0
    ds_read_b64_tr_b16 v[88:89], v15 offset:40
    buffer_load_dwordx4 v8, s[12:15], s50 offen offset:2048 lds
    v_mfma_f32_16x16x32_bf16 v[168:171], v[68:71], v[44:47], 0
    ds_read_b64_tr_b16 v[90:91], v15 offset:1320
    v_mfma_f32_16x16x32_bf16 v[112:115], v[72:75], v[32:35], 0
    ds_read_b64_tr_b16 v[92:93], v15 offset:80
    buffer_load_dwordx4 v9, s[12:15], s50 offen offset:3072 lds
    v_mfma_f32_16x16x32_bf16 v[132:135], v[72:75], v[36:39], 0
    ds_read_b64_tr_b16 v[94:95], v15 offset:1360
    v_mfma_f32_16x16x32_bf16 v[152:155], v[72:75], v[40:43], 0
    ds_read_b64_tr_b16 v[96:97], v15 offset:120
    s_add_u32 m0, s54, 4096
    v_mfma_f32_16x16x32_bf16 v[172:175], v[72:75], v[44:47], 0
    ds_read_b64_tr_b16 v[98:99], v15 offset:1400
    v_mfma_f32_16x16x32_bf16 v[116:119], v[76:79], v[32:35], 0
    ds_read_b64_tr_b16 v[100:101], v17 offset:0
    buffer_load_dwordx4 v10, s[12:15], s50 offen lds
    v_mfma_f32_16x16x32_bf16 v[136:139], v[76:79], v[36:39], 0
    ds_read_b64_tr_b16 v[102:103], v17 offset:1280
    s_add_u32 s51, s51, 1
    s_and_b32 s51, s51, 3
    v_mfma_f32_16x16x32_bf16 v[156:159], v[76:79], v[40:43], 0
    s_cselect_b32 s52, s57, s56
    v_add_u32 v12, s52, v12
    v_add_u32 v13, s52, v13
    v_mfma_f32_16x16x32_bf16 v[176:179], v[76:79], v[44:47], 0
    s_cmp_eq_u32 s51, 2
    v_add_u32 v14, s52, v14
    v_add_u32 v15, s52, v15
    v_mfma_f32_16x16x32_bf16 v[120:123], v[80:83], v[32:35], 0
    s_cselect_b32 s55, s56, s57
    v_add_u32 v16, s52, v16
    v_add_u32 v17, s52, v17
    v_mfma_f32_16x16x32_bf16 v[140:143], v[80:83], v[36:39], 0
    s_add_u32 s53, s53, s55
    s_add_u32 s54, s54, s55
    s_and_b32 s55, s58, 15
    v_mfma_f32_16x16x32_bf16 v[160:163], v[80:83], v[40:43], 0
    s_lshr_b64 s[58:59], s[58:59], 4
    s_lshl_b32 s49, s55, 7
    s_mul_i32 s50, s55, 245760
    v_mfma_f32_16x16x32_bf16 v[180:183], v[80:83], v[44:47], 0
    s_sub_u32 s48, s48, 1
.p2align 3
Lp1loop_15:
    s_waitcnt vmcnt(9) lgkmcnt(0)
    s_barrier
    v_mfma_f32_16x16x32_bf16 v[104:107], v[84:87], v[48:51], v[104:107]
    ds_read_b128 v[32:35], v12 offset:0
    s_mov_b32 m0, s53
    v_mfma_f32_16x16x32_bf16 v[124:127], v[84:87], v[52:55], v[124:127]
    ds_read_b128 v[36:39], v12 offset:2048
    v_mfma_f32_16x16x32_bf16 v[144:147], v[84:87], v[56:59], v[144:147]
    ds_read_b128 v[40:43], v12 offset:4096
    v_mfma_f32_16x16x32_bf16 v[164:167], v[84:87], v[60:63], v[164:167]
    ds_read_b128 v[44:47], v12 offset:6144
    v_mfma_f32_16x16x32_bf16 v[108:111], v[88:91], v[48:51], v[108:111]
    ds_read_b64_tr_b16 v[64:65], v14 offset:0
    buffer_load_dwordx4 v2, s[8:11], s49 offen offset:0 lds
    v_mfma_f32_16x16x32_bf16 v[128:131], v[88:91], v[52:55], v[128:131]
    ds_read_b64_tr_b16 v[66:67], v14 offset:1280
    v_mfma_f32_16x16x32_bf16 v[148:151], v[88:91], v[56:59], v[148:151]
    ds_read_b64_tr_b16 v[68:69], v14 offset:40
    v_mfma_f32_16x16x32_bf16 v[168:171], v[88:91], v[60:63], v[168:171]
    ds_read_b64_tr_b16 v[70:71], v14 offset:1320
    v_mfma_f32_16x16x32_bf16 v[112:115], v[92:95], v[48:51], v[112:115]
    ds_read_b64_tr_b16 v[72:73], v14 offset:80
    buffer_load_dwordx4 v3, s[8:11], s49 offen offset:1024 lds
    v_mfma_f32_16x16x32_bf16 v[132:135], v[92:95], v[52:55], v[132:135]
    ds_read_b64_tr_b16 v[74:75], v14 offset:1360
    v_mfma_f32_16x16x32_bf16 v[152:155], v[92:95], v[56:59], v[152:155]
    ds_read_b64_tr_b16 v[76:77], v14 offset:120
    v_mfma_f32_16x16x32_bf16 v[172:175], v[92:95], v[60:63], v[172:175]
    ds_read_b64_tr_b16 v[78:79], v14 offset:1400
    v_mfma_f32_16x16x32_bf16 v[116:119], v[96:99], v[48:51], v[116:119]
    ds_read_b64_tr_b16 v[80:81], v16 offset:0
    buffer_load_dwordx4 v4, s[8:11], s49 offen offset:2048 lds
    v_mfma_f32_16x16x32_bf16 v[136:139], v[96:99], v[52:55], v[136:139]
    ds_read_b64_tr_b16 v[82:83], v16 offset:1280
    v_mfma_f32_16x16x32_bf16 v[156:159], v[96:99], v[56:59], v[156:159]
    v_mfma_f32_16x16x32_bf16 v[176:179], v[96:99], v[60:63], v[176:179]
    v_mfma_f32_16x16x32_bf16 v[120:123], v[100:103], v[48:51], v[120:123]
    buffer_load_dwordx4 v5, s[8:11], s49 offen offset:3072 lds
    v_mfma_f32_16x16x32_bf16 v[140:143], v[100:103], v[52:55], v[140:143]
    v_mfma_f32_16x16x32_bf16 v[160:163], v[100:103], v[56:59], v[160:163]
    v_mfma_f32_16x16x32_bf16 v[180:183], v[100:103], v[60:63], v[180:183]
    s_waitcnt lgkmcnt(0)
    v_mfma_f32_16x16x32_bf16 v[104:107], v[64:67], v[32:35], v[104:107]
    ds_read_b128 v[48:51], v13 offset:0
    s_mov_b32 m0, s54
    v_mfma_f32_16x16x32_bf16 v[124:127], v[64:67], v[36:39], v[124:127]
    ds_read_b128 v[52:55], v13 offset:2048
    v_mfma_f32_16x16x32_bf16 v[144:147], v[64:67], v[40:43], v[144:147]
    ds_read_b128 v[56:59], v13 offset:4096
    buffer_load_dwordx4 v6, s[12:15], s50 offen offset:0 lds
    v_mfma_f32_16x16x32_bf16 v[164:167], v[64:67], v[44:47], v[164:167]
    ds_read_b128 v[60:63], v13 offset:6144
    v_mfma_f32_16x16x32_bf16 v[108:111], v[68:71], v[32:35], v[108:111]
    ds_read_b64_tr_b16 v[84:85], v15 offset:0
    buffer_load_dwordx4 v7, s[12:15], s50 offen offset:1024 lds
    v_mfma_f32_16x16x32_bf16 v[128:131], v[68:71], v[36:39], v[128:131]
    ds_read_b64_tr_b16 v[86:87], v15 offset:1280
    v_mfma_f32_16x16x32_bf16 v[148:151], v[68:71], v[40:43], v[148:151]
    ds_read_b64_tr_b16 v[88:89], v15 offset:40
    buffer_load_dwordx4 v8, s[12:15], s50 offen offset:2048 lds
    v_mfma_f32_16x16x32_bf16 v[168:171], v[68:71], v[44:47], v[168:171]
    ds_read_b64_tr_b16 v[90:91], v15 offset:1320
    v_mfma_f32_16x16x32_bf16 v[112:115], v[72:75], v[32:35], v[112:115]
    ds_read_b64_tr_b16 v[92:93], v15 offset:80
    buffer_load_dwordx4 v9, s[12:15], s50 offen offset:3072 lds
    v_mfma_f32_16x16x32_bf16 v[132:135], v[72:75], v[36:39], v[132:135]
    ds_read_b64_tr_b16 v[94:95], v15 offset:1360
    v_mfma_f32_16x16x32_bf16 v[152:155], v[72:75], v[40:43], v[152:155]
    ds_read_b64_tr_b16 v[96:97], v15 offset:120
    s_add_u32 m0, s54, 4096
    v_mfma_f32_16x16x32_bf16 v[172:175], v[72:75], v[44:47], v[172:175]
    ds_read_b64_tr_b16 v[98:99], v15 offset:1400
    v_mfma_f32_16x16x32_bf16 v[116:119], v[76:79], v[32:35], v[116:119]
    ds_read_b64_tr_b16 v[100:101], v17 offset:0
    buffer_load_dwordx4 v10, s[12:15], s50 offen lds
    v_mfma_f32_16x16x32_bf16 v[136:139], v[76:79], v[36:39], v[136:139]
    ds_read_b64_tr_b16 v[102:103], v17 offset:1280
    s_add_u32 s51, s51, 1
    s_and_b32 s51, s51, 3
    v_mfma_f32_16x16x32_bf16 v[156:159], v[76:79], v[40:43], v[156:159]
    s_cselect_b32 s52, s57, s56
    v_add_u32 v12, s52, v12
    v_add_u32 v13, s52, v13
    v_mfma_f32_16x16x32_bf16 v[176:179], v[76:79], v[44:47], v[176:179]
    s_cmp_eq_u32 s51, 2
    v_add_u32 v14, s52, v14
    v_add_u32 v15, s52, v15
    v_mfma_f32_16x16x32_bf16 v[120:123], v[80:83], v[32:35], v[120:123]
    s_cselect_b32 s55, s56, s57
    v_add_u32 v16, s52, v16
    v_add_u32 v17, s52, v17
    v_mfma_f32_16x16x32_bf16 v[140:143], v[80:83], v[36:39], v[140:143]
    s_add_u32 s53, s53, s55
    s_add_u32 s54, s54, s55
    s_and_b32 s55, s58, 15
    v_mfma_f32_16x16x32_bf16 v[160:163], v[80:83], v[40:43], v[160:163]
    s_lshr_b64 s[58:59], s[58:59], 4
    s_lshl_b32 s49, s55, 7
    s_mul_i32 s50, s55, 245760
    v_mfma_f32_16x16x32_bf16 v[180:183], v[80:83], v[44:47], v[180:183]
    s_sub_u32 s48, s48, 1
    s_cbranch_scc0 Lp1loop_15
    s_waitcnt vmcnt(9) lgkmcnt(0)
    s_barrier
    v_mov_b32 v30, 0
    global_load_dword v28, v30, s[20:21] offset:8 sc1
    v_mfma_f32_16x16x32_bf16 v[104:107], v[84:87], v[48:51], v[104:107]
    s_lshl_b32 s58, s44, 1
    ds_read_b128 v[32:35], v12 offset:0
    s_add_u32 s58, s58, s72
    v_mfma_f32_16x16x32_bf16 v[124:127], v[84:87], v[52:55], v[124:127]
    s_lshl_b32 s58, s58, 8
    ds_read_b128 v[36:39], v12 offset:2048
    s_add_u32 s58, s58, 262144
    v_mfma_f32_16x16x32_bf16 v[144:147], v[84:87], v[56:59], v[144:147]
    s_mul_i32 s59, s73, 160
    ds_read_b128 v[40:43], v12 offset:4096
    s_add_u32 s59, s59, s46
    v_mfma_f32_16x16x32_bf16 v[164:167], v[84:87], v[60:63], v[164:167]
    s_lshl_b32 s59, s59, 1
    ds_read_b128 v[44:47], v12 offset:6144
    s_add_u32 s59, s59, 294912
    v_mfma_f32_16x16x32_bf16 v[108:111], v[88:91], v[48:51], v[108:111]
    s_lshl_b32 s68, s22, 11
    ds_read_b64_tr_b16 v[64:65], v14 offset:0
    s_add_u32 s68, s68, 148480
    v_mfma_f32_16x16x32_bf16 v[128:131], v[88:91], v[52:55], v[128:131]
    ds_read_b64_tr_b16 v[66:67], v14 offset:1280
    v_lshlrev_b32_e64 v18, 2, v0
    v_mfma_f32_16x16x32_bf16 v[148:151], v[88:91], v[56:59], v[148:151]
    ds_read_b64_tr_b16 v[68:69], v14 offset:40
    v_and_b32_e64 v242, 15, v0
    v_mfma_f32_16x16x32_bf16 v[168:171], v[88:91], v[60:63], v[168:171]
    ds_read_b64_tr_b16 v[70:71], v14 offset:1320
    v_lshlrev_b32_e64 v242, 2, v242
    v_mfma_f32_16x16x32_bf16 v[112:115], v[92:95], v[48:51], v[112:115]
    ds_read_b64_tr_b16 v[72:73], v14 offset:80
    v_bfe_u32 v243, v0, 4, 1
    v_mfma_f32_16x16x32_bf16 v[132:135], v[92:95], v[52:55], v[132:135]
    ds_read_b64_tr_b16 v[74:75], v14 offset:1360
    v_mul_u32_u24 v243, 80, v243
    v_mfma_f32_16x16x32_bf16 v[152:155], v[92:95], v[56:59], v[152:155]
    ds_read_b64_tr_b16 v[76:77], v14 offset:120
    v_lshrrev_b32_e64 v244, 5, v0
    v_mfma_f32_16x16x32_bf16 v[172:175], v[92:95], v[60:63], v[172:175]
    ds_read_b64_tr_b16 v[78:79], v14 offset:1400
    v_mul_u32_u24 v244, 160, v244
    v_mfma_f32_16x16x32_bf16 v[116:119], v[96:99], v[48:51], v[116:119]
    ds_read_b64_tr_b16 v[80:81], v16 offset:0
    v_add3_u32 v19, v242, v243, v244
    v_mfma_f32_16x16x32_bf16 v[136:139], v[96:99], v[52:55], v[136:139]
    ds_read_b64_tr_b16 v[82:83], v16 offset:1280
    v_and_b32 v242, 3, v0
    v_mfma_f32_16x16x32_bf16 v[156:159], v[96:99], v[56:59], v[156:159]
    v_lshlrev_b32 v242, 2, v242
    v_bfe_u32 v243, v0, 2, 1
    v_mfma_f32_16x16x32_bf16 v[176:179], v[96:99], v[60:63], v[176:179]
    v_mul_u32_u24 v243, 80, v243
    v_bfe_u32 v244, v0, 3, 1
    v_mfma_f32_16x16x32_bf16 v[120:123], v[100:103], v[48:51], v[120:123]
    v_mul_u32_u24 v244, 160, v244
    v_add3_u32 v242, v242, v243, v244
    v_mfma_f32_16x16x32_bf16 v[140:143], v[100:103], v[52:55], v[140:143]
    v_bfe_u32 v243, v0, 4, 1
    v_mul_u32_u24 v243, 7680, v243
    v_mfma_f32_16x16x32_bf16 v[160:163], v[100:103], v[56:59], v[160:163]
    v_add3_u32 v20, v242, v243, 64
    v_and_b32_e64 v242, 15, v0
    v_mfma_f32_16x16x32_bf16 v[180:183], v[100:103], v[60:63], v[180:183]
    v_lshl_add_u32 v22, v242, 2, s68
    v_lshrrev_b32 v242, 4, v0
    s_waitcnt lgkmcnt(0)
    v_mov_b32_e64 v30, 0
    global_load_dword v29, v30, s[20:21] offset:8 sc1
    v_mfma_f32_16x16x32_bf16 v[104:107], v[64:67], v[32:35], v[104:107]
    ds_read_b128 v[48:51], v13 offset:0
    v_lshl_add_u32 v21, v242, 4, s68
    v_mfma_f32_16x16x32_bf16 v[124:127], v[64:67], v[36:39], v[124:127]
    s_mov_b32 s60, 901882528
    ds_read_b128 v[52:55], v13 offset:2048
    s_mov_b32 s62, 1060205080
    v_mfma_f32_16x16x32_bf16 v[144:147], v[64:67], v[40:43], v[144:147]
    ds_read_b128 v[56:59], v13 offset:4096
    v_lshlrev_b32 v23, 3, v0
    v_mfma_f32_16x16x32_bf16 v[164:167], v[64:67], v[44:47], v[164:167]
    s_lshl_b32 s55, s44, 3
    ds_read_b128 v[60:63], v13 offset:6144
    s_lshl_b32 s56, s72, 2
    v_mfma_f32_16x16x32_bf16 v[108:111], v[68:71], v[32:35], v[108:111]
    s_add_u32 s55, s55, s56
    ds_read_b64_tr_b16 v[84:85], v15 offset:0
    s_lshl_b32 s55, s55, 2
    v_mfma_f32_16x16x32_bf16 v[128:131], v[68:71], v[36:39], v[128:131]
    s_add_u32 s55, s55, s45
    ds_read_b64_tr_b16 v[86:87], v15 offset:1280
    s_sub_u32 s55, s55, 8
    v_mfma_f32_16x16x32_bf16 v[148:151], v[68:71], v[40:43], v[148:151]
    s_lshl_b32 s55, s55, 1
    ds_read_b64_tr_b16 v[88:89], v15 offset:40
    s_add_u32 s55, s55, s73
    v_mfma_f32_16x16x32_bf16 v[168:171], v[68:71], v[44:47], v[168:171]
    s_mul_i32 s55, s55, 2560
    ds_read_b64_tr_b16 v[90:91], v15 offset:1320
    s_add_u32 s55, s55, 2097152
    v_mfma_f32_16x16x32_bf16 v[112:115], v[72:75], v[32:35], v[112:115]
    ds_read_b64_tr_b16 v[92:93], v15 offset:80
    v_mfma_f32_16x16x32_bf16 v[132:135], v[72:75], v[36:39], v[132:135]
    ds_read_b64_tr_b16 v[94:95], v15 offset:1360
    v_mfma_f32_16x16x32_bf16 v[152:155], v[72:75], v[40:43], v[152:155]
    ds_read_b64_tr_b16 v[96:97], v15 offset:120
    v_mfma_f32_16x16x32_bf16 v[172:175], v[72:75], v[44:47], v[172:175]
    ds_read_b64_tr_b16 v[98:99], v15 offset:1400
    v_mfma_f32_16x16x32_bf16 v[116:119], v[76:79], v[32:35], v[116:119]
    ds_read_b64_tr_b16 v[100:101], v17 offset:0
    v_mfma_f32_16x16x32_bf16 v[136:139], v[76:79], v[36:39], v[136:139]
    ds_read_b64_tr_b16 v[102:103], v17 offset:1280
    v_mfma_f32_16x16x32_bf16 v[156:159], v[76:79], v[40:43], v[156:159]
    v_mfma_f32_16x16x32_bf16 v[176:179], v[76:79], v[44:47], v[176:179]
    v_mfma_f32_16x16x32_bf16 v[120:123], v[80:83], v[32:35], v[120:123]
    v_mfma_f32_16x16x32_bf16 v[140:143], v[80:83], v[36:39], v[140:143]
    v_mfma_f32_16x16x32_bf16 v[160:163], v[80:83], v[40:43], v[160:163]
    v_mfma_f32_16x16x32_bf16 v[180:183], v[80:83], v[44:47], v[180:183]
    s_nop 0
    v_add_u32 v12, 36992, v12
    v_add_u32 v13, 36992, v13
    v_add_u32 v14, 36992, v14
    v_add_u32 v15, 36992, v15
    v_add_u32 v16, 36992, v16
    v_add_u32 v17, 36992, v17
    s_waitcnt vmcnt(2) lgkmcnt(0)
    s_waitcnt vmcnt(1)
    v_readfirstlane_b32 s70, v28
    s_mov_b32 s69, 1048576
    s_cmp_ge_u32 s70, 1
    s_cbranch_scc1 Linitx_18
    s_waitcnt vmcnt(0)
    v_readfirstlane_b32 s70, v29
    s_cmp_ge_u32 s70, 1
    s_cbranch_scc1 Linitx_18
Linit_17:
    s_sub_u32 s69, s69, 1
    s_cbranch_scc1 Linitx_18
    s_sleep 6
    global_load_dword v28, v30, s[20:21] offset:8 sc1
    s_waitcnt vmcnt(0)
    v_readfirstlane_b32 s70, v28
    s_cmp_lt_u32 s70, 1
    s_cbranch_scc1 Linit_17
Linitx_18:
    s_barrier
    v_mfma_f32_16x16x32_bf16 v[104:107], v[84:87], v[48:51], v[104:107]
    ds_read_b128 v[32:35], v12 offset:0
    s_and_b32 s71, s23, 6
    s_lshl_b32 s71, s71, 8
    s_add_u32 s71, s71, 102400
    v_and_b32 v30, 1, v0
    v_lshl_add_u32 v30, v30, 8, s71
    buffer_load_dword v28, v30, s[4:7], 0 offen sc1
    v_mfma_f32_16x16x32_bf16 v[124:127], v[84:87], v[52:55], v[124:127]
    ds_read_b128 v[36:39], v12 offset:2048
    s_add_u32 m0, s68, 1280
    s_nop 0
    buffer_load_dword v20, s[4:7], s59 offen sc1 lds
    v_mfma_f32_16x16x32_bf16 v[144:147], v[84:87], v[56:59], v[144:147]
    ds_read_b128 v[40:43], v12 offset:4096
    s_add_u32 m0, s68, 768
    s_nop 0
    buffer_load_dword v19, s[4:7], s59 offen sc1 lds
    v_mfma_f32_16x16x32_bf16 v[164:167], v[84:87], v[60:63], v[164:167]
    ds_read_b128 v[44:47], v12 offset:6144
    s_add_u32 m0, s68, 1024
    s_add_u32 s59, s59, 7680
    buffer_load_dword v19, s[4:7], s59 offen sc1 lds
    v_mfma_f32_16x16x32_bf16 v[108:111], v[88:91], v[48:51], v[108:111]
    ds_read_b64_tr_b16 v[64:65], v14 offset:0
    s_add_u32 m0, s68, 0
    s_nop 0
    buffer_load_dword v18, s[4:7], s58 offen sc1 lds
    v_mfma_f32_16x16x32_bf16 v[128:131], v[88:91], v[52:55], v[128:131]
    ds_read_b64_tr_b16 v[66:67], v14 offset:1280
    s_add_u32 m0, s68, 256
    s_add_u32 s58, s58, 8192
    buffer_load_dword v18, s[4:7], s58 offen sc1 lds
    v_mfma_f32_16x16x32_bf16 v[148:151], v[88:91], v[56:59], v[148:151]
    ds_read_b64_tr_b16 v[68:69], v14 offset:40
    s_add_u32 m0, s68, 512
    s_add_u32 s58, s58, 8192
    buffer_load_dword v18, s[4:7], s58 offen sc1 lds
    v_mfma_f32_16x16x32_bf16 v[168:171], v[88:91], v[60:63], v[168:171]
    ds_read_b64_tr_b16 v[70:71], v14 offset:1320
    v_mfma_f32_16x16x32_bf16 v[112:115], v[92:95], v[48:51], v[112:115]
    ds_read_b64_tr_b16 v[72:73], v14 offset:80
    v_mfma_f32_16x16x32_bf16 v[132:135], v[92:95], v[52:55], v[132:135]
    ds_read_b64_tr_b16 v[74:75], v14 offset:1360
    v_mfma_f32_16x16x32_bf16 v[152:155], v[92:95], v[56:59], v[152:155]
    ds_read_b64_tr_b16 v[76:77], v14 offset:120
    v_mfma_f32_16x16x32_bf16 v[172:175], v[92:95], v[60:63], v[172:175]
    ds_read_b64_tr_b16 v[78:79], v14 offset:1400
    v_mfma_f32_16x16x32_bf16 v[116:119], v[96:99], v[48:51], v[116:119]
    ds_read_b64_tr_b16 v[80:81], v16 offset:0
    v_mfma_f32_16x16x32_bf16 v[136:139], v[96:99], v[52:55], v[136:139]
    ds_read_b64_tr_b16 v[82:83], v16 offset:1280
    v_mfma_f32_16x16x32_bf16 v[156:159], v[96:99], v[56:59], v[156:159]
    v_mfma_f32_16x16x32_bf16 v[176:179], v[96:99], v[60:63], v[176:179]
    v_mfma_f32_16x16x32_bf16 v[120:123], v[100:103], v[48:51], v[120:123]
    v_mfma_f32_16x16x32_bf16 v[140:143], v[100:103], v[52:55], v[140:143]
    v_mfma_f32_16x16x32_bf16 v[160:163], v[100:103], v[56:59], v[160:163]
    v_mfma_f32_16x16x32_bf16 v[180:183], v[100:103], v[60:63], v[180:183]
    s_waitcnt lgkmcnt(0)
    v_mfma_f32_16x16x32_bf16 v[104:107], v[64:67], v[32:35], v[104:107]
    ds_read_b128 v[48:51], v13 offset:0
    v_mfma_f32_16x16x32_bf16 v[124:127], v[64:67], v[36:39], v[124:127]
    ds_read_b128 v[52:55], v13 offset:2048
    v_mfma_f32_16x16x32_bf16 v[144:147], v[64:67], v[40:43], v[144:147]
    ds_read_b128 v[56:59], v13 offset:4096
    v_mfma_f32_16x16x32_bf16 v[164:167], v[64:67], v[44:47], v[164:167]
    ds_read_b128 v[60:63], v13 offset:6144
    v_mfma_f32_16x16x32_bf16 v[108:111], v[68:71], v[32:35], v[108:111]
    ds_read_b64_tr_b16 v[84:85], v15 offset:0
    v_mfma_f32_16x16x32_bf16 v[128:131], v[68:71], v[36:39], v[128:131]
    ds_read_b64_tr_b16 v[86:87], v15 offset:1280
    v_mfma_f32_16x16x32_bf16 v[148:151], v[68:71], v[40:43], v[148:151]
    ds_read_b64_tr_b16 v[88:89], v15 offset:40
    v_mfma_f32_16x16x32_bf16 v[168:171], v[68:71], v[44:47], v[168:171]
    ds_read_b64_tr_b16 v[90:91], v15 offset:1320
    v_mfma_f32_16x16x32_bf16 v[112:115], v[72:75], v[32:35], v[112:115]
    ds_read_b64_tr_b16 v[92:93], v15 offset:80
    v_mfma_f32_16x16x32_bf16 v[132:135], v[72:75], v[36:39], v[132:135]
    ds_read_b64_tr_b16 v[94:95], v15 offset:1360
    v_mfma_f32_16x16x32_bf16 v[152:155], v[72:75], v[40:43], v[152:155]
    ds_read_b64_tr_b16 v[96:97], v15 offset:120
    v_mfma_f32_16x16x32_bf16 v[172:175], v[72:75], v[44:47], v[172:175]
    ds_read_b64_tr_b16 v[98:99], v15 offset:1400
    v_mfma_f32_16x16x32_bf16 v[116:119], v[76:79], v[32:35], v[116:119]
    ds_read_b64_tr_b16 v[100:101], v17 offset:0
    v_mfma_f32_16x16x32_bf16 v[136:139], v[76:79], v[36:39], v[136:139]
    ds_read_b64_tr_b16 v[102:103], v17 offset:1280
    v_mfma_f32_16x16x32_bf16 v[156:159], v[76:79], v[40:43], v[156:159]
    v_mfma_f32_16x16x32_bf16 v[176:179], v[76:79], v[44:47], v[176:179]
    v_mfma_f32_16x16x32_bf16 v[120:123], v[80:83], v[32:35], v[120:123]
    v_mfma_f32_16x16x32_bf16 v[140:143], v[80:83], v[36:39], v[140:143]
    v_mfma_f32_16x16x32_bf16 v[160:163], v[80:83], v[40:43], v[160:163]
    v_mfma_f32_16x16x32_bf16 v[180:183], v[80:83], v[44:47], v[180:183]
    s_waitcnt lgkmcnt(0)
    s_waitcnt vmcnt(6)
    v_cmp_ne_u32 vcc, 1, v28
    s_mov_b32 s69, 1048576
    s_cbranch_vccz Lpollx_20
Lpoll_19:
    s_sleep 8
    buffer_load_dword v28, v30, s[4:7], 0 offen sc1
    s_sub_u32 s69, s69, 1
    s_waitcnt vmcnt(0)
    s_cbranch_scc1 Lpollx_20
    v_cmp_ne_u32 vcc, 1, v28
    s_cbranch_vccnz Lpoll_19
Lpollx_20:
    s_waitcnt vmcnt(0)
    s_barrier
    v_mfma_f32_16x16x32_bf16 v[104:107], v[84:87], v[48:51], v[104:107]
    ds_read_b128 v[184:187], v21 offset:768
    v_mfma_f32_16x16x32_bf16 v[124:127], v[84:87], v[52:55], v[124:127]
    ds_read_b128 v[188:191], v21 offset:832
    v_mfma_f32_16x16x32_bf16 v[144:147], v[84:87], v[56:59], v[144:147]
    ds_read_b128 v[192:195], v21 offset:896
    s_xor_b32 s53, s23, 0
    s_lshl_b32 s53, s53, 2
    s_add_u32 s53, s53, s22
    s_mul_i32 s53, s53, 25600
    s_add_u32 s53, s53, 1048576
    buffer_load_dwordx4 a[156:159], v1, s[4:7], s53 offen offset:0 sc1
    v_mfma_f32_16x16x32_bf16 v[164:167], v[84:87], v[60:63], v[164:167]
    ds_read_b128 v[196:199], v21 offset:960
    v_mfma_f32_16x16x32_bf16 v[108:111], v[88:91], v[48:51], v[108:111]
    ds_read_b128 v[200:203], v21 offset:1280
    v_mfma_f32_16x16x32_bf16 v[128:131], v[88:91], v[52:55], v[128:131]
    ds_read_b128 v[204:207], v21 offset:1024
    buffer_load_dwordx4 a[160:163], v1, s[4:7], s53 offen offset:1024 sc1
    v_mfma_f32_16x16x32_bf16 v[148:151], v[88:91], v[56:59], v[148:151]
    ds_read_b128 v[208:211], v21 offset:1088
    v_mfma_f32_16x16x32_bf16 v[168:171], v[88:91], v[60:63], v[168:171]
    ds_read_b128 v[212:215], v21 offset:1152
    v_mfma_f32_16x16x32_bf16 v[112:115], v[92:95], v[48:51], v[112:115]
    ds_read_b128 v[216:219], v21 offset:1216
    buffer_load_dwordx4 a[164:167], v1, s[4:7], s53 offen offset:2048 sc1
    v_mfma_f32_16x16x32_bf16 v[132:135], v[92:95], v[52:55], v[132:135]
    ds_read_b128 v[220:223], v21 offset:1344
    v_mfma_f32_16x16x32_bf16 v[152:155], v[92:95], v[56:59], v[152:155]
    ds_read2_b32 v[224:225], v22 offset0:0 offset1:16
    v_mfma_f32_16x16x32_bf16 v[172:175], v[92:95], v[60:63], v[172:175]
    ds_read2_b32 v[226:227], v22 offset0:32 offset1:48
    buffer_load_dwordx4 a[168:171], v1, s[4:7], s53 offen offset:3072 sc1
    v_mfma_f32_16x16x32_bf16 v[116:119], v[96:99], v[48:51], v[116:119]
    ds_read2_b32 v[232:233], v22 offset0:128 offset1:144
    v_mfma_f32_16x16x32_bf16 v[136:139], v[96:99], v[52:55], v[136:139]
    ds_read2_b32 v[234:235], v22 offset0:160 offset1:176
    v_mfma_f32_16x16x32_bf16 v[156:159], v[96:99], v[56:59], v[156:159]
    s_add_u32 s53, s53, 4096
    buffer_load_dwordx4 a[172:175], v1, s[4:7], s53 offen offset:0 sc1
    v_mfma_f32_16x16x32_bf16 v[176:179], v[96:99], v[60:63], v[176:179]
    v_mfma_f32_16x16x32_bf16 v[120:123], v[100:103], v[48:51], v[120:123]
    v_mfma_f32_16x16x32_bf16 v[140:143], v[100:103], v[52:55], v[140:143]
    buffer_load_dwordx4 a[176:179], v1, s[4:7], s53 offen offset:1024 sc1
    v_mfma_f32_16x16x32_bf16 v[160:163], v[100:103], v[56:59], v[160:163]
    v_mfma_f32_16x16x32_bf16 v[180:183], v[100:103], v[60:63], v[180:183]
    s_waitcnt lgkmcnt(0)
    s_nop 0
    v_pk_add_f32 v[184:185], v[184:185], v[204:205] op_sel:[0,0] op_sel_hi:[1,1]
    v_pk_add_f32 v[186:187], v[186:187], v[206:207] op_sel:[0,0] op_sel_hi:[1,1]
    v_pk_add_f32 v[188:189], v[188:189], v[208:209] op_sel:[0,0] op_sel_hi:[1,1]
    v_pk_add_f32 v[190:191], v[190:191], v[210:211] op_sel:[0,0] op_sel_hi:[1,1]
    v_pk_add_f32 v[192:193], v[192:193], v[212:213] op_sel:[0,0] op_sel_hi:[1,1]
    v_pk_add_f32 v[194:195], v[194:195], v[214:215] op_sel:[0,0] op_sel_hi:[1,1]
    v_pk_add_f32 v[196:197], v[196:197], v[216:217] op_sel:[0,0] op_sel_hi:[1,1]
    v_pk_add_f32 v[198:199], v[198:199], v[218:219] op_sel:[0,0] op_sel_hi:[1,1]
    v_pk_add_f32 v[200:201], v[200:201], v[220:221] op_sel:[0,0] op_sel_hi:[1,1]
    v_pk_add_f32 v[202:203], v[202:203], v[222:223] op_sel:[0,0] op_sel_hi:[1,1]
    v_pk_fma_f32 v[104:105], v[224:225], v[184:185], v[104:105] op_sel:[0,0,0] op_sel_hi:[0,1,1] neg_lo:[1,0,0] neg_hi:[1,0,0]
    v_pk_fma_f32 v[106:107], v[224:225], v[186:187], v[106:107] op_sel:[0,0,0] op_sel_hi:[0,1,1] neg_lo:[1,0,0] neg_hi:[1,0,0]
    v_pk_fma_f32 v[104:105], v[104:105], v[232:233], s[60:61] op_sel:[0,0,0] op_sel_hi:[1,0,0]
    v_pk_fma_f32 v[106:107], v[106:107], v[232:233], s[60:61] op_sel:[0,0,0] op_sel_hi:[1,0,0]
    v_exp_f32_e64 v242, v104 clamp
    v_exp_f32_e64 v243, v105 clamp
    v_exp_f32_e64 v244, v106 clamp
    v_exp_f32_e64 v245, v107 clamp
    v_max_f32 v104, s60, v104
    v_max_f32 v105, s60, v105
    v_max_f32 v106, s60, v106
    v_max_f32 v107, s60, v107
    v_pk_fma_f32 v[104:105], v[104:105], s[62:63], v[242:243] op_sel:[0,0,0] op_sel_hi:[1,0,1]
    v_pk_fma_f32 v[106:107], v[106:107], s[62:63], v[244:245] op_sel:[0,0,0] op_sel_hi:[1,0,1]
    v_cvt_pk_bf16_f32 v48, v104, v105
    v_cvt_pk_bf16_f32 v49, v106, v107
    buffer_load_dwordx4 a[180:183], v1, s[4:7], s53 offen offset:2048 sc1
    buffer_load_dwordx4 a[184:187], v1, s[4:7], s53 offen offset:3072 sc1
    v_pk_fma_f32 v[120:121], v[224:225], v[200:201], v[120:121] op_sel:[0,0,0] op_sel_hi:[0,1,1] neg_lo:[1,0,0] neg_hi:[1,0,0]
    v_pk_fma_f32 v[122:123], v[224:225], v[202:203], v[122:123] op_sel:[0,0,0] op_sel_hi:[0,1,1] neg_lo:[1,0,0] neg_hi:[1,0,0]
    v_pk_fma_f32 v[120:121], v[120:121], v[232:233], s[60:61] op_sel:[0,0,0] op_sel_hi:[1,0,0]
    v_pk_fma_f32 v[122:123], v[122:123], v[232:233], s[60:61] op_sel:[0,0,0] op_sel_hi:[1,0,0]
    v_exp_f32_e64 v242, v120 clamp
    v_exp_f32_e64 v243, v121 clamp
    v_exp_f32_e64 v244, v122 clamp
    v_exp_f32_e64 v245, v123 clamp
    v_max_f32 v120, s60, v120
    v_max_f32 v121, s60, v121
    v_max_f32 v122, s60, v122
    v_max_f32 v123, s60, v123
    v_pk_fma_f32 v[120:121], v[120:121], s[62:63], v[242:243] op_sel:[0,0,0] op_sel_hi:[1,0,1]
    v_pk_fma_f32 v[122:123], v[122:123], s[62:63], v[244:245] op_sel:[0,0,0] op_sel_hi:[1,0,1]
    v_cvt_pk_bf16_f32 v50, v120, v121
    v_cvt_pk_bf16_f32 v51, v122, v123
    buffer_store_dwordx4 v[48:51], v1, s[4:7], s55 offen offset:0 sc1
    v_pk_fma_f32 v[108:109], v[224:225], v[188:189], v[108:109] op_sel:[0,0,0] op_sel_hi:[0,1,1] neg_lo:[1,0,0] neg_hi:[1,0,0]
    v_pk_fma_f32 v[110:111], v[224:225], v[190:191], v[110:111] op_sel:[0,0,0] op_sel_hi:[0,1,1] neg_lo:[1,0,0] neg_hi:[1,0,0]
    v_pk_fma_f32 v[108:109], v[108:109], v[232:233], s[60:61] op_sel:[0,0,0] op_sel_hi:[1,0,0]
    v_pk_fma_f32 v[110:111], v[110:111], v[232:233], s[60:61] op_sel:[0,0,0] op_sel_hi:[1,0,0]
    v_exp_f32_e64 v242, v108 clamp
    v_exp_f32_e64 v243, v109 clamp
    v_exp_f32_e64 v244, v110 clamp
    v_exp_f32_e64 v245, v111 clamp
    v_max_f32 v108, s60, v108
    v_max_f32 v109, s60, v109
    v_max_f32 v110, s60, v110
    v_max_f32 v111, s60, v111
    v_pk_fma_f32 v[108:109], v[108:109], s[62:63], v[242:243] op_sel:[0,0,0] op_sel_hi:[1,0,1]
    v_pk_fma_f32 v[110:111], v[110:111], s[62:63], v[244:245] op_sel:[0,0,0] op_sel_hi:[1,0,1]
    v_cvt_pk_bf16_f32 v52, v108, v109
    v_cvt_pk_bf16_f32 v53, v110, v111
    v_pk_fma_f32 v[112:113], v[224:225], v[192:193], v[112:113] op_sel:[0,0,0] op_sel_hi:[0,1,1] neg_lo:[1,0,0] neg_hi:[1,0,0]
    v_pk_fma_f32 v[114:115], v[224:225], v[194:195], v[114:115] op_sel:[0,0,0] op_sel_hi:[0,1,1] neg_lo:[1,0,0] neg_hi:[1,0,0]
    v_pk_fma_f32 v[112:113], v[112:113], v[232:233], s[60:61] op_sel:[0,0,0] op_sel_hi:[1,0,0]
    v_pk_fma_f32 v[114:115], v[114:115], v[232:233], s[60:61] op_sel:[0,0,0] op_sel_hi:[1,0,0]
    v_exp_f32_e64 v242, v112 clamp
    v_exp_f32_e64 v243, v113 clamp
    v_exp_f32_e64 v244, v114 clamp
    v_exp_f32_e64 v245, v115 clamp
    v_max_f32 v112, s60, v112
    v_max_f32 v113, s60, v113
    v_max_f32 v114, s60, v114
    v_max_f32 v115, s60, v115
    v_pk_fma_f32 v[112:113], v[112:113], s[62:63], v[242:243] op_sel:[0,0,0] op_sel_hi:[1,0,1]
    v_pk_fma_f32 v[114:115], v[114:115], s[62:63], v[244:245] op_sel:[0,0,0] op_sel_hi:[1,0,1]
    v_cvt_pk_bf16_f32 v54, v112, v113
    v_cvt_pk_bf16_f32 v55, v114, v115
    buffer_store_dwordx4 v[52:55], v1, s[4:7], s55 offen offset:1024 sc1
    v_pk_fma_f32 v[116:117], v[224:225], v[196:197], v[116:117] op_sel:[0,0,0] op_sel_hi:[0,1,1] neg_lo:[1,0,0] neg_hi:[1,0,0]
    v_pk_fma_f32 v[118:119], v[224:225], v[198:199], v[118:119] op_sel:[0,0,0] op_sel_hi:[0,1,1] neg_lo:[1,0,0] neg_hi:[1,0,0]
    v_pk_fma_f32 v[116:117], v[116:117], v[232:233], s[60:61] op_sel:[0,0,0] op_sel_hi:[1,0,0]
    v_pk_fma_f32 v[118:119], v[118:119], v[232:233], s[60:61] op_sel:[0,0,0] op_sel_hi:[1,0,0]
    s_branch Lpg_q_1_go
.p2align 12
Lpg_q_1:
    s_setpc_b64 s[0:1]
.p2align 3
Lpg_q_1_go:
    v_exp_f32_e64 v242, v116 clamp
    v_exp_f32_e64 v243, v117 clamp
    v_exp_f32_e64 v244, v118 clamp
    v_exp_f32_e64 v245, v119 clamp
    v_max_f32 v116, s60, v116
    v_max_f32 v117, s60, v117
    v_max_f32 v118, s60, v118
    v_max_f32 v119, s60, v119
    v_pk_fma_f32 v[116:117], v[116:117], s[62:63], v[242:243] op_sel:[0,0,0] op_sel_hi:[1,0,1]
    v_pk_fma_f32 v[118:119], v[118:119], s[62:63], v[244:245] op_sel:[0,0,0] op_sel_hi:[1,0,1]
    v_cvt_pk_bf16_f32 v56, v116, v117
    v_cvt_pk_bf16_f32 v57, v118, v119
    buffer_store_dwordx2 v[56:57], v23, s[4:7], s55 offen offset:2048 sc1
    s_add_u32 s55, s55, 20480
    v_pk_fma_f32 v[124:125], v[224:225], v[184:185], v[124:125] op_sel:[1,0,0] op_sel_hi:[1,1,1] neg_lo:[1,0,0] neg_hi:[1,0,0]
    v_pk_fma_f32 v[126:127], v[224:225], v[186:187], v[126:127] op_sel:[1,0,0] op_sel_hi:[1,1,1] neg_lo:[1,0,0] neg_hi:[1,0,0]
    v_pk_fma_f32 v[124:125], v[124:125], v[232:233], s[60:61] op_sel:[0,1,0] op_sel_hi:[1,1,0]
    v_pk_fma_f32 v[126:127], v[126:127], v[232:233], s[60:61] op_sel:[0,1,0] op_sel_hi:[1,1,0]
    v_exp_f32_e64 v242, v124 clamp
    v_exp_f32_e64 v243, v125 clamp
    v_exp_f32_e64 v244, v126 clamp
    v_exp_f32_e64 v245, v127 clamp
    v_max_f32 v124, s60, v124
    v_max_f32 v125, s60, v125
    v_max_f32 v126, s60, v126
    v_max_f32 v127, s60, v127
    v_pk_fma_f32 v[124:125], v[124:125], s[62:63], v[242:243] op_sel:[0,0,0] op_sel_hi:[1,0,1]
    v_pk_fma_f32 v[126:127], v[126:127], s[62:63], v[244:245] op_sel:[0,0,0] op_sel_hi:[1,0,1]
    v_cvt_pk_bf16_f32 v60, v124, v125
    v_cvt_pk_bf16_f32 v61, v126, v127
    v_pk_fma_f32 v[140:141], v[224:225], v[200:201], v[140:141] op_sel:[1,0,0] op_sel_hi:[1,1,1] neg_lo:[1,0,0] neg_hi:[1,0,0]
    v_pk_fma_f32 v[142:143], v[224:225], v[202:203], v[142:143] op_sel:[1,0,0] op_sel_hi:[1,1,1] neg_lo:[1,0,0] neg_hi:[1,0,0]
    v_pk_fma_f32 v[140:141], v[140:141], v[232:233], s[60:61] op_sel:[0,1,0] op_sel_hi:[1,1,0]
    v_pk_fma_f32 v[142:143], v[142:143], v[232:233], s[60:61] op_sel:[0,1,0] op_sel_hi:[1,1,0]
    v_exp_f32_e64 v242, v140 clamp
    v_exp_f32_e64 v243, v141 clamp
    v_exp_f32_e64 v244, v142 clamp
    v_exp_f32_e64 v245, v143 clamp
    v_max_f32 v140, s60, v140
    v_max_f32 v141, s60, v141
    v_max_f32 v142, s60, v142
    v_max_f32 v143, s60, v143
    v_pk_fma_f32 v[140:141], v[140:141], s[62:63], v[242:243] op_sel:[0,0,0] op_sel_hi:[1,0,1]
    v_pk_fma_f32 v[142:143], v[142:143], s[62:63], v[244:245] op_sel:[0,0,0] op_sel_hi:[1,0,1]
    v_cvt_pk_bf16_f32 v62, v140, v141
    v_cvt_pk_bf16_f32 v63, v142, v143
    buffer_store_dwordx4 v[60:63], v1, s[4:7], s55 offen offset:0 sc1
    v_pk_fma_f32 v[128:129], v[224:225], v[188:189], v[128:129] op_sel:[1,0,0] op_sel_hi:[1,1,1] neg_lo:[1,0,0] neg_hi:[1,0,0]
    v_pk_fma_f32 v[130:131], v[224:225], v[190:191], v[130:131] op_sel:[1,0,0] op_sel_hi:[1,1,1] neg_lo:[1,0,0] neg_hi:[1,0,0]
    v_pk_fma_f32 v[128:129], v[128:129], v[232:233], s[60:61] op_sel:[0,1,0] op_sel_hi:[1,1,0]
    v_pk_fma_f32 v[130:131], v[130:131], v[232:233], s[60:61] op_sel:[0,1,0] op_sel_hi:[1,1,0]
    v_exp_f32_e64 v242, v128 clamp
    v_exp_f32_e64 v243, v129 clamp
    v_exp_f32_e64 v244, v130 clamp
    v_exp_f32_e64 v245, v131 clamp
    v_max_f32 v128, s60, v128
    v_max_f32 v129, s60, v129
    v_max_f32 v130, s60, v130
    v_max_f32 v131, s60, v131
    v_pk_fma_f32 v[128:129], v[128:129], s[62:63], v[242:243] op_sel:[0,0,0] op_sel_hi:[1,0,1]
    v_pk_fma_f32 v[130:131], v[130:131], s[62:63], v[244:245] op_sel:[0,0,0] op_sel_hi:[1,0,1]
    v_cvt_pk_bf16_f32 v64, v128, v129
    v_cvt_pk_bf16_f32 v65, v130, v131
    v_pk_fma_f32 v[132:133], v[224:225], v[192:193], v[132:133] op_sel:[1,0,0] op_sel_hi:[1,1,1] neg_lo:[1,0,0] neg_hi:[1,0,0]
    v_pk_fma_f32 v[134:135], v[224:225], v[194:195], v[134:135] op_sel:[1,0,0] op_sel_hi:[1,1,1] neg_lo:[1,0,0] neg_hi:[1,0,0]
    v_pk_fma_f32 v[132:133], v[132:133], v[232:233], s[60:61] op_sel:[0,1,0] op_sel_hi:[1,1,0]
    v_pk_fma_f32 v[134:135], v[134:135], v[232:233], s[60:61] op_sel:[0,1,0] op_sel_hi:[1,1,0]
    v_exp_f32_e64 v242, v132 clamp
    v_exp_f32_e64 v243, v133 clamp
    v_exp_f32_e64 v244, v134 clamp
    v_exp_f32_e64 v245, v135 clamp
    v_max_f32 v132, s60, v132
    v_max_f32 v133, s60, v133
    v_max_f32 v134, s60, v134
    v_max_f32 v135, s60, v135
    v_pk_fma_f32 v[132:133], v[132:133], s[62:63], v[242:243] op_sel:[0,0,0] op_sel_hi:[1,0,1]
    v_pk_fma_f32 v[134:135], v[134:135], s[62:63], v[244:245] op_sel:[0,0,0] op_sel_hi:[1,0,1]
    v_cvt_pk_bf16_f32 v66, v132, v133
    v_cvt_pk_bf16_f32 v67, v134, v135
    buffer_store_dwordx4 v[64:67], v1, s[4:7], s55 offen offset:1024 sc1
    v_pk_fma_f32 v[136:137], v[224:225], v[196:197], v[136:137] op_sel:[1,0,0] op_sel_hi:[1,1,1] neg_lo:[1,0,0] neg_hi:[1,0,0]
    v_pk_fma_f32 v[138:139], v[224:225], v[198:199], v[138:139] op_sel:[1,0,0] op_sel_hi:[1,1,1] neg_lo:[1,0,0] neg_hi:[1,0,0]
    v_pk_fma_f32 v[136:137], v[136:137], v[232:233], s[60:61] op_sel:[0,1,0] op_sel_hi:[1,1,0]
    v_pk_fma_f32 v[138:139], v[138:139], v[232:233], s[60:61] op_sel:[0,1,0] op_sel_hi:[1,1,0]
    v_exp_f32_e64 v242, v136 clamp
    v_exp_f32_e64 v243, v137 clamp
    v_exp_f32_e64 v244, v138 clamp
    v_exp_f32_e64 v245, v139 clamp
    v_max_f32 v136, s60, v136
    v_max_f32 v137, s60, v137
    v_max_f32 v138, s60, v138
    v_max_f32 v139, s60, v139
    v_pk_fma_f32 v[136:137], v[136:137], s[62:63], v[242:243] op_sel:[0,0,0] op_sel_hi:[1,0,1]
    v_pk_fma_f32 v[138:139], v[138:139], s[62:63], v[244:245] op_sel:[0,0,0] op_sel_hi:[1,0,1]
    v_cvt_pk_bf16_f32 v68, v136, v137
    v_cvt_pk_bf16_f32 v69, v138, v139
    buffer_store_dwordx2 v[68:69], v23, s[4:7], s55 offen offset:2048 sc1
    s_add_u32 s55, s55, 20480
    v_pk_fma_f32 v[144:145], v[226:227], v[184:185], v[144:145] op_sel:[0,0,0] op_sel_hi:[0,1,1] neg_lo:[1,0,0] neg_hi:[1,0,0]
    v_pk_fma_f32 v[146:147], v[226:227], v[186:187], v[146:147] op_sel:[0,0,0] op_sel_hi:[0,1,1] neg_lo:[1,0,0] neg_hi:[1,0,0]
    v_pk_fma_f32 v[144:145], v[144:145], v[234:235], s[60:61] op_sel:[0,0,0] op_sel_hi:[1,0,0]
    v_pk_fma_f32 v[146:147], v[146:147], v[234:235], s[60:61] op_sel:[0,0,0] op_sel_hi:[1,0,0]
    v_exp_f32_e64 v242, v144 clamp
    v_exp_f32_e64 v243, v145 clamp
    v_exp_f32_e64 v244, v146 clamp
    v_exp_f32_e64 v245, v147 clamp
    v_max_f32 v144, s60, v144
    v_max_f32 v145, s60, v145
    v_max_f32 v146, s60, v146
    v_max_f32 v147, s60, v147
    v_pk_fma_f32 v[144:145], v[144:145], s[62:63], v[242:243] op_sel:[0,0,0] op_sel_hi:[1,0,1]
    v_pk_fma_f32 v[146:147], v[146:147], s[62:63], v[244:245] op_sel:[0,0,0] op_sel_hi:[1,0,1]
    v_cvt_pk_bf16_f32 v72, v144, v145
    v_cvt_pk_bf16_f32 v73, v146, v147
    v_pk_fma_f32 v[160:161], v[226:227], v[200:201], v[160:161] op_sel:[0,0,0] op_sel_hi:[0,1,1] neg_lo:[1,0,0] neg_hi:[1,0,0]
    v_pk_fma_f32 v[162:163], v[226:227], v[202:203], v[162:163] op_sel:[0,0,0] op_sel_hi:[0,1,1] neg_lo:[1,0,0] neg_hi:[1,0,0]
    v_pk_fma_f32 v[160:161], v[160:161], v[234:235], s[60:61] op_sel:[0,0,0] op_sel_hi:[1,0,0]
    v_pk_fma_f32 v[162:163], v[162:163], v[234:235], s[60:61] op_sel:[0,0,0] op_sel_hi:[1,0,0]
    v_exp_f32_e64 v242, v160 clamp
    v_exp_f32_e64 v243, v161 clamp
    v_exp_f32_e64 v244, v162 clamp
    v_exp_f32_e64 v245, v163 clamp
    v_max_f32 v160, s60, v160
    v_max_f32 v161, s60, v161
    v_max_f32 v162, s60, v162
    v_max_f32 v163, s60, v163
    v_pk_fma_f32 v[160:161], v[160:161], s[62:63], v[242:243] op_sel:[0,0,0] op_sel_hi:[1,0,1]
    v_pk_fma_f32 v[162:163], v[162:163], s[62:63], v[244:245] op_sel:[0,0,0] op_sel_hi:[1,0,1]
    v_cvt_pk_bf16_f32 v74, v160, v161
    v_cvt_pk_bf16_f32 v75, v162, v163
    buffer_store_dwordx4 v[72:75], v1, s[4:7], s55 offen offset:0 sc1
    v_pk_fma_f32 v[148:149], v[226:227], v[188:189], v[148:149] op_sel:[0,0,0] op_sel_hi:[0,1,1] neg_lo:[1,0,0] neg_hi:[1,0,0]
    v_pk_fma_f32 v[150:151], v[226:227], v[190:191], v[150:151] op_sel:[0,0,0] op_sel_hi:[0,1,1] neg_lo:[1,0,0] neg_hi:[1,0,0]
    v_pk_fma_f32 v[148:149], v[148:149], v[234:235], s[60:61] op_sel:[0,0,0] op_sel_hi:[1,0,0]
    v_pk_fma_f32 v[150:151], v[150:151], v[234:235], s[60:61] op_sel:[0,0,0] op_sel_hi:[1,0,0]
    v_exp_f32_e64 v242, v148 clamp
    v_exp_f32_e64 v243, v149 clamp
    v_exp_f32_e64 v244, v150 clamp
    v_exp_f32_e64 v245, v151 clamp
    v_max_f32 v148, s60, v148
    v_max_f32 v149, s60, v149
    v_max_f32 v150, s60, v150
    v_max_f32 v151, s60, v151
    v_pk_fma_f32 v[148:149], v[148:149], s[62:63], v[242:243] op_sel:[0,0,0] op_sel_hi:[1,0,1]
    v_pk_fma_f32 v[150:151], v[150:151], s[62:63], v[244:245] op_sel:[0,0,0] op_sel_hi:[1,0,1]
    v_cvt_pk_bf16_f32 v76, v148, v149
    v_cvt_pk_bf16_f32 v77, v150, v151
    v_pk_fma_f32 v[152:153], v[226:227], v[192:193], v[152:153] op_sel:[0,0,0] op_sel_hi:[0,1,1] neg_lo:[1,0,0] neg_hi:[1,0,0]
    v_pk_fma_f32 v[154:155], v[226:227], v[194:195], v[154:155] op_sel:[0,0,0] op_sel_hi:[0,1,1] neg_lo:[1,0,0] neg_hi:[1,0,0]
    v_pk_fma_f32 v[152:153], v[152:153], v[234:235], s[60:61] op_sel:[0,0,0] op_sel_hi:[1,0,0]
    v_pk_fma_f32 v[154:155], v[154:155], v[234:235], s[60:61] op_sel:[0,0,0] op_sel_hi:[1,0,0]
    v_exp_f32_e64 v242, v152 clamp
    v_exp_f32_e64 v243, v153 clamp
    v_exp_f32_e64 v244, v154 clamp
    v_exp_f32_e64 v245, v155 clamp
    v_max_f32 v152, s60, v152
    v_max_f32 v153, s60, v153
    v_max_f32 v154, s60, v154
    v_max_f32 v155, s60, v155
    v_pk_fma_f32 v[152:153], v[152:153], s[62:63], v[242:243] op_sel:[0,0,0] op_sel_hi:[1,0,1]
    v_pk_fma_f32 v[154:155], v[154:155], s[62:63], v[244:245] op_sel:[0,0,0] op_sel_hi:[1,0,1]
    v_cvt_pk_bf16_f32 v78, v152, v153
    v_cvt_pk_bf16_f32 v79, v154, v155
    buffer_store_dwordx4 v[76:79], v1, s[4:7], s55 offen offset:1024 sc1
    v_pk_fma_f32 v[156:157], v[226:227], v[196:197], v[156:157] op_sel:[0,0,0] op_sel_hi:[0,1,1] neg_lo:[1,0,0] neg_hi:[1,0,0]
    v_pk_fma_f32 v[158:159], v[226:227], v[198:199], v[158:159] op_sel:[0,0,0] op_sel_hi:[0,1,1] neg_lo:[1,0,0] neg_hi:[1,0,0]
    v_pk_fma_f32 v[156:157], v[156:157], v[234:235], s[60:61] op_sel:[0,0,0] op_sel_hi:[1,0,0]
    v_pk_fma_f32 v[158:159], v[158:159], v[234:235], s[60:61] op_sel:[0,0,0] op_sel_hi:[1,0,0]
    v_exp_f32_e64 v242, v156 clamp
    v_exp_f32_e64 v243, v157 clamp
    v_exp_f32_e64 v244, v158 clamp
    v_exp_f32_e64 v245, v159 clamp
    v_max_f32 v156, s60, v156
    v_max_f32 v157, s60, v157
    v_max_f32 v158, s60, v158
    v_max_f32 v159, s60, v159
    v_pk_fma_f32 v[156:157], v[156:157], s[62:63], v[242:243] op_sel:[0,0,0] op_sel_hi:[1,0,1]
    v_pk_fma_f32 v[158:159], v[158:159], s[62:63], v[244:245] op_sel:[0,0,0] op_sel_hi:[1,0,1]
    v_cvt_pk_bf16_f32 v80, v156, v157
    v_cvt_pk_bf16_f32 v81, v158, v159
    buffer_store_dwordx2 v[80:81], v23, s[4:7], s55 offen offset:2048 sc1
    s_add_u32 s55, s55, 20480
    v_pk_fma_f32 v[164:165], v[226:227], v[184:185], v[164:165] op_sel:[1,0,0] op_sel_hi:[1,1,1] neg_lo:[1,0,0] neg_hi:[1,0,0]
    v_pk_fma_f32 v[166:167], v[226:227], v[186:187], v[166:167] op_sel:[1,0,0] op_sel_hi:[1,1,1] neg_lo:[1,0,0] neg_hi:[1,0,0]
    v_pk_fma_f32 v[164:165], v[164:165], v[234:235], s[60:61] op_sel:[0,1,0] op_sel_hi:[1,1,0]
    v_pk_fma_f32 v[166:167], v[166:167], v[234:235], s[60:61] op_sel:[0,1,0] op_sel_hi:[1,1,0]
    v_exp_f32_e64 v242, v164 clamp
    v_exp_f32_e64 v243, v165 clamp
    v_exp_f32_e64 v244, v166 clamp
    v_exp_f32_e64 v245, v167 clamp
    v_max_f32 v164, s60, v164
    v_max_f32 v165, s60, v165
    v_max_f32 v166, s60, v166
    v_max_f32 v167, s60, v167
    v_pk_fma_f32 v[164:165], v[164:165], s[62:63], v[242:243] op_sel:[0,0,0] op_sel_hi:[1,0,1]
    v_pk_fma_f32 v[166:167], v[166:167], s[62:63], v[244:245] op_sel:[0,0,0] op_sel_hi:[1,0,1]
    v_cvt_pk_bf16_f32 v84, v164, v165
    v_cvt_pk_bf16_f32 v85, v166, v167
    v_pk_fma_f32 v[180:181], v[226:227], v[200:201], v[180:181] op_sel:[1,0,0] op_sel_hi:[1,1,1] neg_lo:[1,0,0] neg_hi:[1,0,0]
    v_pk_fma_f32 v[182:183], v[226:227], v[202:203], v[182:183] op_sel:[1,0,0] op_sel_hi:[1,1,1] neg_lo:[1,0,0] neg_hi:[1,0,0]
    v_pk_fma_f32 v[180:181], v[180:181], v[234:235], s[60:61] op_sel:[0,1,0] op_sel_hi:[1,1,0]
    v_pk_fma_f32 v[182:183], v[182:183], v[234:235], s[60:61] op_sel:[0,1,0] op_sel_hi:[1,1,0]
    v_exp_f32_e64 v242, v180 clamp
    v_exp_f32_e64 v243, v181 clamp
    v_exp_f32_e64 v244, v182 clamp
    v_exp_f32_e64 v245, v183 clamp
    v_max_f32 v180, s60, v180
    v_max_f32 v181, s60, v181
    v_max_f32 v182, s60, v182
    v_max_f32 v183, s60, v183
    v_pk_fma_f32 v[180:181], v[180:181], s[62:63], v[242:243] op_sel:[0,0,0] op_sel_hi:[1,0,1]
    v_pk_fma_f32 v[182:183], v[182:183], s[62:63], v[244:245] op_sel:[0,0,0] op_sel_hi:[1,0,1]
    v_cvt_pk_bf16_f32 v86, v180, v181
    v_cvt_pk_bf16_f32 v87, v182, v183
    buffer_store_dwordx4 v[84:87], v1, s[4:7], s55 offen offset:0 sc1
    v_pk_fma_f32 v[168:169], v[226:227], v[188:189], v[168:169] op_sel:[1,0,0] op_sel_hi:[1,1,1] neg_lo:[1,0,0] neg_hi:[1,0,0]
    v_pk_fma_f32 v[170:171], v[226:227], v[190:191], v[170:171] op_sel:[1,0,0] op_sel_hi:[1,1,1] neg_lo:[1,0,0] neg_hi:[1,0,0]
    v_pk_fma_f32 v[168:169], v[168:169], v[234:235], s[60:61] op_sel:[0,1,0] op_sel_hi:[1,1,0]
    v_pk_fma_f32 v[170:171], v[170:171], v[234:235], s[60:61] op_sel:[0,1,0] op_sel_hi:[1,1,0]
    v_exp_f32_e64 v242, v168 clamp
    v_exp_f32_e64 v243, v169 clamp
    v_exp_f32_e64 v244, v170 clamp
    v_exp_f32_e64 v245, v171 clamp
    v_max_f32 v168, s60, v168
    v_max_f32 v169, s60, v169
    v_max_f32 v170, s60, v170
    v_max_f32 v171, s60, v171
    v_pk_fma_f32 v[168:169], v[168:169], s[62:63], v[242:243] op_sel:[0,0,0] op_sel_hi:[1,0,1]
    v_pk_fma_f32 v[170:171], v[170:171], s[62:63], v[244:245] op_sel:[0,0,0] op_sel_hi:[1,0,1]
    v_cvt_pk_bf16_f32 v88, v168, v169
    v_cvt_pk_bf16_f32 v89, v170, v171
    v_pk_fma_f32 v[172:173], v[226:227], v[192:193], v[172:173] op_sel:[1,0,0] op_sel_hi:[1,1,1] neg_lo:[1,0,0] neg_hi:[1,0,0]
    v_pk_fma_f32 v[174:175], v[226:227], v[194:195], v[174:175] op_sel:[1,0,0] op_sel_hi:[1,1,1] neg_lo:[1,0,0] neg_hi:[1,0,0]
    v_pk_fma_f32 v[172:173], v[172:173], v[234:235], s[60:61] op_sel:[0,1,0] op_sel_hi:[1,1,0]
    v_pk_fma_f32 v[174:175], v[174:175], v[234:235], s[60:61] op_sel:[0,1,0] op_sel_hi:[1,1,0]
    v_exp_f32_e64 v242, v172 clamp
    v_exp_f32_e64 v243, v173 clamp
    v_exp_f32_e64 v244, v174 clamp
    v_exp_f32_e64 v245, v175 clamp
    v_max_f32 v172, s60, v172
    v_max_f32 v173, s60, v173
    v_max_f32 v174, s60, v174
    v_max_f32 v175, s60, v175
    v_pk_fma_f32 v[172:173], v[172:173], s[62:63], v[242:243] op_sel:[0,0,0] op_sel_hi:[1,0,1]
    v_pk_fma_f32 v[174:175], v[174:175], s[62:63], v[244:245] op_sel:[0,0,0] op_sel_hi:[1,0,1]
    v_cvt_pk_bf16_f32 v90, v172, v173
    v_cvt_pk_bf16_f32 v91, v174, v175
    buffer_store_dwordx4 v[88:91], v1, s[4:7], s55 offen offset:1024 sc1
    v_pk_fma_f32 v[176:177], v[226:227], v[196:197], v[176:177] op_sel:[1,0,0] op_sel_hi:[1,1,1] neg_lo:[1,0,0] neg_hi:[1,0,0]
    v_pk_fma_f32 v[178:179], v[226:227], v[198:199], v[178:179] op_sel:[1,0,0] op_sel_hi:[1,1,1] neg_lo:[1,0,0] neg_hi:[1,0,0]
    v_pk_fma_f32 v[176:177], v[176:177], v[234:235], s[60:61] op_sel:[0,1,0] op_sel_hi:[1,1,0]
    v_pk_fma_f32 v[178:179], v[178:179], v[234:235], s[60:61] op_sel:[0,1,0] op_sel_hi:[1,1,0]
    v_exp_f32_e64 v242, v176 clamp
    v_exp_f32_e64 v243, v177 clamp
    v_exp_f32_e64 v244, v178 clamp
    v_exp_f32_e64 v245, v179 clamp
    v_max_f32 v176, s60, v176
    v_max_f32 v177, s60, v177
    v_max_f32 v178, s60, v178
    v_max_f32 v179, s60, v179
    v_pk_fma_f32 v[176:177], v[176:177], s[62:63], v[242:243] op_sel:[0,0,0] op_sel_hi:[1,0,1]
    v_pk_fma_f32 v[178:179], v[178:179], s[62:63], v[244:245] op_sel:[0,0,0] op_sel_hi:[1,0,1]
    v_cvt_pk_bf16_f32 v92, v176, v177
    v_cvt_pk_bf16_f32 v93, v178, v179
    buffer_store_dwordx2 v[92:93], v23, s[4:7], s55 offen offset:2048 sc1
    s_lshl_b32 s55, s44, 2
    s_add_u32 s55, s55, s45
    s_lshl_b32 s55, s55, 8
    s_add_u32 s55, s55, 79872
    s_add_u32 s53, s53, 4096
    buffer_load_dwordx4 a[188:191], v1, s[4:7], s53 offen offset:0 sc1
    buffer_load_dwordx4 a[192:195], v1, s[4:7], s53 offen offset:1024 sc1
    buffer_load_dwordx4 a[196:199], v1, s[4:7], s53 offen offset:2048 sc1
    s_cmp_lg_u32 s22, 3
    s_cbranch_scc1 Lwm_6
    s_call_b64 s[0:1], Lpg_join
Lwm_6:
    s_waitcnt vmcnt(3)
    s_barrier
    s_cmp_lg_u32 s22, 0
    s_cbranch_scc1 Lsig_21
    s_add_u32 s42, s4, s55
    s_addc_u32 s43, s5, 0
    s_mov_b32 s70, 1
    s_atomic_add s70, s[42:43], 0
Lsig_21:
    buffer_load_dwordx4 a[200:203], v1, s[4:7], s53 offen offset:3072 sc1
    s_add_u32 s53, s53, 4096
    buffer_load_dwordx4 a[204:207], v1, s[4:7], s53 offen offset:0 sc1
    buffer_load_dwordx4 a[208:211], v1, s[4:7], s53 offen offset:1024 sc1
    buffer_load_dwordx4 a[212:215], v1, s[4:7], s53 offen offset:2048 sc1
    buffer_load_dwordx4 a[216:219], v1, s[4:7], s53 offen offset:3072 sc1
    s_add_u32 s53, s53, 4096
    buffer_load_dwordx4 a[220:223], v1, s[4:7], s53 offen offset:0 sc1
    buffer_load_dwordx4 a[224:227], v1, s[4:7], s53 offen offset:1024 sc1
    buffer_load_dwordx4 a[228:231], v1, s[4:7], s53 offen offset:2048 sc1
    buffer_load_dwordx4 a[232:235], v1, s[4:7], s53 offen offset:3072 sc1
    s_add_u32 s53, s53, 4096
    buffer_load_dwordx4 a[236:239], v1, s[4:7], s53 offen offset:0 sc1
    buffer_load_dwordx4 a[240:243], v1, s[4:7], s53 offen offset:1024 sc1
    buffer_load_dwordx4 a[244:247], v1, s[4:7], s53 offen offset:2048 sc1
    buffer_load_dwordx4 a[248:251], v1, s[4:7], s53 offen offset:3072 sc1
    s_add_u32 s53, s53, 4096
    buffer_load_dwordx4 a[252:255], v1, s[4:7], s53 offen offset:0 sc1
    s_xor_b32 s53, s23, 1
    s_lshl_b32 s53, s53, 2
    s_add_u32 s53, s53, s22
    s_mul_i32 s53, s53, 25600
    s_add_u32 s53, s53, 1048576
    s_mul_i32 s52, s22, 25600
    s_add_u32 m0, s52, 0
    s_nop 0
    s_nop 0
    buffer_load_dwordx4 v1, s[4:7], s53 offen offset:0 sc1 lds
    buffer_load_dwordx4 v1, s[4:7], s53 offen offset:1024 sc1 lds
    buffer_load_dwordx4 v1, s[4:7], s53 offen offset:2048 sc1 lds
    buffer_load_dwordx4 v1, s[4:7], s53 offen offset:3072 sc1 lds
    s_add_u32 m0, s52, 4096
    s_add_u32 s53, s53, 4096
    buffer_load_dwordx4 v1, s[4:7], s53 offen offset:0 sc1 lds
    buffer_load_dwordx4 v1, s[4:7], s53 offen offset:1024 sc1 lds
    buffer_load_dwordx4 v1, s[4:7], s53 offen offset:2048 sc1 lds
    buffer_load_dwordx4 v1, s[4:7], s53 offen offset:3072 sc1 lds
    s_add_u32 m0, s52, 8192
    s_add_u32 s53, s53, 4096
    buffer_load_dwordx4 v1, s[4:7], s53 offen offset:0 sc1 lds
    buffer_load_dwordx4 v1, s[4:7], s53 offen offset:1024 sc1 lds
    buffer_load_dwordx4 v1, s[4:7], s53 offen offset:2048 sc1 lds
    buffer_load_dwordx4 v1, s[4:7], s53 offen offset:3072 sc1 lds
    s_add_u32 m0, s52, 12288
    s_add_u32 s53, s53, 4096
    buffer_load_dwordx4 v1, s[4:7], s53 offen offset:0 sc1 lds
    buffer_load_dwordx4 v1, s[4:7], s53 offen offset:1024 sc1 lds
    buffer_load_dwordx4 v1, s[4:7], s53 offen offset:2048 sc1 lds
    buffer_load_dwordx4 v1, s[4:7], s53 offen offset:3072 sc1 lds
    s_add_u32 m0, s52, 16384
    s_add_u32 s53, s53, 4096
    buffer_load_dwordx4 v1, s[4:7], s53 offen offset:0 sc1 lds
    s_lshl_b32 s71, s24, 2
    s_add_u32 s71, s71, s22
    s_lshl_b32 s71, s71, 8
    s_add_u32 s71, s71, 81920
    v_mov_b32 v246, s71
    buffer_load_dword v245, v246, s[4:7], 0 offen sc1
    buffer_load_dwordx4 v1, s[4:7], s53 offen offset:1024 sc1 lds
    buffer_load_dwordx4 v1, s[4:7], s53 offen offset:2048 sc1 lds
    buffer_load_dwordx4 v1, s[4:7], s53 offen offset:3072 sc1 lds
    s_add_u32 m0, s52, 20480
    s_add_u32 s53, s53, 4096
    buffer_load_dwordx4 v1, s[4:7], s53 offen offset:0 sc1 lds
    buffer_load_dwordx4 v1, s[4:7], s53 offen offset:1024 sc1 lds
    buffer_load_dwordx4 v1, s[4:7], s53 offen offset:2048 sc1 lds
    buffer_load_dwordx4 v1, s[4:7], s53 offen offset:3072 sc1 lds
    s_add_u32 m0, s52, 24576
    s_add_u32 s53, s53, 4096
    buffer_load_dwordx4 v1, s[4:7], s53 offen offset:0 sc1 lds
    s_branch Ljoin
.p2align 12
Lpg_h:
    s_setpc_b64 s[0:1]
.p2align 3
Lpg_h_go:
Lroleh_2:
    s_sub_u32 s48, s56, 25
    s_mov_b32 s45, s55
    s_getpc_b64 s[46:47]
Lpc:
    s_sub_u32 s46, s46, Lpc-sequential_preLN__linear_attn_block__glu_gated_swiglu__prompt_kernel
    s_subb_u32 s47, s47, 0
    s_add_u32 s50, s48, 1
    s_lshl_b32 s50, s50, 2
    s_add_u32 s50, s50, s22
    s_lshl_b32 s50, s50, 7
    v_min_u32 v1, 15, v0
    v_lshl_add_u32 v1, v1, 12, s50
    v_min_u32 v1, Lend-sequential_preLN__linear_attn_block__glu_gated_swiglu__prompt_kernel, v1
    s_mov_b64 exec, 0xffff
    global_load_dword v3, v1, s[46:47]
    s_mov_b64 exec, -1
    s_add_u32 s55, s48, 1
    s_lshl_b32 s56, s55, 2
    s_add_u32 s56, s56, s22
    s_lshl_b32 s57, s45, 5
    s_add_u32 s56, s56, s57
    s_lshl_b32 s58, s56, 5
    s_mul_i32 s53, s56, 10240
    s_lshr_b32 s56, s45, 1
    s_lshl_b32 s56, s56, 3
    s_add_u32 s55, s55, s56
    s_min_u32 s55, s55, 29
    s_lshr_b32 s56, s55, 1
    s_mul_i32 s57, s56, 52
    s_lshr_b32 s57, s57, 8
    s_mul_i32 s57, s57, 640
    s_lshl_b32 s56, s56, 7
    s_add_u32 s56, s56, s57
    s_and_b32 s57, s45, 1
    s_mul_i32 s57, s57, 640
    s_add_u32 s56, s56, s57
    s_and_b32 s55, s55, 1
    s_mul_i32 s51, s55, 7680
    s_lshl_b32 s57, s56, 1
    s_add_u32 s51, s51, s57
    s_add_u32 s51, s51, 294912
    s_lshl_b32 s55, s55, 2
    s_add_u32 s55, s55, s22
    s_mul_i32 s52, s55, 30720
    s_add_u32 s52, s52, s56
    v_lshrrev_b32 v238, 3, v0
    v_and_b32 v239, 7, v0
    v_lshlrev_b32 v240, 4, v239
    v_mul_u32_u24 v241, 1280, v238
    v_add_u32 v18, v241, v240
    v_mul_u32_u24 v241, 3840, v238
    v_add_u32 v19, v241, v240
    v_lshlrev_b32_e64 v1, 4, v0
    s_waitcnt lgkmcnt(0)
    s_mov_b32 s8, s24
    s_mov_b32 s9, s25
    s_mov_b32 s10, 2621440
    s_mov_b32 s11, 0x20000
    s_mov_b32 s4, s42
    s_mov_b32 s5, s43
    s_mov_b32 s6, 26214400
    s_mov_b32 s7, 0x20000
    s_mov_b32 s20, s40
    s_mov_b32 s21, s41
    s_mov_b32 s12, s26
    s_mov_b32 s13, s27
    s_mov_b32 s14, 2457600
    s_mov_b32 s15, 0x20000
    s_cmp_lg_u32 s48, 6
    s_cbranch_scc1 Lnz_23
    v_mov_b32 v224, 0
    v_mov_b32 v225, 0
    v_mov_b32 v226, 0
    v_mov_b32 v227, 0
    s_lshl_b32 s56, s45, 2
    s_add_u32 s56, s56, s22
    s_mul_i32 s55, s56, 2048
    s_add_u32 s55, s55, 23330816
    v_lshrrev_b32 v228, 4, v0
    v_mul_u32_u24 v228, 0, v228
    v_add_u32_e64 v228, v228, v1
    buffer_store_dwordx4 v[224:227], v228, s[4:7], s55 offen sc1
    s_add_u32 s55, s55, 1024
    buffer_store_dwordx4 v[224:227], v228, s[4:7], s55 offen sc1
    s_add_u32 s55, s55, 1024
    s_lshl_b32 s55, s56, 10
    s_add_u32 s55, s55, 327680
    buffer_store_dwordx4 v[224:227], v1, s[4:7], s55 offen sc1
    s_mul_i32 s55, s56, 2304
    s_add_u32 s55, s55, 65536
    v_lshlrev_b32 v228, 8, v0
    s_mov_b64 exec, 0x1ff
    buffer_store_dword v224, v228, s[4:7], s55 offen sc1
    s_mov_b64 exec, -1
Lnz_23:
    s_nop 0
    buffer_load_dwordx4 v[72:75], v18, s[8:11], s53 offen offset:256
    s_add_u32 s55, s52, 491520
    buffer_load_dwordx4 v[112:115], v19, s[12:15], s55 offen
    buffer_load_dwordx4 v[76:79], v18, s[8:11], s53 offen offset:384
    s_add_u32 s55, s52, 737280
    buffer_load_dwordx4 v[116:119], v19, s[12:15], s55 offen
    buffer_load_dwordx4 v[80:83], v18, s[8:11], s53 offen offset:512
    s_add_u32 s55, s52, 983040
    buffer_load_dwordx4 v[120:123], v19, s[12:15], s55 offen
    buffer_load_dwordx4 v[84:87], v18, s[8:11], s53 offen offset:640
    s_add_u32 s55, s52, 1228800
    buffer_load_dwordx4 v[124:127], v19, s[12:15], s55 offen
    s_cmp_lg_u32 s48, 6
    s_cbranch_scc1 Lnz_25
    s_waitcnt vmcnt(8)
    s_barrier
    s_cmp_lg_u32 s22, 0
    s_cbranch_scc1 Lda_26
    s_mov_b32 s70, 1
    s_atomic_add s70, s[20:21], 0
Lda_26:
Lnz_25:
    s_and_b32 s55, s2, 7
    s_lshr_b32 s56, s2, 3
    s_lshr_b32 s24, s55, 1
    s_lshl_b32 s24, s24, 2
    s_and_b32 s57, s56, 3
    s_add_u32 s24, s24, s57
    s_and_b32 s25, s55, 1
    s_lshl_b32 s25, s25, 3
    s_lshr_b32 s56, s56, 2
    s_add_u32 s25, s25, s56
    s_and_b32 s30, s25, 1
    s_lshr_b32 s31, s25, 1
    s_lshr_b32 s3, s25, 2
    s_and_b32 s23, s25, 3
    s_lshl_b32 s3, s3, 1
    s_and_b32 s55, s22, 1
    s_add_u32 s3, s3, s55
    s_lshl_b32 s23, s23, 1
    s_lshr_b32 s55, s22, 1
    s_add_u32 s23, s23, s55
    s_and_b32 s55, s2, 7
    s_lshr_b32 s56, s2, 3
    s_lshr_b32 s26, s55, 2
    s_lshl_b32 s26, s26, 3
    s_and_b32 s57, s56, 7
    s_add_u32 s26, s26, s57
    s_and_b32 s25, s55, 3
    s_lshl_b32 s25, s25, 2
    s_lshr_b32 s56, s56, 3
    s_add_u32 s25, s25, s56
    v_lshlrev_b32 v1, 4, v0
    v_lshrrev_b32 v20, 4, v0
    v_bfe_u32 v21, v0, 2, 2
    v_and_b32_e64 v22, 3, v0
    s_add_u32 s47, s48, 1
    s_lshl_b32 s44, s47, 1
    s_sub_u32 s56, s47, 4
    s_max_i32 s56, s56, 0
    s_add_u32 s44, s44, s56
    s_mul_i32 s50, s44, 98304
    s_mul_i32 s56, s45, 384
    s_add_u32 s50, s50, s56
    s_and_b32 s56, s22, 1
    s_mul_i32 s56, s56, 49152
    s_add_u32 s50, s50, s56
    s_mul_i32 s54, s22, 6144
    v_add_u32 v224, 0, v0
    v_mul_u32_u24 v225, 2731, v224
    v_lshrrev_b32 v225, 16, v225
    v_mul_u32_u24 v226, 24, v225
    v_sub_u32_e64 v226, v224, v226
    v_mul_u32_u24 v225, 3072, v225
    v_lshl_add_u32 v6, v226, 4, v225
    v_add_u32 v224, 64, v0
    v_mul_u32_u24 v225, 2731, v224
    v_lshrrev_b32 v225, 16, v225
    v_mul_u32_u24 v226, 24, v225
    v_sub_u32 v226, v224, v226
    v_mul_u32_u24 v225, 3072, v225
    v_lshl_add_u32 v7, v226, 4, v225
    v_subrev_u32 v7, 1024, v7
    v_add_u32 v224, 128, v0
    v_mul_u32_u24 v225, 2731, v224
    v_lshrrev_b32 v225, 16, v225
    v_mul_u32_u24 v226, 24, v225
    v_sub_u32_e64 v226, v224, v226
    v_mul_u32_u24 v225, 3072, v225
    v_lshl_add_u32 v8, v226, 4, v225
    v_subrev_u32 v8, 2048, v8
    v_lshl_add_u32 v224, v20, 3, v21
    v_mul_u32_u24 v224, 384, v224
    s_mul_i32 s56, s22, 96
    v_add_u32 v224, s56, v224
    v_lshrrev_b32 v225, 1, v22
    v_mul_u32_u24 v225, 12288, v225
    v_and_b32 v226, 1, v22
    v_lshlrev_b32 v226, 3, v226
    v_add3_u32 v26, v224, v225, v226
    v_add_u32 v27, 49152, v26
    v_bfe_u32 v224, v0, 1, 2
    v_bfe_u32 v225, v0, 3, 1
    v_and_b32 v226, 1, v0
    v_lshlrev_b32 v224, 2, v224
    v_lshl_add_u32 v224, v225, 1, v224
    v_add_u32 v224, v224, v226
    v_lshl_add_u32 v224, v20, 4, v224
    v_lshlrev_b32 v25, 4, v224
    s_mul_i32 s46, s45, 160
    s_mul_i32 s56, s22, 40
    s_add_u32 s46, s46, s56
    s_add_u32 s46, s46, s44
    s_nop 0
    s_mul_i32 s46, s46, 3072
    s_add_u32 s46, s46, 10485760
    buffer_load_dwordx4 v[88:91], v18, s[8:11], s53 offen offset:768
    s_add_u32 s55, s52, 1474560
    buffer_load_dwordx4 v[128:131], v19, s[12:15], s55 offen
    buffer_load_dwordx4 v[92:95], v18, s[8:11], s53 offen offset:896
    s_add_u32 s55, s52, 1720320
    buffer_load_dwordx4 v[132:135], v19, s[12:15], s55 offen
    buffer_load_dwordx4 v[96:99], v18, s[8:11], s53 offen offset:1024
    s_add_u32 s55, s52, 1966080
    buffer_load_dwordx4 v[136:139], v19, s[12:15], s55 offen
    buffer_load_dwordx4 v[100:103], v18, s[8:11], s53 offen offset:1152
    s_add_u32 s55, s52, 2211840
    buffer_load_dwordx4 v[140:143], v19, s[12:15], s55 offen
    buffer_load_dwordx4 v[64:67], v18, s[8:11], s53 offen offset:0
    s_add_u32 s55, s52, 0
    buffer_load_dwordx4 v[104:107], v19, s[12:15], s55 offen
    buffer_load_dwordx4 v[68:71], v18, s[8:11], s53 offen offset:128
    s_add_u32 s55, s52, 245760
    buffer_load_dwordx4 v[108:111], v19, s[12:15], s55 offen
    s_cmp_lg_u32 s22, 3
    s_cbranch_scc1 Lwm_7
    s_call_b64 s[0:1], Lpg_h_1
Lwm_7:
    s_cmp_lg_u32 s22, 2
    s_cbranch_scc1 Lwm_8
    s_call_b64 s[0:1], Lpg_hb
Lwm_8:
    s_cmp_lg_u32 s22, 1
    s_cbranch_scc1 Lwm_9
    s_call_b64 s[0:1], Lpg_hb_1
Lwm_9:
    s_cmp_lg_u32 s22, 0
    s_cbranch_scc1 Lwm_10
    s_call_b64 s[0:1], Lpg_join
Lwm_10:
    s_cmp_ge_u32 s47, 4
    s_cbranch_scc1 Lhb_22
    v_add_u32 v224, 0, v0
    v_mul_u32_u24 v225, 6554, v224
    v_lshrrev_b32 v225, 16, v225
    v_mul_u32_u24 v226, 10, v225
    v_sub_u32_e64 v226, v224, v226
    v_mul_u32_u24 v225, 1280, v225
    v_lshl_add_u32 v32, v226, 4, v225
    v_add_u32 v224, 64, v0
    v_mul_u32_u24 v225, 6554, v224
    v_lshrrev_b32 v225, 16, v225
    v_mul_u32_u24 v226, 10, v225
    v_sub_u32 v226, v224, v226
    v_mul_u32_u24 v225, 1280, v225
    v_lshl_add_u32 v33, v226, 4, v225
    v_subrev_u32 v33, 1024, v33
    v_add_u32 v224, 128, v0
    v_mul_u32_u24 v225, 6554, v224
    v_lshrrev_b32 v225, 16, v225
    v_mul_u32_u24 v226, 10, v225
    v_sub_u32_e64 v226, v224, v226
    v_mul_u32_u24 v225, 1280, v225
    v_lshl_add_u32 v34, v226, 4, v225
    v_subrev_u32 v34, 2048, v34
    v_add_u32 v224, 192, v0
    v_mul_u32_u24 v225, 6554, v224
    v_lshrrev_b32 v225, 16, v225
    v_mul_u32_u24 v226, 10, v225
    v_sub_u32_e64 v226, v224, v226
    v_mul_u32_u24 v225, 1280, v225
    v_lshl_add_u32 v35, v226, 4, v225
    v_subrev_u32 v35, 3072, v35
    v_add_u32 v224, 256, v0
    v_mul_u32_u24 v225, 6554, v224
    v_lshrrev_b32 v225, 16, v225
    v_mul_u32_u24 v226, 10, v225
    v_sub_u32_e64 v226, v224, v226
    v_mul_u32_u24 v225, 1280, v225
    v_lshl_add_u32 v36, v226, 4, v225
    s_lshl_b32 s56, s22, 6
    v_add_u32 v224, s56, v0
    v_mul_u32_u24 v225, 6554, v224
    v_lshrrev_b32 v225, 16, v225
    v_mul_u32_u24 v226, 10, v225
    v_sub_u32_e64 v226, v224, v226
    v_mul_u32_u24 v225, 1280, v225
    v_lshl_add_u32 v37, v226, 4, v225
    s_mov_b32 s12, s28
    s_mov_b32 s13, s29
    s_mov_b32 s14, 819200
    s_mov_b32 s15, 0x20000
    s_mul_i32 s49, s47, 204800
    s_mul_i32 s56, s45, 160
    s_add_u32 s49, s49, s56
    s_mul_i32 s55, s22, 40960
    s_add_u32 s55, s55, s49
    s_add_u32 s49, s49, 163840
    s_mul_i32 s56, s22, 5120
    s_add_u32 m0, s56, 102400
    s_nop 0
    buffer_load_dwordx4 v32, s[12:15], s55 offen offset:0 lds
    buffer_load_dwordx4 v33, s[12:15], s55 offen offset:1024 lds
    buffer_load_dwordx4 v34, s[12:15], s55 offen offset:2048 lds
    buffer_load_dwordx4 v35, s[12:15], s55 offen offset:3072 lds
    s_add_u32 m0, s56, 106496
    s_nop 0
    buffer_load_dwordx4 v36, s[12:15], s55 offen lds
    s_lshl_b32 s56, s22, 10
    s_add_u32 m0, s56, 122880
    s_nop 0
    buffer_load_dwordx4 v37, s[12:15], s49 offen lds
    s_mov_b32 m0, 126976
    s_nop 0
    buffer_load_dwordx4 v36, s[12:15], s49 offen lds
    s_mov_b32 s60, 1065369472
    s_mov_b32 s61, 0x3f80
    s_mov_b32 s62, 0x3f800000
    v_mov_b32 v144, 0
    v_mov_b32 v145, 0
    v_mov_b32 v146, 0
    v_mov_b32 v147, 0
    v_mov_b32 v148, 0
    v_mov_b32 v149, 0
    v_mov_b32 v150, 0
    v_mov_b32 v151, 0
    v_mov_b32 v152, 0
    v_mov_b32_e64 v153, 0
    s_lshl_b32 s57, s22, 11
    s_add_u32 s57, s57, 131072
    v_lshl_add_u32 v240, v0, 5, s57
    s_waitcnt vmcnt(25)
    v_dot2c_f32_bf16 v144, s61, v112
    v_dot2c_f32_bf16 v145, s62, v112
    v_dot2c_f32_bf16 v152, s60, v72
    v_dot2c_f32_bf16 v153, v72, v72
    v_dot2c_f32_bf16 v146, s61, v113
    v_dot2c_f32_bf16 v147, s62, v113
    v_dot2c_f32_bf16 v152, s60, v73
    v_dot2c_f32_bf16 v153, v73, v73
    v_dot2c_f32_bf16 v148, s61, v114
    v_dot2c_f32_bf16 v149, s62, v114
    v_dot2c_f32_bf16 v152, s60, v74
    v_dot2c_f32_bf16 v153, v74, v74
    v_dot2c_f32_bf16 v150, s61, v115
    v_dot2c_f32_bf16 v151, s62, v115
    v_dot2c_f32_bf16 v152, s60, v75
    v_dot2c_f32_bf16 v153, v75, v75
    s_waitcnt vmcnt(23)
    v_dot2c_f32_bf16 v144, s61, v116
    v_dot2c_f32_bf16 v145, s62, v116
    v_dot2c_f32_bf16 v152, s60, v76
    v_dot2c_f32_bf16 v153, v76, v76
    v_dot2c_f32_bf16 v146, s61, v117
    v_dot2c_f32_bf16 v147, s62, v117
    v_dot2c_f32_bf16 v152, s60, v77
    v_dot2c_f32_bf16 v153, v77, v77
    v_dot2c_f32_bf16 v148, s61, v118
    v_dot2c_f32_bf16 v149, s62, v118
    v_dot2c_f32_bf16 v152, s60, v78
    v_dot2c_f32_bf16 v153, v78, v78
    v_dot2c_f32_bf16 v150, s61, v119
    v_dot2c_f32_bf16 v151, s62, v119
    v_dot2c_f32_bf16 v152, s60, v79
    v_dot2c_f32_bf16 v153, v79, v79
    s_waitcnt vmcnt(21)
    v_dot2c_f32_bf16 v144, s61, v120
    v_dot2c_f32_bf16 v145, s62, v120
    v_dot2c_f32_bf16 v152, s60, v80
    v_dot2c_f32_bf16 v153, v80, v80
    v_dot2c_f32_bf16 v146, s61, v121
    v_dot2c_f32_bf16 v147, s62, v121
    v_dot2c_f32_bf16 v152, s60, v81
    v_dot2c_f32_bf16 v153, v81, v81
    v_dot2c_f32_bf16 v148, s61, v122
    v_dot2c_f32_bf16 v149, s62, v122
    v_dot2c_f32_bf16 v152, s60, v82
    v_dot2c_f32_bf16 v153, v82, v82
    v_dot2c_f32_bf16 v150, s61, v123
    v_dot2c_f32_bf16 v151, s62, v123
    v_dot2c_f32_bf16 v152, s60, v83
    v_dot2c_f32_bf16 v153, v83, v83
    s_waitcnt vmcnt(19)
    v_dot2c_f32_bf16 v144, s61, v124
    v_dot2c_f32_bf16 v145, s62, v124
    v_dot2c_f32_bf16 v152, s60, v84
    v_dot2c_f32_bf16 v153, v84, v84
    v_dot2c_f32_bf16 v146, s61, v125
    v_dot2c_f32_bf16 v147, s62, v125
    v_dot2c_f32_bf16 v152, s60, v85
    v_dot2c_f32_bf16 v153, v85, v85
    v_dot2c_f32_bf16 v148, s61, v126
    v_dot2c_f32_bf16 v149, s62, v126
    v_dot2c_f32_bf16 v152, s60, v86
    v_dot2c_f32_bf16 v153, v86, v86
    v_dot2c_f32_bf16 v150, s61, v127
    v_dot2c_f32_bf16 v151, s62, v127
    v_dot2c_f32_bf16 v152, s60, v87
    v_dot2c_f32_bf16 v153, v87, v87
    s_waitcnt vmcnt(17)
    v_dot2c_f32_bf16 v144, s61, v128
    v_dot2c_f32_bf16 v145, s62, v128
    v_dot2c_f32_bf16 v152, s60, v88
    v_dot2c_f32_bf16 v153, v88, v88
    v_dot2c_f32_bf16 v146, s61, v129
    v_dot2c_f32_bf16 v147, s62, v129
    v_dot2c_f32_bf16 v152, s60, v89
    v_dot2c_f32_bf16 v153, v89, v89
    v_dot2c_f32_bf16 v148, s61, v130
    v_dot2c_f32_bf16 v149, s62, v130
    v_dot2c_f32_bf16 v152, s60, v90
    v_dot2c_f32_bf16 v153, v90, v90
    v_dot2c_f32_bf16 v150, s61, v131
    v_dot2c_f32_bf16 v151, s62, v131
    v_dot2c_f32_bf16 v152, s60, v91
    v_dot2c_f32_bf16 v153, v91, v91
    s_waitcnt vmcnt(15)
    v_dot2c_f32_bf16 v144, s61, v132
    v_dot2c_f32_bf16 v145, s62, v132
    v_dot2c_f32_bf16 v152, s60, v92
    v_dot2c_f32_bf16 v153, v92, v92
    v_dot2c_f32_bf16 v146, s61, v133
    v_dot2c_f32_bf16 v147, s62, v133
    v_dot2c_f32_bf16 v152, s60, v93
    v_dot2c_f32_bf16 v153, v93, v93
    v_dot2c_f32_bf16 v148, s61, v134
    v_dot2c_f32_bf16 v149, s62, v134
    v_dot2c_f32_bf16 v152, s60, v94
    v_dot2c_f32_bf16 v153, v94, v94
    v_dot2c_f32_bf16 v150, s61, v135
    v_dot2c_f32_bf16 v151, s62, v135
    v_dot2c_f32_bf16 v152, s60, v95
    v_dot2c_f32_bf16 v153, v95, v95
    s_waitcnt vmcnt(13)
    v_dot2c_f32_bf16 v144, s61, v136
    v_dot2c_f32_bf16 v145, s62, v136
    v_dot2c_f32_bf16 v152, s60, v96
    v_dot2c_f32_bf16 v153, v96, v96
    v_dot2c_f32_bf16 v146, s61, v137
    v_dot2c_f32_bf16 v147, s62, v137
    v_dot2c_f32_bf16 v152, s60, v97
    v_dot2c_f32_bf16 v153, v97, v97
    v_dot2c_f32_bf16 v148, s61, v138
    v_dot2c_f32_bf16 v149, s62, v138
    v_dot2c_f32_bf16 v152, s60, v98
    v_dot2c_f32_bf16 v153, v98, v98
    v_dot2c_f32_bf16 v150, s61, v139
    v_dot2c_f32_bf16 v151, s62, v139
    v_dot2c_f32_bf16 v152, s60, v99
    v_dot2c_f32_bf16 v153, v99, v99
    s_waitcnt vmcnt(11)
    v_dot2c_f32_bf16 v144, s61, v140
    v_dot2c_f32_bf16 v145, s62, v140
    v_dot2c_f32_bf16 v152, s60, v100
    v_dot2c_f32_bf16 v153, v100, v100
    v_dot2c_f32_bf16 v146, s61, v141
    v_dot2c_f32_bf16 v147, s62, v141
    v_dot2c_f32_bf16 v152, s60, v101
    v_dot2c_f32_bf16 v153, v101, v101
    v_dot2c_f32_bf16 v148, s61, v142
    v_dot2c_f32_bf16 v149, s62, v142
    v_dot2c_f32_bf16 v152, s60, v102
    v_dot2c_f32_bf16 v153, v102, v102
    v_dot2c_f32_bf16 v150, s61, v143
    v_dot2c_f32_bf16 v151, s62, v143
    v_dot2c_f32_bf16 v152, s60, v103
    v_dot2c_f32_bf16 v153, v103, v103
    s_waitcnt vmcnt(9)
    v_dot2c_f32_bf16 v144, s61, v104
    v_dot2c_f32_bf16 v145, s62, v104
    v_dot2c_f32_bf16 v152, s60, v64
    v_dot2c_f32_bf16 v153, v64, v64
    v_dot2c_f32_bf16 v146, s61, v105
    v_dot2c_f32_bf16 v147, s62, v105
    v_dot2c_f32_bf16 v152, s60, v65
    v_dot2c_f32_bf16 v153, v65, v65
    v_dot2c_f32_bf16 v148, s61, v106
    v_dot2c_f32_bf16 v149, s62, v106
    v_dot2c_f32_bf16 v152, s60, v66
    v_dot2c_f32_bf16 v153, v66, v66
    v_dot2c_f32_bf16 v150, s61, v107
    v_dot2c_f32_bf16 v151, s62, v107
    v_dot2c_f32_bf16 v152, s60, v67
    v_dot2c_f32_bf16 v153, v67, v67
    s_waitcnt vmcnt(7)
    v_dot2c_f32_bf16 v144, s61, v108
    v_dot2c_f32_bf16 v145, s62, v108
    v_dot2c_f32_bf16 v152, s60, v68
    v_dot2c_f32_bf16 v153, v68, v68
    v_dot2c_f32_bf16 v146, s61, v109
    v_dot2c_f32_bf16 v147, s62, v109
    v_dot2c_f32_bf16 v152, s60, v69
    v_dot2c_f32_bf16 v153, v69, v69
    v_dot2c_f32_bf16 v148, s61, v110
    v_dot2c_f32_bf16 v149, s62, v110
    v_dot2c_f32_bf16 v152, s60, v70
    v_dot2c_f32_bf16 v153, v70, v70
    v_dot2c_f32_bf16 v150, s61, v111
    v_dot2c_f32_bf16 v151, s62, v111
    v_dot2c_f32_bf16 v152, s60, v71
    v_dot2c_f32_bf16 v153, v71, v71
    ds_write_b128 v240, v[144:147]
    ds_write_b128 v240, v[148:151] offset:16
    v_add_f32_dpp v152, v152, v152 quad_perm:[1,0,3,2] row_mask:0xf bank_mask:0xf
    v_add_f32_dpp v153, v153, v153 quad_perm:[1,0,3,2] row_mask:0xf bank_mask:0xf
    s_nop 0
    v_add_f32_dpp v152, v152, v152 quad_perm:[2,3,0,1] row_mask:0xf bank_mask:0xf
    v_add_f32_dpp v153, v153, v153 quad_perm:[2,3,0,1] row_mask:0xf bank_mask:0xf
    s_nop 0
    v_add_f32_dpp v152, v152, v152 row_half_mirror row_mask:0xf bank_mask:0xf
    v_add_f32_dpp v153, v153, v153 row_half_mirror row_mask:0xf bank_mask:0xf
    v_mul_f32 v152, 986500301, v152
    v_mul_f32 v153, 986500301, v153
    v_fma_f32 v153, -v152, v152, v153
    v_max_f32 v153, 0, v153
    v_add_f32 v153, 925353388, v153
    v_rsq_f32 v153, v153
    s_nop 0
    v_mul_f32 v241, 1069066811, v153
    v_cmp_eq_u32 vcc, 1, v239
    s_nop 1
    v_cndmask_b32 v152, v152, v153, vcc
    v_cmp_eq_u32 vcc, 2, v239
    s_nop 1
    v_cndmask_b32 v152, v152, v241, vcc
    v_lshlrev_b32 v238, 2, v238
    v_lshl_add_u32 v238, v239, 13, v238
    s_add_u32 s58, s58, 262144
    s_mov_b32 exec_lo, 0x07070707
    s_mov_b32 exec_hi, 0x07070707
    buffer_store_dword v152, v238, s[4:7], s58 offen sc1
    s_mov_b64 exec, -1
    v_and_b32 v238, 15, v0
    s_lshl_b32 s57, s22, 6
    v_lshl_add_u32 v238, v238, 2, s57
    v_lshrrev_b32 v239, 4, v0
    v_lshl_add_u32 v239, v239, 11, v238
    v_add_u32 v239, 131072, v239
    s_waitcnt lgkmcnt(0)
    s_barrier
    ds_read2st64_b32 v[144:145], v239 offset0:0 offset1:1
    ds_read2st64_b32 v[146:147], v239 offset0:2 offset1:3
    ds_read2st64_b32 v[148:149], v239 offset0:4 offset1:5
    ds_read2st64_b32 v[150:151], v239 offset0:6 offset1:7
    s_waitcnt lgkmcnt(0)
    v_add_f32 v144, v144, v145
    v_add_f32 v144, v144, v146
    v_add_f32 v144, v144, v147
    v_add_f32 v144, v144, v148
    v_add_f32 v144, v144, v149
    v_add_f32 v144, v144, v150
    v_add_f32 v144, v144, v151
    v_mov_b32 v145, v144
    s_nop 1
    v_permlane32_swap_b32 v144, v145
    v_add_f32 v144, v144, v145
    v_mov_b32 v145, v144
    s_nop 1
    v_permlane16_swap_b32 v144, v145
    v_add_f32 v144, v144, v145
    v_mov_b32_e64 v241, 0
    global_load_dword v240, v241, s[20:21] offset:0 sc1
    s_mov_b64 exec, 0xffff
    buffer_store_dword v144, v238, s[4:7], s51 offen sc1
    s_mov_b64 exec, -1
    v_lshlrev_b32 v227, 4, v22
    v_and_b32 v224, 1, v22
    v_lshrrev_b32 v225, 1, v22
    v_lshlrev_b32_e64 v224, 4, v224
    v_lshl_add_u32 v224, v225, 3, v224
    v_add_u32 v228, 128, v224
    v_lshl_add_u32 v224, v20, 2, v21
    v_mul_u32_u24 v224, 160, v224
    s_mul_i32 s56, s22, 6400
    s_add_u32 s56, s56, 102400
    v_add3_u32 v40, v224, v227, s56
    v_add3_u32 v41, v224, v228, s56
    v_mul_u32_u24_e64 v224, 20, v21
    v_add3_u32 v224, v224, v20, 16
    v_mul_u32_u24 v224, 160, v224
    v_add_u32 v224, 102400, v224
    s_lshr_b32 s56, s22, 1
    s_lshl_b32 s56, s56, 6
    s_and_b32 s55, s22, 1
    s_lshl_b32 s55, s55, 3
    s_add_u32 s56, s56, s55
    v_add3_u32 v42, v224, v227, s56
    v_add_u32 v43, v224, v228
    s_lshl_b32 s49, s45, 2
    s_add_u32 s49, s49, s47
    s_mul_i32 s49, s49, 25600
    s_add_u32 s49, s49, 1048576
    s_mul_i32 s55, s22, 5120
    s_add_u32 s55, s55, s49
    s_waitcnt vmcnt(3)
    s_barrier
    s_nop 0
    ds_read_b64_tr_b16 v[160:161], v40 offset:0
    ds_read_b64_tr_b16 v[162:163], v40 offset:3200
    ds_read_b64_tr_b16 v[164:165], v40 offset:8
    ds_read_b64_tr_b16 v[166:167], v40 offset:3208
    ds_read_b64_tr_b16 v[168:169], v40 offset:64
    ds_read_b64_tr_b16 v[170:171], v40 offset:3264
    ds_read_b64_tr_b16 v[172:173], v40 offset:72
    ds_read_b64_tr_b16 v[174:175], v40 offset:3272
    ds_read_b64_tr_b16 v[176:177], v41 offset:0
    ds_read_b64_tr_b16 v[178:179], v41 offset:3200
    ds_read_b64_tr_b16 v[180:181], v42 offset:0
    ds_read_b64_tr_b16 v[182:183], v42 offset:12800
    ds_read_b64_tr_b16 v[184:185], v43 offset:0
    ds_read_b64_tr_b16 v[186:187], v43 offset:12800
    s_waitcnt lgkmcnt(12)
    buffer_store_dwordx4 v[160:163], v1, s[4:7], s55 offen offset:0 sc1
    s_waitcnt lgkmcnt(10)
    buffer_store_dwordx4 v[164:167], v1, s[4:7], s55 offen offset:1024 sc1
    s_waitcnt lgkmcnt(8)
    buffer_store_dwordx4 v[168:171], v1, s[4:7], s55 offen offset:2048 sc1
    s_waitcnt lgkmcnt(6)
    buffer_store_dwordx4 v[172:175], v1, s[4:7], s55 offen offset:3072 sc1
    s_add_u32 s55, s55, 4096
    s_waitcnt lgkmcnt(4)
    buffer_store_dwordx4 v[176:179], v1, s[4:7], s55 offen offset:0 sc1
    s_lshl_b32 s55, s22, 10
    s_add_u32 s55, s55, s49
    s_add_u32 s55, s55, 20480
    s_waitcnt lgkmcnt(2)
    buffer_store_dwordx4 v[180:183], v1, s[4:7], s55 offen offset:0 sc1
    s_add_u32 s55, s49, 24576
    s_waitcnt lgkmcnt(0)
    buffer_store_dwordx4 v[184:187], v1, s[4:7], s55 offen offset:0 sc1
    s_waitcnt vmcnt(8)
    v_readfirstlane_b32 s70, v240
    s_mov_b32 s69, 1048576
    s_cmp_ge_u32 s70, 8
    s_cbranch_scc1 Linitx_28
Linit_27:
    s_sub_u32 s69, s69, 1
    s_cbranch_scc1 Linitx_28
    s_sleep 16
    global_load_dword v240, v241, s[20:21] offset:0 sc1
    s_waitcnt vmcnt(0)
    v_readfirstlane_b32 s70, v240
    s_cmp_lt_u32 s70, 8
    s_cbranch_scc1 Linit_27
Linitx_28:
    s_waitcnt vmcnt(7)
    s_barrier
    s_cmp_lg_u32 s22, 0
    s_cbranch_scc1 Lsig_29
    s_add_u32 s42, s4, 104448
    s_addc_u32 s43, s5, 0
    s_mov_b32 s70, 1
    s_atomic_add s70, s[42:43], 0 glc
    s_waitcnt lgkmcnt(0)
    s_cmp_lg_u32 s70, 63
    s_cbranch_scc1 Lsig_29
    s_mov_b32 s70, 1
    s_atomic_add s70, s[20:21], 8
Lsig_29:
    s_cmp_ge_u32 s22, 2
    s_cselect_b32 s12, s34, s32
    s_cselect_b32 s13, s35, s33
    s_mov_b32 s14, 1966080
    s_add_u32 m0, s54, 0
    s_nop 0
    buffer_load_dwordx4 v6, s[12:15], s50 offen offset:0 lds
    buffer_load_dwordx4 v7, s[12:15], s50 offen offset:1024 lds
    buffer_load_dwordx4 v8, s[12:15], s50 offen offset:2048 lds
    s_add_u32 s50, s50, 24576
    s_add_u32 m0, s54, 3072
    s_nop 0
    buffer_load_dwordx4 v6, s[12:15], s50 offen offset:0 lds
    buffer_load_dwordx4 v7, s[12:15], s50 offen offset:1024 lds
    buffer_load_dwordx4 v8, s[12:15], s50 offen offset:2048 lds
    s_add_u32 s50, s50, 73728
    s_waitcnt vmcnt(6)
    s_barrier
    s_lshl_b32 s55, s45, 8
    s_add_u32 s55, s55, 69632
    s_cmp_lg_u32 s22, 0
    s_cbranch_scc1 Lsig_30
    s_add_u32 s42, s4, s55
    s_addc_u32 s43, s5, 0
    s_mov_b32 s70, 1
    s_atomic_add s70, s[42:43], 0 glc
    s_waitcnt lgkmcnt(0)
    s_cmp_lg_u32 s70, 3
    s_cbranch_scc1 Lsig_30
    s_mov_b32 s70, 1
    s_atomic_add s70, s[42:43], 32768
Lsig_30:
    s_add_u32 m0, s54, 24576
    s_nop 0
    buffer_load_dwordx4 v6, s[12:15], s50 offen offset:0 lds
    buffer_load_dwordx4 v7, s[12:15], s50 offen offset:1024 lds
    buffer_load_dwordx4 v8, s[12:15], s50 offen offset:2048 lds
    s_add_u32 s50, s50, 24576
    s_add_u32 m0, s54, 27648
    s_nop 0
    buffer_load_dwordx4 v6, s[12:15], s50 offen offset:0 lds
    buffer_load_dwordx4 v7, s[12:15], s50 offen offset:1024 lds
    buffer_load_dwordx4 v8, s[12:15], s50 offen offset:2048 lds
    s_add_u32 s50, s50, 73728
    s_mov_b32 s12, s36
    s_mov_b32 s13, s37
    s_mov_b32 s14, 1966080
    s_mov_b32 s15, 0x20000
    s_lshr_b32 s49, s45, 1
    s_mul_i32 s49, s49, 12
    s_add_u32 s49, s49, s47
    s_sub_u32 s55, s47, 4
    s_max_i32 s55, s55, 0
    s_add_u32 s49, s49, s55
    s_lshl_b32 s55, s49, 2
    s_add_u32 s55, s55, s22
    s_mul_i32 s55, s55, 10240
    s_and_b32 s53, s45, 1
    s_mul_i32 s56, s53, 640
    s_add_u32 s55, s55, s56
    s_mul_i32 s56, s22, 5120
    v_add_u32 v224, 0, v0
    v_mul_u32_u24 v225, 1639, v224
    v_lshrrev_b32 v225, 16, v225
    v_mul_u32_u24 v226, 40, v225
    v_sub_u32 v226, v224, v226
    v_mul_u32_u24 v225, 1280, v225
    v_lshl_add_u32 v32, v226, 4, v225
    v_add_u32 v224, 64, v0
    v_mul_u32_u24 v225, 1639, v224
    v_lshrrev_b32 v225, 16, v225
    v_mul_u32_u24 v226, 40, v225
    v_sub_u32 v226, v224, v226
    v_mul_u32_u24 v225, 1280, v225
    v_lshl_add_u32 v33, v226, 4, v225
    v_subrev_u32 v33, 1024, v33
    v_add_u32 v224, 128, v0
    v_mul_u32_u24 v225, 1639, v224
    v_lshrrev_b32 v225, 16, v225
    v_mul_u32_u24 v226, 40, v225
    v_sub_u32_e64 v226, v224, v226
    v_mul_u32_u24 v225, 1280, v225
    v_lshl_add_u32 v34, v226, 4, v225
    v_subrev_u32 v34, 2048, v34
    v_add_u32 v224, 192, v0
    v_mul_u32_u24 v225, 1639, v224
    v_lshrrev_b32 v225, 16, v225
    v_mul_u32_u24 v226, 40, v225
    v_sub_u32_e64 v226, v224, v226
    v_mul_u32_u24 v225, 1280, v225
    v_lshl_add_u32 v35, v226, 4, v225
    v_subrev_u32 v35, 3072, v35
    v_add_u32 v224, 256, v0
    s_branch Lpg_h_1_go
.p2align 12
Lpg_h_1:
    s_setpc_b64 s[0:1]
.p2align 3
Lpg_h_1_go:
    v_mul_u32_u24 v225, 1639, v224
    v_lshrrev_b32 v225, 16, v225
    v_mul_u32_u24 v226, 40, v225
    v_sub_u32_e64 v226, v224, v226
    v_mul_u32_u24 v225, 1280, v225
    v_lshl_add_u32 v36, v226, 4, v225
    s_add_u32 m0, s56, 49152
    s_nop 0
    buffer_load_dwordx4 v32, s[12:15], s55 offen offset:0 lds
    buffer_load_dwordx4 v33, s[12:15], s55 offen offset:1024 lds
    buffer_load_dwordx4 v34, s[12:15], s55 offen offset:2048 lds
    buffer_load_dwordx4 v35, s[12:15], s55 offen offset:3072 lds
    s_add_u32 m0, s56, 53248
    s_nop 0
    buffer_load_dwordx4 v36, s[12:15], s55 offen offset:0 lds
    s_add_u32 s55, s55, 40960
    v_lshl_add_u32 v224, v20, 3, v21
    v_mul_u32_u24 v224, 640, v224
    s_mul_i32 s56, s22, 160
    s_add_u32 s56, s56, 49152
    v_add_u32 v224, s56, v224
    v_lshl_add_u32 v40, v22, 4, v224
    v_and_b32 v225, 1, v22
    v_lshl_add_u32 v224, v225, 4, v224
    v_lshrrev_b32_e64 v225, 1, v22
    v_lshl_add_u32 v224, v225, 3, v224
    v_add_u32 v41, 128, v224
    s_lshl_b32 s53, s53, 2
    s_add_u32 s53, s53, s22
    s_mul_i32 s56, s53, 48
    s_add_u32 s49, s49, s56
    s_mul_i32 s49, s49, 5120
    s_add_u32 s49, s49, 8388608
    s_waitcnt vmcnt(11)
    s_barrier
    ds_read_b64_tr_b16 v[64:65], v26 offset:0
    ds_read_b64_tr_b16 v[66:67], v26 offset:1536
    ds_read_b64_tr_b16 v[68:69], v26 offset:16
    ds_read_b64_tr_b16 v[70:71], v26 offset:1552
    ds_read_b64_tr_b16 v[72:73], v26 offset:32
    ds_read_b64_tr_b16 v[74:75], v26 offset:1568
    ds_read_b64_tr_b16 v[76:77], v26 offset:48
    ds_read_b64_tr_b16 v[78:79], v26 offset:1584
    ds_read_b64_tr_b16 v[80:81], v26 offset:64
    ds_read_b64_tr_b16 v[82:83], v26 offset:1600
    ds_read_b64_tr_b16 v[84:85], v26 offset:80
    ds_read_b64_tr_b16 v[86:87], v26 offset:1616
    s_waitcnt lgkmcnt(10)
    buffer_store_dwordx4 v[64:67], v25, s[4:7], s46 offen offset:0 sc1
    s_waitcnt lgkmcnt(8)
    buffer_store_dwordx4 v[68:71], v25, s[4:7], s46 offen offset:1024 sc1
    s_waitcnt lgkmcnt(6)
    buffer_store_dwordx4 v[72:75], v25, s[4:7], s46 offen offset:2048 sc1
    s_add_u32 s46, s46, 61440
    s_waitcnt lgkmcnt(4)
    buffer_store_dwordx4 v[76:79], v25, s[4:7], s46 offen offset:0 sc1
    s_waitcnt lgkmcnt(2)
    buffer_store_dwordx4 v[80:83], v25, s[4:7], s46 offen offset:1024 sc1
    s_waitcnt lgkmcnt(0)
    buffer_store_dwordx4 v[84:87], v25, s[4:7], s46 offen offset:2048 sc1
    v_mov_b32 v44, 1065369472
    v_mov_b32 v45, 1065369472
    v_mov_b32 v46, 1065369472
    v_mov_b32 v47, 1065369472
    s_nop 1
    v_mfma_f32_16x16x32_bf16 v[192:195], v[44:47], v[64:67], 0
    v_mfma_f32_16x16x32_bf16 v[196:199], v[44:47], v[68:71], 0
    v_mfma_f32_16x16x32_bf16 v[200:203], v[44:47], v[72:75], 0
    v_mfma_f32_16x16x32_bf16 v[204:207], v[44:47], v[76:79], 0
    v_mfma_f32_16x16x32_bf16 v[208:211], v[44:47], v[80:83], 0
    v_mfma_f32_16x16x32_bf16 v[212:215], v[44:47], v[84:87], 0
    s_waitcnt vmcnt(11)
    s_barrier
    s_nop 0
    ds_read_b64_tr_b16 v[88:89], v26 offset:24576
    ds_read_b64_tr_b16 v[90:91], v26 offset:26112
    ds_read_b64_tr_b16 v[92:93], v26 offset:24592
    ds_read_b64_tr_b16 v[94:95], v26 offset:26128
    ds_read_b64_tr_b16 v[96:97], v26 offset:24608
    ds_read_b64_tr_b16 v[98:99], v26 offset:26144
    ds_read_b64_tr_b16 v[100:101], v26 offset:24624
    ds_read_b64_tr_b16 v[102:103], v26 offset:26160
    ds_read_b64_tr_b16 v[104:105], v26 offset:24640
    ds_read_b64_tr_b16 v[106:107], v26 offset:26176
    ds_read_b64_tr_b16 v[108:109], v26 offset:24656
    ds_read_b64_tr_b16 v[110:111], v26 offset:26192
    s_sub_u32 s46, s46, 58368
    s_waitcnt lgkmcnt(10)
    buffer_store_dwordx4 v[88:91], v25, s[4:7], s46 offen offset:0 sc1
    s_waitcnt lgkmcnt(8)
    buffer_store_dwordx4 v[92:95], v25, s[4:7], s46 offen offset:1024 sc1
    s_waitcnt lgkmcnt(6)
    buffer_store_dwordx4 v[96:99], v25, s[4:7], s46 offen offset:2048 sc1
    s_add_u32 s46, s46, 61440
    s_waitcnt lgkmcnt(4)
    buffer_store_dwordx4 v[100:103], v25, s[4:7], s46 offen offset:0 sc1
    s_waitcnt lgkmcnt(2)
    buffer_store_dwordx4 v[104:107], v25, s[4:7], s46 offen offset:1024 sc1
    s_waitcnt lgkmcnt(0)
    buffer_store_dwordx4 v[108:111], v25, s[4:7], s46 offen offset:2048 sc1
    v_mfma_f32_16x16x32_bf16 v[192:195], v[44:47], v[88:91], v[192:195]
    v_mfma_f32_16x16x32_bf16 v[196:199], v[44:47], v[92:95], v[196:199]
    v_mfma_f32_16x16x32_bf16 v[200:203], v[44:47], v[96:99], v[200:203]
    v_mfma_f32_16x16x32_bf16 v[204:207], v[44:47], v[100:103], v[204:207]
    v_mfma_f32_16x16x32_bf16 v[208:211], v[44:47], v[104:107], v[208:211]
    v_mfma_f32_16x16x32_bf16 v[212:215], v[44:47], v[108:111], v[212:215]
    s_mov_b32 s60, 4294901760
    s_mov_b32 s61, 0
    s_nop 1
    v_cndmask_b32 v192, v192, v196, s[60:61]
    s_nop 2
    v_cndmask_b32 v208, v208, v212, s[60:61]
    s_mov_b32 s60, 0
    s_mov_b32 s61, 65535
    v_cndmask_b32 v192, v192, v200, s[60:61]
    s_mov_b32 s60, 0
    s_mov_b32 s61, 4294901760
    v_cndmask_b32 v192, v192, v204, s[60:61]
    s_lshl_b32 s55, s45, 2
    s_add_u32 s55, s55, s22
    s_mul_i32 s55, s55, 384
    s_add_u32 s55, s55, 327680
    v_lshrrev_b32 v224, 2, v25
    buffer_atomic_add_f32 v192, v224, s[4:7], s55 offen
    s_mov_b32 exec_hi, 0
    buffer_atomic_add_f32 v208, v224, s[4:7], s55 offen offset:256
    s_mov_b32 exec_hi, -1
    s_and_b32 s71, s23, 6
    s_lshl_b32 s71, s71, 8
    s_add_u32 s71, s71, 102400
    v_and_b32_e64 v233, 1, v0
    v_lshl_add_u32 v233, v233, 8, s71
    buffer_load_dword v232, v233, s[4:7], 0 offen sc1
    s_waitcnt vmcnt(15)
    s_barrier
    ds_read_b64_tr_b16 v[140:141], v40 offset:0
    ds_read_b64_tr_b16 v[142:143], v40 offset:2560
    ds_read_b64_tr_b16 v[144:145], v40 offset:8
    ds_read_b64_tr_b16 v[146:147], v40 offset:2568
    ds_read_b64_tr_b16 v[148:149], v40 offset:64
    ds_read_b64_tr_b16 v[150:151], v40 offset:2624
    ds_read_b64_tr_b16 v[152:153], v40 offset:72
    ds_read_b64_tr_b16 v[154:155], v40 offset:2632
    ds_read_b64_tr_b16 v[156:157], v41 offset:0
    ds_read_b64_tr_b16 v[158:159], v41 offset:2560
    s_waitcnt lgkmcnt(8)
    buffer_store_dwordx4 v[140:143], v1, s[4:7], s49 offen offset:0 sc1
    s_waitcnt lgkmcnt(6)
    buffer_store_dwordx4 v[144:147], v1, s[4:7], s49 offen offset:1024 sc1
    s_waitcnt lgkmcnt(4)
    buffer_store_dwordx4 v[148:151], v1, s[4:7], s49 offen offset:2048 sc1
    s_waitcnt lgkmcnt(2)
    buffer_store_dwordx4 v[152:155], v1, s[4:7], s49 offen offset:3072 sc1
    s_add_u32 s49, s49, 4096
    s_waitcnt lgkmcnt(0)
    buffer_store_dwordx4 v[156:159], v1, s[4:7], s49 offen offset:0 sc1
    s_mov_b32 s46, s53
    s_mov_b32 s47, 1
    s_waitcnt vmcnt(5)
    s_branch Lhfin_24
.p2align 12
Lpg_hb:
    s_setpc_b64 s[0:1]
.p2align 3
Lpg_hb_go:
Lhb_22:
    s_cmp_ge_u32 s22, 2
    s_cselect_b32 s12, s34, s32
    s_cselect_b32 s13, s35, s33
    s_mov_b32 s14, 1966080
    s_add_u32 m0, s54, 0
    s_nop 0
    buffer_load_dwordx4 v6, s[12:15], s50 offen offset:0 lds
    buffer_load_dwordx4 v7, s[12:15], s50 offen offset:1024 lds
    buffer_load_dwordx4 v8, s[12:15], s50 offen offset:2048 lds
    s_add_u32 s50, s50, 24576
    s_add_u32 m0, s54, 3072
    s_nop 0
    s_nop 0
    buffer_load_dwordx4 v6, s[12:15], s50 offen offset:0 lds
    buffer_load_dwordx4 v7, s[12:15], s50 offen offset:1024 lds
    buffer_load_dwordx4 v8, s[12:15], s50 offen offset:2048 lds
    s_add_u32 s50, s50, 73728
    s_mov_b32 s60, 1065369472
    s_mov_b32 s61, 0x3f80
    s_mov_b32 s62, 0x3f800000
    v_mov_b32 v144, 0
    v_mov_b32 v145, 0
    v_mov_b32 v146, 0
    v_mov_b32 v147, 0
    v_mov_b32 v148, 0
    v_mov_b32 v149, 0
    v_mov_b32 v150, 0
    v_mov_b32 v151, 0
    v_mov_b32 v152, 0
    v_mov_b32 v153, 0
    s_lshl_b32 s57, s22, 11
    s_add_u32 s57, s57, 131072
    v_lshl_add_u32 v240, v0, 5, s57
    s_waitcnt vmcnt(24)
    v_dot2c_f32_bf16 v144, s61, v112
    v_dot2c_f32_bf16 v145, s62, v112
    v_dot2c_f32_bf16 v152, s60, v72
    v_dot2c_f32_bf16 v153, v72, v72
    v_dot2c_f32_bf16 v146, s61, v113
    v_dot2c_f32_bf16 v147, s62, v113
    v_dot2c_f32_bf16 v152, s60, v73
    v_dot2c_f32_bf16 v153, v73, v73
    v_dot2c_f32_bf16 v148, s61, v114
    v_dot2c_f32_bf16 v149, s62, v114
    v_dot2c_f32_bf16 v152, s60, v74
    v_dot2c_f32_bf16 v153, v74, v74
    v_dot2c_f32_bf16 v150, s61, v115
    v_dot2c_f32_bf16 v151, s62, v115
    v_dot2c_f32_bf16 v152, s60, v75
    v_dot2c_f32_bf16 v153, v75, v75
    s_waitcnt vmcnt(22)
    v_dot2c_f32_bf16 v144, s61, v116
    v_dot2c_f32_bf16 v145, s62, v116
    v_dot2c_f32_bf16 v152, s60, v76
    v_dot2c_f32_bf16 v153, v76, v76
    v_dot2c_f32_bf16 v146, s61, v117
    v_dot2c_f32_bf16 v147, s62, v117
    v_dot2c_f32_bf16 v152, s60, v77
    v_dot2c_f32_bf16 v153, v77, v77
    v_dot2c_f32_bf16 v148, s61, v118
    v_dot2c_f32_bf16 v149, s62, v118
    v_dot2c_f32_bf16 v152, s60, v78
    v_dot2c_f32_bf16 v153, v78, v78
    v_dot2c_f32_bf16 v150, s61, v119
    v_dot2c_f32_bf16 v151, s62, v119
    v_dot2c_f32_bf16 v152, s60, v79
    v_dot2c_f32_bf16 v153, v79, v79
    s_waitcnt vmcnt(20)
    v_dot2c_f32_bf16 v144, s61, v120
    v_dot2c_f32_bf16 v145, s62, v120
    v_dot2c_f32_bf16 v152, s60, v80
    v_dot2c_f32_bf16 v153, v80, v80
    v_dot2c_f32_bf16 v146, s61, v121
    v_dot2c_f32_bf16 v147, s62, v121
    v_dot2c_f32_bf16 v152, s60, v81
    v_dot2c_f32_bf16 v153, v81, v81
    v_dot2c_f32_bf16 v148, s61, v122
    v_dot2c_f32_bf16 v149, s62, v122
    v_dot2c_f32_bf16 v152, s60, v82
    v_dot2c_f32_bf16 v153, v82, v82
    v_dot2c_f32_bf16 v150, s61, v123
    v_dot2c_f32_bf16 v151, s62, v123
    v_dot2c_f32_bf16 v152, s60, v83
    v_dot2c_f32_bf16 v153, v83, v83
    s_waitcnt vmcnt(18)
    v_dot2c_f32_bf16 v144, s61, v124
    v_dot2c_f32_bf16 v145, s62, v124
    v_dot2c_f32_bf16 v152, s60, v84
    v_dot2c_f32_bf16 v153, v84, v84
    v_dot2c_f32_bf16 v146, s61, v125
    v_dot2c_f32_bf16 v147, s62, v125
    v_dot2c_f32_bf16 v152, s60, v85
    v_dot2c_f32_bf16 v153, v85, v85
    v_dot2c_f32_bf16 v148, s61, v126
    v_dot2c_f32_bf16 v149, s62, v126
    v_dot2c_f32_bf16 v152, s60, v86
    v_dot2c_f32_bf16 v153, v86, v86
    v_dot2c_f32_bf16 v150, s61, v127
    v_dot2c_f32_bf16 v151, s62, v127
    v_dot2c_f32_bf16 v152, s60, v87
    v_dot2c_f32_bf16 v153, v87, v87
    s_waitcnt vmcnt(16)
    v_dot2c_f32_bf16 v144, s61, v128
    v_dot2c_f32_bf16 v145, s62, v128
    v_dot2c_f32_bf16 v152, s60, v88
    v_dot2c_f32_bf16 v153, v88, v88
    v_dot2c_f32_bf16 v146, s61, v129
    v_dot2c_f32_bf16 v147, s62, v129
    v_dot2c_f32_bf16 v152, s60, v89
    v_dot2c_f32_bf16 v153, v89, v89
    v_dot2c_f32_bf16 v148, s61, v130
    v_dot2c_f32_bf16 v149, s62, v130
    v_dot2c_f32_bf16 v152, s60, v90
    v_dot2c_f32_bf16 v153, v90, v90
    v_dot2c_f32_bf16 v150, s61, v131
    v_dot2c_f32_bf16 v151, s62, v131
    v_dot2c_f32_bf16 v152, s60, v91
    v_dot2c_f32_bf16 v153, v91, v91
    s_waitcnt vmcnt(14)
    v_dot2c_f32_bf16 v144, s61, v132
    v_dot2c_f32_bf16 v145, s62, v132
    v_dot2c_f32_bf16 v152, s60, v92
    v_dot2c_f32_bf16 v153, v92, v92
    v_dot2c_f32_bf16 v146, s61, v133
    v_dot2c_f32_bf16 v147, s62, v133
    v_dot2c_f32_bf16 v152, s60, v93
    v_dot2c_f32_bf16 v153, v93, v93
    v_dot2c_f32_bf16 v148, s61, v134
    v_dot2c_f32_bf16 v149, s62, v134
    v_dot2c_f32_bf16 v152, s60, v94
    v_dot2c_f32_bf16 v153, v94, v94
    v_dot2c_f32_bf16 v150, s61, v135
    v_dot2c_f32_bf16 v151, s62, v135
    v_dot2c_f32_bf16 v152, s60, v95
    v_dot2c_f32_bf16 v153, v95, v95
    s_waitcnt vmcnt(12)
    v_dot2c_f32_bf16 v144, s61, v136
    v_dot2c_f32_bf16 v145, s62, v136
    v_dot2c_f32_bf16 v152, s60, v96
    v_dot2c_f32_bf16 v153, v96, v96
    v_dot2c_f32_bf16 v146, s61, v137
    v_dot2c_f32_bf16 v147, s62, v137
    v_dot2c_f32_bf16 v152, s60, v97
    v_dot2c_f32_bf16 v153, v97, v97
    v_dot2c_f32_bf16 v148, s61, v138
    v_dot2c_f32_bf16 v149, s62, v138
    v_dot2c_f32_bf16 v152, s60, v98
    v_dot2c_f32_bf16 v153, v98, v98
    v_dot2c_f32_bf16 v150, s61, v139
    v_dot2c_f32_bf16 v151, s62, v139
    v_dot2c_f32_bf16 v152, s60, v99
    v_dot2c_f32_bf16 v153, v99, v99
    s_waitcnt vmcnt(10)
    v_dot2c_f32_bf16 v144, s61, v140
    v_dot2c_f32_bf16 v145, s62, v140
    v_dot2c_f32_bf16 v152, s60, v100
    v_dot2c_f32_bf16 v153, v100, v100
    v_dot2c_f32_bf16 v146, s61, v141
    v_dot2c_f32_bf16 v147, s62, v141
    v_dot2c_f32_bf16 v152, s60, v101
    v_dot2c_f32_bf16 v153, v101, v101
    v_dot2c_f32_bf16 v148, s61, v142
    v_dot2c_f32_bf16 v149, s62, v142
    v_dot2c_f32_bf16 v152, s60, v102
    v_dot2c_f32_bf16 v153, v102, v102
    v_dot2c_f32_bf16 v150, s61, v143
    v_dot2c_f32_bf16 v151, s62, v143
    v_dot2c_f32_bf16 v152, s60, v103
    v_dot2c_f32_bf16 v153, v103, v103
    s_waitcnt vmcnt(8)
    v_dot2c_f32_bf16 v144, s61, v104
    v_dot2c_f32_bf16 v145, s62, v104
    v_dot2c_f32_bf16 v152, s60, v64
    v_dot2c_f32_bf16 v153, v64, v64
    v_dot2c_f32_bf16 v146, s61, v105
    v_dot2c_f32_bf16 v147, s62, v105
    v_dot2c_f32_bf16 v152, s60, v65
    v_dot2c_f32_bf16 v153, v65, v65
    v_dot2c_f32_bf16 v148, s61, v106
    v_dot2c_f32_bf16 v149, s62, v106
    v_dot2c_f32_bf16 v152, s60, v66
    v_dot2c_f32_bf16 v153, v66, v66
    v_dot2c_f32_bf16 v150, s61, v107
    v_dot2c_f32_bf16 v151, s62, v107
    v_dot2c_f32_bf16 v152, s60, v67
    v_dot2c_f32_bf16 v153, v67, v67
    s_waitcnt vmcnt(6)
    v_dot2c_f32_bf16 v144, s61, v108
    v_dot2c_f32_bf16 v145, s62, v108
    v_dot2c_f32_bf16 v152, s60, v68
    v_dot2c_f32_bf16 v153, v68, v68
    v_dot2c_f32_bf16 v146, s61, v109
    v_dot2c_f32_bf16 v147, s62, v109
    v_dot2c_f32_bf16 v152, s60, v69
    v_dot2c_f32_bf16 v153, v69, v69
    v_dot2c_f32_bf16 v148, s61, v110
    v_dot2c_f32_bf16 v149, s62, v110
    v_dot2c_f32_bf16 v152, s60, v70
    v_dot2c_f32_bf16 v153, v70, v70
    v_dot2c_f32_bf16 v150, s61, v111
    v_dot2c_f32_bf16 v151, s62, v111
    v_dot2c_f32_bf16 v152, s60, v71
    v_dot2c_f32_bf16 v153, v71, v71
    ds_write_b128 v240, v[144:147]
    ds_write_b128 v240, v[148:151] offset:16
    v_add_f32_dpp v152, v152, v152 quad_perm:[1,0,3,2] row_mask:0xf bank_mask:0xf
    v_add_f32_dpp v153, v153, v153 quad_perm:[1,0,3,2] row_mask:0xf bank_mask:0xf
    s_nop 0
    v_add_f32_dpp v152, v152, v152 quad_perm:[2,3,0,1] row_mask:0xf bank_mask:0xf
    v_add_f32_dpp v153, v153, v153 quad_perm:[2,3,0,1] row_mask:0xf bank_mask:0xf
    s_nop 0
    v_add_f32_dpp v152, v152, v152 row_half_mirror row_mask:0xf bank_mask:0xf
    v_add_f32_dpp v153, v153, v153 row_half_mirror row_mask:0xf bank_mask:0xf
    v_mul_f32 v152, 986500301, v152
    v_mul_f32 v153, 986500301, v153
    v_fma_f32 v153, -v152, v152, v153
    v_max_f32 v153, 0, v153
    v_add_f32 v153, 925353388, v153
    v_rsq_f32 v153, v153
    s_nop 0
    v_mul_f32 v241, 1069066811, v153
    v_cmp_eq_u32 vcc, 1, v239
    s_nop 1
    v_cndmask_b32 v152, v152, v153, vcc
    v_cmp_eq_u32 vcc, 2, v239
    s_nop 1
    v_cndmask_b32 v152, v152, v241, vcc
    v_lshlrev_b32 v238, 2, v238
    v_lshl_add_u32 v238, v239, 13, v238
    s_add_u32 s58, s58, 262144
    s_mov_b32 exec_lo, 0x07070707
    s_mov_b32 exec_hi, 0x07070707
    buffer_store_dword v152, v238, s[4:7], s58 offen sc1
    s_mov_b64 exec, -1
    v_and_b32 v238, 15, v0
    s_lshl_b32 s57, s22, 6
    v_lshl_add_u32 v238, v238, 2, s57
    v_lshrrev_b32 v239, 4, v0
    v_lshl_add_u32 v239, v239, 11, v238
    v_add_u32 v239, 131072, v239
    s_waitcnt lgkmcnt(0)
    s_barrier
    ds_read2st64_b32 v[144:145], v239 offset0:0 offset1:1
    ds_read2st64_b32 v[146:147], v239 offset0:2 offset1:3
    ds_read2st64_b32 v[148:149], v239 offset0:4 offset1:5
    ds_read2st64_b32 v[150:151], v239 offset0:6 offset1:7
    s_waitcnt lgkmcnt(0)
    v_add_f32 v144, v144, v145
    v_add_f32 v144, v144, v146
    v_add_f32 v144, v144, v147
    v_add_f32 v144, v144, v148
    v_add_f32 v144, v144, v149
    v_add_f32 v144, v144, v150
    v_add_f32 v144, v144, v151
    v_mov_b32 v145, v144
    s_nop 1
    v_permlane32_swap_b32 v144, v145
    v_add_f32 v144, v144, v145
    v_mov_b32 v145, v144
    s_nop 1
    v_permlane16_swap_b32 v144, v145
    v_add_f32 v144, v144, v145
    v_mov_b32_e64 v241, 0
    global_load_dword v240, v241, s[20:21] offset:0 sc1
    s_mov_b64 exec, 0xffff
    buffer_store_dword v144, v238, s[4:7], s51 offen sc1
    s_mov_b64 exec, -1
    s_add_u32 m0, s54, 24576
    s_nop 0
    buffer_load_dwordx4 v6, s[12:15], s50 offen offset:0 lds
    buffer_load_dwordx4 v7, s[12:15], s50 offen offset:1024 lds
    buffer_load_dwordx4 v8, s[12:15], s50 offen offset:2048 lds
    s_add_u32 s50, s50, 24576
    s_add_u32 m0, s54, 27648
    s_nop 0
    buffer_load_dwordx4 v6, s[12:15], s50 offen offset:0 lds
    buffer_load_dwordx4 v7, s[12:15], s50 offen offset:1024 lds
    buffer_load_dwordx4 v8, s[12:15], s50 offen offset:2048 lds
    s_add_u32 s50, s50, 73728
    s_waitcnt vmcnt(7)
    v_readfirstlane_b32 s70, v240
    s_mov_b32 s69, 1048576
    s_cmp_ge_u32 s70, 8
    s_cbranch_scc1 Linitx_32
Linit_31:
    s_sub_u32 s69, s69, 1
    s_cbranch_scc1 Linitx_32
    s_sleep 16
    global_load_dword v240, v241, s[20:21] offset:0 sc1
    s_waitcnt vmcnt(0)
    v_readfirstlane_b32 s70, v240
    s_cmp_lt_u32 s70, 8
    s_cbranch_scc1 Linit_31
Linitx_32:
    s_waitcnt vmcnt(6)
    s_barrier
    s_cmp_lg_u32 s22, 0
    s_cbranch_scc1 Lsig_33
    s_add_u32 s42, s4, 104448
    s_addc_u32 s43, s5, 0
    s_mov_b32 s70, 1
    s_atomic_add s70, s[42:43], 0 glc
    s_waitcnt lgkmcnt(0)
    s_cmp_lg_u32 s70, 63
    s_cbranch_scc1 Lsig_33
    s_mov_b32 s70, 1
    s_atomic_add s70, s[20:21], 8
Lsig_33:
    s_add_u32 m0, s54, 49152
    s_nop 0
    buffer_load_dwordx4 v6, s[12:15], s50 offen offset:0 lds
    buffer_load_dwordx4 v7, s[12:15], s50 offen offset:1024 lds
    buffer_load_dwordx4 v8, s[12:15], s50 offen offset:2048 lds
    s_add_u32 s50, s50, 24576
    s_add_u32 m0, s54, 52224
    s_nop 0
    buffer_load_dwordx4 v6, s[12:15], s50 offen offset:0 lds
    buffer_load_dwordx4 v7, s[12:15], s50 offen offset:1024 lds
    buffer_load_dwordx4 v8, s[12:15], s50 offen offset:2048 lds
    s_add_u32 s50, s50, 73728
    s_mov_b32 s12, s36
    s_mov_b32 s13, s37
    s_mov_b32 s14, 1966080
    s_mov_b32 s15, 0x20000
    s_lshr_b32 s49, s45, 1
    s_mul_i32 s49, s49, 12
    s_add_u32 s49, s49, s47
    s_sub_u32 s55, s47, 4
    s_max_i32 s55, s55, 0
    s_add_u32 s49, s49, s55
    s_lshl_b32 s55, s49, 2
    s_add_u32 s55, s55, s22
    s_mul_i32 s55, s55, 10240
    s_and_b32 s53, s45, 1
    s_mul_i32 s56, s53, 640
    s_add_u32 s55, s55, s56
    s_mul_i32 s56, s22, 5120
    v_add_u32 v224, 0, v0
    v_mul_u32_u24 v225, 1639, v224
    v_lshrrev_b32 v225, 16, v225
    v_mul_u32_u24 v226, 40, v225
    v_sub_u32 v226, v224, v226
    v_mul_u32_u24 v225, 1280, v225
    v_lshl_add_u32 v32, v226, 4, v225
    v_add_u32 v224, 64, v0
    v_mul_u32_u24 v225, 1639, v224
    v_lshrrev_b32 v225, 16, v225
    v_mul_u32_u24 v226, 40, v225
    v_sub_u32 v226, v224, v226
    v_mul_u32_u24 v225, 1280, v225
    v_lshl_add_u32 v33, v226, 4, v225
    v_subrev_u32 v33, 1024, v33
    v_add_u32 v224, 128, v0
    v_mul_u32_u24 v225, 1639, v224
    v_lshrrev_b32 v225, 16, v225
    v_mul_u32_u24 v226, 40, v225
    v_sub_u32_e64 v226, v224, v226
    v_mul_u32_u24 v225, 1280, v225
    v_lshl_add_u32 v34, v226, 4, v225
    v_subrev_u32 v34, 2048, v34
    v_add_u32 v224, 192, v0
    v_mul_u32_u24 v225, 1639, v224
    v_lshrrev_b32 v225, 16, v225
    v_mul_u32_u24 v226, 40, v225
    v_sub_u32_e64 v226, v224, v226
    v_mul_u32_u24 v225, 1280, v225
    v_lshl_add_u32 v35, v226, 4, v225
    v_subrev_u32 v35, 3072, v35
    v_add_u32 v224, 256, v0
    v_mul_u32_u24 v225, 1639, v224
    v_lshrrev_b32 v225, 16, v225
    v_mul_u32_u24 v226, 40, v225
    v_sub_u32_e64 v226, v224, v226
    v_mul_u32_u24 v225, 1280, v225
    v_lshl_add_u32 v36, v226, 4, v225
    s_add_u32 m0, s56, 73728
    s_nop 0
    buffer_load_dwordx4 v32, s[12:15], s55 offen offset:0 lds
    buffer_load_dwordx4 v33, s[12:15], s55 offen offset:1024 lds
    buffer_load_dwordx4 v34, s[12:15], s55 offen offset:2048 lds
    buffer_load_dwordx4 v35, s[12:15], s55 offen offset:3072 lds
    s_add_u32 m0, s56, 77824
    s_nop 0
    buffer_load_dwordx4 v36, s[12:15], s55 offen offset:0 lds
    s_add_u32 s55, s55, 40960
    s_add_u32 m0, s56, 94208
    s_nop 0
    buffer_load_dwordx4 v32, s[12:15], s55 offen offset:0 lds
    buffer_load_dwordx4 v33, s[12:15], s55 offen offset:1024 lds
    buffer_load_dwordx4 v34, s[12:15], s55 offen offset:2048 lds
    buffer_load_dwordx4 v35, s[12:15], s55 offen offset:3072 lds
    s_add_u32 m0, s56, 98304
    s_nop 0
    buffer_load_dwordx4 v36, s[12:15], s55 offen offset:0 lds
    s_add_u32 s55, s55, 40960
    v_lshl_add_u32 v224, v20, 3, v21
    v_mul_u32_u24 v224, 640, v224
    s_mul_i32 s56, s22, 160
    s_add_u32 s56, s56, 73728
    v_add_u32 v224, s56, v224
    v_lshl_add_u32 v40, v22, 4, v224
    v_and_b32 v225, 1, v22
    v_lshl_add_u32 v224, v225, 4, v224
    v_lshrrev_b32_e64 v225, 1, v22
    v_lshl_add_u32 v224, v225, 3, v224
    v_add_u32 v41, 128, v224
    s_lshl_b32 s53, s53, 2
    s_add_u32 s53, s53, s22
    s_mul_i32 s56, s53, 48
    s_add_u32 s49, s49, s56
    s_mul_i32 s49, s49, 5120
    s_add_u32 s49, s49, 8388608
    s_barrier
    s_nop 0
    ds_read_b64_tr_b16 v[64:65], v26 offset:0
    ds_read_b64_tr_b16 v[66:67], v26 offset:1536
    ds_read_b64_tr_b16 v[68:69], v26 offset:16
    ds_read_b64_tr_b16 v[70:71], v26 offset:1552
    ds_read_b64_tr_b16 v[72:73], v26 offset:32
    ds_read_b64_tr_b16 v[74:75], v26 offset:1568
    ds_read_b64_tr_b16 v[76:77], v26 offset:48
    ds_read_b64_tr_b16 v[78:79], v26 offset:1584
    ds_read_b64_tr_b16 v[80:81], v26 offset:64
    ds_read_b64_tr_b16 v[82:83], v26 offset:1600
    ds_read_b64_tr_b16 v[84:85], v26 offset:80
    ds_read_b64_tr_b16 v[86:87], v26 offset:1616
    s_waitcnt lgkmcnt(10)
    buffer_store_dwordx4 v[64:67], v25, s[4:7], s46 offen offset:0 sc1
    s_waitcnt lgkmcnt(8)
    buffer_store_dwordx4 v[68:71], v25, s[4:7], s46 offen offset:1024 sc1
    s_waitcnt lgkmcnt(6)
    buffer_store_dwordx4 v[72:75], v25, s[4:7], s46 offen offset:2048 sc1
    s_add_u32 s46, s46, 61440
    s_waitcnt lgkmcnt(4)
    buffer_store_dwordx4 v[76:79], v25, s[4:7], s46 offen offset:0 sc1
    s_waitcnt lgkmcnt(2)
    buffer_store_dwordx4 v[80:83], v25, s[4:7], s46 offen offset:1024 sc1
    s_waitcnt lgkmcnt(0)
    buffer_store_dwordx4 v[84:87], v25, s[4:7], s46 offen offset:2048 sc1
    v_mov_b32 v44, 1065369472
    v_mov_b32 v45, 1065369472
    v_mov_b32 v46, 1065369472
    v_mov_b32 v47, 1065369472
    s_nop 1
    v_mfma_f32_16x16x32_bf16 v[192:195], v[44:47], v[64:67], 0
    v_mfma_f32_16x16x32_bf16 v[196:199], v[44:47], v[68:71], 0
    v_mfma_f32_16x16x32_bf16 v[200:203], v[44:47], v[72:75], 0
    v_mfma_f32_16x16x32_bf16 v[204:207], v[44:47], v[76:79], 0
    v_mfma_f32_16x16x32_bf16 v[208:211], v[44:47], v[80:83], 0
    v_mfma_f32_16x16x32_bf16 v[212:215], v[44:47], v[84:87], 0
    s_waitcnt vmcnt(22)
    s_barrier
    s_nop 0
    ds_read_b64_tr_b16 v[88:89], v26 offset:24576
    ds_read_b64_tr_b16 v[90:91], v26 offset:26112
    ds_read_b64_tr_b16 v[92:93], v26 offset:24592
    ds_read_b64_tr_b16 v[94:95], v26 offset:26128
    ds_read_b64_tr_b16 v[96:97], v26 offset:24608
    ds_read_b64_tr_b16 v[98:99], v26 offset:26144
    ds_read_b64_tr_b16 v[100:101], v26 offset:24624
    ds_read_b64_tr_b16 v[102:103], v26 offset:26160
    ds_read_b64_tr_b16 v[104:105], v26 offset:24640
    ds_read_b64_tr_b16 v[106:107], v26 offset:26176
    ds_read_b64_tr_b16 v[108:109], v26 offset:24656
    ds_read_b64_tr_b16 v[110:111], v26 offset:26192
    s_sub_u32 s46, s46, 58368
    s_waitcnt lgkmcnt(10)
    buffer_store_dwordx4 v[88:91], v25, s[4:7], s46 offen offset:0 sc1
    s_waitcnt lgkmcnt(8)
    buffer_store_dwordx4 v[92:95], v25, s[4:7], s46 offen offset:1024 sc1
    s_waitcnt lgkmcnt(6)
    buffer_store_dwordx4 v[96:99], v25, s[4:7], s46 offen offset:2048 sc1
    s_add_u32 s46, s46, 61440
    s_waitcnt lgkmcnt(4)
    buffer_store_dwordx4 v[100:103], v25, s[4:7], s46 offen offset:0 sc1
    s_waitcnt lgkmcnt(2)
    buffer_store_dwordx4 v[104:107], v25, s[4:7], s46 offen offset:1024 sc1
    s_waitcnt lgkmcnt(0)
    buffer_store_dwordx4 v[108:111], v25, s[4:7], s46 offen offset:2048 sc1
    v_mfma_f32_16x16x32_bf16 v[192:195], v[44:47], v[88:91], v[192:195]
    v_mfma_f32_16x16x32_bf16 v[196:199], v[44:47], v[92:95], v[196:199]
    v_mfma_f32_16x16x32_bf16 v[200:203], v[44:47], v[96:99], v[200:203]
    v_mfma_f32_16x16x32_bf16 v[204:207], v[44:47], v[100:103], v[204:207]
    v_mfma_f32_16x16x32_bf16 v[208:211], v[44:47], v[104:107], v[208:211]
    v_mfma_f32_16x16x32_bf16 v[212:215], v[44:47], v[108:111], v[212:215]
    s_waitcnt vmcnt(22)
    s_barrier
    ds_read_b64_tr_b16 v[112:113], v27 offset:0
    ds_read_b64_tr_b16 v[114:115], v27 offset:1536
    ds_read_b64_tr_b16 v[116:117], v27 offset:16
    ds_read_b64_tr_b16 v[118:119], v27 offset:1552
    ds_read_b64_tr_b16 v[120:121], v27 offset:32
    ds_read_b64_tr_b16 v[122:123], v27 offset:1568
    ds_read_b64_tr_b16 v[124:125], v27 offset:48
    ds_read_b64_tr_b16 v[126:127], v27 offset:1584
    ds_read_b64_tr_b16 v[128:129], v27 offset:64
    ds_read_b64_tr_b16 v[130:131], v27 offset:1600
    ds_read_b64_tr_b16 v[132:133], v27 offset:80
    ds_read_b64_tr_b16 v[134:135], v27 offset:1616
    s_sub_u32 s46, s46, 58368
    s_waitcnt lgkmcnt(10)
    buffer_store_dwordx4 v[112:115], v25, s[4:7], s46 offen offset:0 sc1
    s_waitcnt lgkmcnt(8)
    buffer_store_dwordx4 v[116:119], v25, s[4:7], s46 offen offset:1024 sc1
    s_waitcnt lgkmcnt(6)
    buffer_store_dwordx4 v[120:123], v25, s[4:7], s46 offen offset:2048 sc1
    s_add_u32 s46, s46, 61440
    s_waitcnt lgkmcnt(4)
    buffer_store_dwordx4 v[124:127], v25, s[4:7], s46 offen offset:0 sc1
    s_waitcnt lgkmcnt(2)
    buffer_store_dwordx4 v[128:131], v25, s[4:7], s46 offen offset:1024 sc1
    s_waitcnt lgkmcnt(0)
    buffer_store_dwordx4 v[132:135], v25, s[4:7], s46 offen offset:2048 sc1
    v_mfma_f32_16x16x32_bf16 v[192:195], v[44:47], v[112:115], v[192:195]
    v_mfma_f32_16x16x32_bf16 v[196:199], v[44:47], v[116:119], v[196:199]
    v_mfma_f32_16x16x32_bf16 v[200:203], v[44:47], v[120:123], v[200:203]
    v_mfma_f32_16x16x32_bf16 v[204:207], v[44:47], v[124:127], v[204:207]
    v_mfma_f32_16x16x32_bf16 v[208:211], v[44:47], v[128:131], v[208:211]
    v_mfma_f32_16x16x32_bf16 v[212:215], v[44:47], v[132:135], v[212:215]
    s_mov_b32 s60, 4294901760
    s_mov_b32 s61, 0
    s_nop 1
    v_cndmask_b32 v192, v192, v196, s[60:61]
    s_nop 2
    v_cndmask_b32 v208, v208, v212, s[60:61]
    s_mov_b32 s60, 0
    s_mov_b32 s61, 65535
    v_cndmask_b32 v192, v192, v200, s[60:61]
    s_mov_b32 s60, 0
    s_mov_b32 s61, 4294901760
    v_cndmask_b32 v192, v192, v204, s[60:61]
    s_lshl_b32 s55, s45, 2
    s_add_u32 s55, s55, s22
    s_mul_i32 s55, s55, 384
    s_add_u32 s55, s55, 327680
    v_lshrrev_b32 v224, 2, v25
    buffer_atomic_add_f32 v192, v224, s[4:7], s55 offen
    s_mov_b32 exec_hi, 0
    buffer_atomic_add_f32 v208, v224, s[4:7], s55 offen offset:256
    s_mov_b32 exec_hi, -1
    s_and_b32 s71, s23, 6
    s_lshl_b32 s71, s71, 8
    s_add_u32 s71, s71, 102400
    v_and_b32_e64 v233, 1, v0
    v_lshl_add_u32 v233, v233, 8, s71
    buffer_load_dword v232, v233, s[4:7], 0 offen sc1
    s_waitcnt vmcnt(21)
    s_barrier
    ds_read_b64_tr_b16 v[140:141], v40 offset:0
    ds_read_b64_tr_b16 v[142:143], v40 offset:2560
    ds_read_b64_tr_b16 v[144:145], v40 offset:8
    ds_read_b64_tr_b16 v[146:147], v40 offset:2568
    ds_read_b64_tr_b16 v[148:149], v40 offset:64
    ds_read_b64_tr_b16 v[150:151], v40 offset:2624
    ds_read_b64_tr_b16 v[152:153], v40 offset:72
    ds_read_b64_tr_b16 v[154:155], v40 offset:2632
    ds_read_b64_tr_b16 v[156:157], v41 offset:0
    ds_read_b64_tr_b16 v[158:159], v41 offset:2560
    ds_read_b64_tr_b16 v[160:161], v40 offset:20480
    ds_read_b64_tr_b16 v[162:163], v40 offset:23040
    ds_read_b64_tr_b16 v[164:165], v40 offset:20488
    ds_read_b64_tr_b16 v[166:167], v40 offset:23048
    ds_read_b64_tr_b16 v[168:169], v40 offset:20544
    ds_read_b64_tr_b16 v[170:171], v40 offset:23104
    ds_read_b64_tr_b16 v[172:173], v40 offset:20552
    ds_read_b64_tr_b16 v[174:175], v40 offset:23112
    ds_read_b64_tr_b16 v[176:177], v41 offset:20480
    ds_read_b64_tr_b16 v[178:179], v41 offset:23040
    s_waitcnt lgkmcnt(15)
    buffer_store_dwordx4 v[140:143], v1, s[4:7], s49 offen offset:0 sc1
    buffer_store_dwordx4 v[144:147], v1, s[4:7], s49 offen offset:1024 sc1
    s_waitcnt lgkmcnt(14)
    buffer_store_dwordx4 v[148:151], v1, s[4:7], s49 offen offset:2048 sc1
    s_waitcnt lgkmcnt(12)
    buffer_store_dwordx4 v[152:155], v1, s[4:7], s49 offen offset:3072 sc1
    s_add_u32 s49, s49, 4096
    s_waitcnt lgkmcnt(10)
    buffer_store_dwordx4 v[156:159], v1, s[4:7], s49 offen offset:0 sc1
    s_waitcnt lgkmcnt(8)
    buffer_store_dwordx4 v[160:163], v1, s[4:7], s49 offen offset:1024 sc1
    s_waitcnt lgkmcnt(6)
    buffer_store_dwordx4 v[164:167], v1, s[4:7], s49 offen offset:2048 sc1
    s_waitcnt lgkmcnt(4)
    buffer_store_dwordx4 v[168:171], v1, s[4:7], s49 offen offset:3072 sc1
    s_add_u32 s49, s49, 4096
    s_waitcnt lgkmcnt(2)
    buffer_store_dwordx4 v[172:175], v1, s[4:7], s49 offen offset:0 sc1
    s_waitcnt lgkmcnt(0)
    buffer_store_dwordx4 v[176:179], v1, s[4:7], s49 offen offset:1024 sc1
    s_mov_b32 s46, s53
    s_mov_b32 s47, 2
    s_waitcnt vmcnt(10)
Lhfin_24:
    s_lshl_b32 s55, s45, 8
    s_add_u32 s55, s55, 71680
    s_barrier
    s_cmp_lg_u32 s22, 0
    s_cbranch_scc1 Lsig_34
    s_add_u32 s42, s4, s55
    s_addc_u32 s43, s5, 0
    s_mov_b32 s70, 1
    s_atomic_add s70, s[42:43], 0
Lsig_34:
    v_cmp_ne_u32 vcc, 1, v232
    s_mov_b32 s69, 1048576
    s_cbranch_vccz Lpollx_36
Lpoll_35:
    s_sleep 24
    buffer_load_dword v232, v233, s[4:7], 0 offen sc1
    s_sub_u32 s69, s69, 1
    s_waitcnt vmcnt(0)
    s_cbranch_scc1 Lpollx_36
    v_cmp_ne_u32 vcc, 1, v232
    s_cbranch_vccnz Lpoll_35
Lpollx_36:
    s_xor_b32 s56, s23, 0
    s_lshl_b32 s56, s56, 2
    s_add_u32 s56, s56, s22
    s_mul_i32 s56, s56, 25600
    s_add_u32 s56, s56, 1048576
    buffer_load_dwordx4 a[156:159], v1, s[4:7], s56 offen offset:0 sc1
    buffer_load_dwordx4 a[160:163], v1, s[4:7], s56 offen offset:1024 sc1
    buffer_load_dwordx4 a[164:167], v1, s[4:7], s56 offen offset:2048 sc1
    buffer_load_dwordx4 a[168:171], v1, s[4:7], s56 offen offset:3072 sc1
    s_add_u32 s56, s56, 4096
    buffer_load_dwordx4 a[172:175], v1, s[4:7], s56 offen offset:0 sc1
    buffer_load_dwordx4 a[176:179], v1, s[4:7], s56 offen offset:1024 sc1
    buffer_load_dwordx4 a[180:183], v1, s[4:7], s56 offen offset:2048 sc1
    buffer_load_dwordx4 a[184:187], v1, s[4:7], s56 offen offset:3072 sc1
    s_add_u32 s56, s56, 4096
    buffer_load_dwordx4 a[188:191], v1, s[4:7], s56 offen offset:0 sc1
    buffer_load_dwordx4 a[192:195], v1, s[4:7], s56 offen offset:1024 sc1
    buffer_load_dwordx4 a[196:199], v1, s[4:7], s56 offen offset:2048 sc1
    buffer_load_dwordx4 a[200:203], v1, s[4:7], s56 offen offset:3072 sc1
    s_add_u32 s56, s56, 4096
    buffer_load_dwordx4 a[204:207], v1, s[4:7], s56 offen offset:0 sc1
    buffer_load_dwordx4 a[208:211], v1, s[4:7], s56 offen offset:1024 sc1
    buffer_load_dwordx4 a[212:215], v1, s[4:7], s56 offen offset:2048 sc1
    buffer_load_dwordx4 a[216:219], v1, s[4:7], s56 offen offset:3072 sc1
    s_add_u32 s56, s56, 4096
    buffer_load_dwordx4 a[220:223], v1, s[4:7], s56 offen offset:0 sc1
    buffer_load_dwordx4 a[224:227], v1, s[4:7], s56 offen offset:1024 sc1
    buffer_load_dwordx4 a[228:231], v1, s[4:7], s56 offen offset:2048 sc1
    buffer_load_dwordx4 a[232:235], v1, s[4:7], s56 offen offset:3072 sc1
    s_add_u32 s56, s56, 4096
    buffer_load_dwordx4 a[236:239], v1, s[4:7], s56 offen offset:0 sc1
    buffer_load_dwordx4 a[240:243], v1, s[4:7], s56 offen offset:1024 sc1
    buffer_load_dwordx4 a[244:247], v1, s[4:7], s56 offen offset:2048 sc1
    buffer_load_dwordx4 a[248:251], v1, s[4:7], s56 offen offset:3072 sc1
    s_add_u32 s56, s56, 4096
    buffer_load_dwordx4 a[252:255], v1, s[4:7], s56 offen offset:0 sc1
    s_xor_b32 s56, s23, 1
    s_lshl_b32 s56, s56, 2
    s_add_u32 s56, s56, s22
    s_mul_i32 s56, s56, 25600
    s_add_u32 s56, s56, 1048576
    s_mul_i32 s57, s22, 25600
    s_add_u32 m0, s57, 0
    s_nop 0
    s_nop 0
    buffer_load_dwordx4 v1, s[4:7], s56 offen offset:0 sc1 lds
    buffer_load_dwordx4 v1, s[4:7], s56 offen offset:1024 sc1 lds
    buffer_load_dwordx4 v1, s[4:7], s56 offen offset:2048 sc1 lds
    buffer_load_dwordx4 v1, s[4:7], s56 offen offset:3072 sc1 lds
    s_add_u32 m0, s57, 4096
    s_add_u32 s56, s56, 4096
    buffer_load_dwordx4 v1, s[4:7], s56 offen offset:0 sc1 lds
    buffer_load_dwordx4 v1, s[4:7], s56 offen offset:1024 sc1 lds
    buffer_load_dwordx4 v1, s[4:7], s56 offen offset:2048 sc1 lds
    buffer_load_dwordx4 v1, s[4:7], s56 offen offset:3072 sc1 lds
    s_add_u32 m0, s57, 8192
    s_add_u32 s56, s56, 4096
    buffer_load_dwordx4 v1, s[4:7], s56 offen offset:0 sc1 lds
    buffer_load_dwordx4 v1, s[4:7], s56 offen offset:1024 sc1 lds
    buffer_load_dwordx4 v1, s[4:7], s56 offen offset:2048 sc1 lds
    buffer_load_dwordx4 v1, s[4:7], s56 offen offset:3072 sc1 lds
    s_add_u32 m0, s57, 12288
    s_add_u32 s56, s56, 4096
    buffer_load_dwordx4 v1, s[4:7], s56 offen offset:0 sc1 lds
    buffer_load_dwordx4 v1, s[4:7], s56 offen offset:1024 sc1 lds
    buffer_load_dwordx4 v1, s[4:7], s56 offen offset:2048 sc1 lds
    buffer_load_dwordx4 v1, s[4:7], s56 offen offset:3072 sc1 lds
    s_add_u32 m0, s57, 16384
    s_add_u32 s56, s56, 4096
    buffer_load_dwordx4 v1, s[4:7], s56 offen offset:0 sc1 lds
    s_lshl_b32 s71, s24, 2
    s_add_u32 s71, s71, s22
    s_lshl_b32 s71, s71, 8
    s_add_u32 s71, s71, 81920
    v_mov_b32 v246, s71
    buffer_load_dword v245, v246, s[4:7], 0 offen sc1
    buffer_load_dwordx4 v1, s[4:7], s56 offen offset:1024 sc1 lds
    buffer_load_dwordx4 v1, s[4:7], s56 offen offset:2048 sc1 lds
    buffer_load_dwordx4 v1, s[4:7], s56 offen offset:3072 sc1 lds
    s_add_u32 m0, s57, 20480
    s_add_u32 s56, s56, 4096
    buffer_load_dwordx4 v1, s[4:7], s56 offen offset:0 sc1 lds
    buffer_load_dwordx4 v1, s[4:7], s56 offen offset:1024 sc1 lds
    buffer_load_dwordx4 v1, s[4:7], s56 offen offset:2048 sc1 lds
    s_branch Lpg_hb_1_go
.p2align 12
Lpg_hb_1:
    s_setpc_b64 s[0:1]
.p2align 3
Lpg_hb_1_go:
    buffer_load_dwordx4 v1, s[4:7], s56 offen offset:3072 sc1 lds
    s_add_u32 m0, s57, 24576
    s_add_u32 s56, s56, 4096
    buffer_load_dwordx4 v1, s[4:7], s56 offen offset:0 sc1 lds
    s_branch Lpg_join_go
.p2align 12
Lpg_join:
    s_setpc_b64 s[0:1]
.p2align 3
Lpg_join_go:
Ljoin:
    s_lshl_b32 s48, s24, 3
    s_add_u32 s48, s48, s3
    s_mul_i32 s48, s48, 20480
    s_mul_i32 s49, s23, 160
    s_add_u32 s48, s48, s49
    s_xor_b32 s49, s22, 1
    s_mul_i32 s49, s49, 15360
    s_add_u32 m0, s49, 102400
    v_add_u32 v240, 0, v0
    v_mul_u32_u24 v241, 6554, v240
    v_lshrrev_b32 v241, 16, v241
    v_mul_u32_u24 v242, 10, v241
    v_sub_u32 v242, v240, v242
    v_mul_u32_u24 v241, 1280, v241
    v_lshl_add_u32 v241, v242, 4, v241
    buffer_load_dwordx4 v241, s[8:11], s48 offen offset:0 lds
    v_add_u32 v240, 64, v0
    v_mul_u32_u24 v241, 6554, v240
    v_lshrrev_b32 v241, 16, v241
    v_mul_u32_u24 v242, 10, v241
    v_sub_u32 v242, v240, v242
    v_mul_u32_u24 v241, 1280, v241
    v_lshl_add_u32 v241, v242, 4, v241
    v_subrev_u32 v241, 1024, v241
    buffer_load_dwordx4 v241, s[8:11], s48 offen offset:1024 lds
    v_add_u32 v240, 128, v0
    v_min_u32 v240, 159, v240
    v_mul_u32_u24 v241, 6554, v240
    v_lshrrev_b32 v241, 16, v241
    v_mul_u32_u24 v242, 10, v241
    v_sub_u32_e64 v242, v240, v242
    v_mul_u32_u24 v241, 1280, v241
    v_lshl_add_u32 v241, v242, 4, v241
    v_subrev_u32 v241, 2048, v241
    buffer_load_dwordx4 v241, s[8:11], s48 offen offset:2048 lds
    s_waitcnt vmcnt(11)
    v_cmp_ne_u32 vcc, 1, v245
    s_mov_b32 s69, 1048576
    s_cbranch_vccz Lpollx_38
Lpoll_37:
    s_sleep 4
    buffer_load_dword v245, v246, s[4:7], 0 offen sc1
    s_sub_u32 s69, s69, 1
    s_waitcnt vmcnt(0)
    s_cbranch_scc1 Lpollx_38
    v_cmp_ne_u32 vcc, 1, v245
    s_cbranch_vccnz Lpoll_37
Lpollx_38:
    s_and_b32 s48, s2, 7
    s_lshl_b32 s48, s48, 2
    s_add_u32 s48, s48, s22
    s_lshl_b32 s48, s48, 1
    s_lshl_b32 s48, s48, 8
    s_add_u32 s48, s48, 106496
    s_lshr_b32 s49, s25, 1
    s_lshl_b32 s49, s49, 8
    s_add_u32 s49, s49, 71680
    v_and_b32 v246, 1, v0
    v_lshl_add_u32 v246, v246, 8, s48
    v_mov_b32 v15, s49
    v_lshlrev_b32 v168, 3, v0
    s_xor_b32 s48, s3, 1
    s_lshl_b32 s49, s24, 3
    s_add_u32 s48, s48, s49
    s_lshl_b32 s48, s48, 2
    s_add_u32 s48, s48, s22
    s_mul_i32 s48, s48, 5120
    s_add_u32 s48, s48, 2097152
    buffer_load_dwordx4 v[80:83], v1, s[4:7], s48 offen offset:0 sc1
    buffer_load_dwordx4 v[84:87], v1, s[4:7], s48 offen offset:1024 sc1
    buffer_load_dwordx2 v[90:91], v168, s[4:7], s48 offen offset:2048 sc1
    s_add_u32 s48, s48, 2560
    buffer_load_dwordx4 v[92:95], v1, s[4:7], s48 offen offset:0 sc1
    buffer_load_dwordx4 v[96:99], v1, s[4:7], s48 offen offset:1024 sc1
    buffer_load_dwordx2 v[102:103], v168, s[4:7], s48 offen offset:2048 sc1
    s_xor_b32 s48, s3, 0
    s_lshl_b32 s49, s24, 3
    s_add_u32 s48, s48, s49
    s_lshl_b32 s48, s48, 2
    s_add_u32 s48, s48, s22
    s_nop 0
    s_mul_i32 s48, s48, 5120
    s_add_u32 s48, s48, 2097152
    buffer_load_dwordx4 v[104:107], v1, s[4:7], s48 offen offset:0 sc1
    buffer_load_dwordx4 v[108:111], v1, s[4:7], s48 offen offset:1024 sc1
    buffer_load_dwordx2 v[114:115], v168, s[4:7], s48 offen offset:2048 sc1
    s_add_u32 s48, s48, 2560
    buffer_load_dwordx4 v[116:119], v1, s[4:7], s48 offen offset:0 sc1
    buffer_load_dwordx4 v[120:123], v1, s[4:7], s48 offen offset:1024 sc1
    buffer_load_dwordx2 v[126:127], v168, s[4:7], s48 offen offset:2048 sc1
    buffer_load_dword v247, v15, s[4:7], 0 offen sc1
    buffer_load_dword v245, v246, s[4:7], 0 offen sc1
    s_mov_b32 s60, 65535
    s_mov_b32 s61, 0
    s_mov_b32 s62, 4294901760
    s_mov_b32 s63, 0
    s_mov_b32 s64, 0
    s_mov_b32 s65, 65535
    s_mov_b32 s66, 0
    s_mov_b32 s67, 4294901760
    s_mov_b32 s72, 0x33333333
    s_mov_b32 s73, 0x33333333
    s_lshl_b32 s48, s24, 2
    s_lshr_b32 s49, s3, 1
    s_add_u32 s48, s48, s49
    s_mul_i32 s48, s48, 40
    s_and_b32 s49, s3, 1
    s_add_u32 s48, s48, s49
    s_lshl_b32 s48, s48, 10
    s_add_u32 s48, s48, 5242880
    s_mul_i32 s49, s23, 10
    v_lshrrev_b32 v240, 4, v0
    v_and_b32 v241, 15, v0
    v_lshl_add_u32 v241, v241, 4, s48
    v_add3_u32 v242, v240, s49, 0
    v_lshrrev_b32 v243, 2, v242
    v_and_b32 v242, 3, v242
    v_lshl_add_u32 v242, v242, 8, v241
    v_lshl_add_u32 v12, v243, 11, v242
    v_add3_u32 v242, v240, s49, 4
    v_lshrrev_b32 v243, 2, v242
    v_and_b32 v242, 3, v242
    v_lshl_add_u32 v242, v242, 8, v241
    v_lshl_add_u32 v13, v243, 11, v242
    v_add3_u32 v242, v240, s49, 8
    v_lshrrev_b32 v243, 2, v242
    v_and_b32 v242, 3, v242
    v_lshl_add_u32 v242, v242, 8, v241
    v_lshl_add_u32 v14, v243, 11, v242
    s_mul_i32 s48, s22, 25600
    v_add_u32 v244, s48, v1
    v_mov_b32 v236, 0
    v_mov_b32 v237, 897988541
    v_mov_b32 v238, 0
    v_mov_b32 v239, 897988541
    s_xor_b32 s48, s22, 1
    s_mul_i32 s48, s48, 15360
    s_add_u32 s48, s48, 102400
    v_add_u32 v248, s48, v1
    s_xor_b32 s48, s22, 2
    s_mul_i32 s48, s48, 15360
    s_add_u32 s48, s48, 107520
    v_add_u32 v249, s48, v1
    s_xor_b32 s48, s22, 3
    s_mul_i32 s48, s48, 15360
    s_add_u32 s48, s48, 112640
    v_add_u32_e64 v250, s48, v1
    s_mul_i32 s48, s22, 15360
    s_add_u32 s48, s48, 102400
    v_add_u32_e64 v251, s48, v1
    s_mul_i32 s52, s22, 16384
    s_add_u32 s52, s52, 23330816
    v_lshrrev_b32 v255, 4, v0
    v_mul_u32_u24 v255, 0, v255
    v_add_u32 v255, v255, v1
    s_xor_b32 s48, s22, 1
    s_mul_i32 s48, s48, 15360
    s_add_u32 s48, s48, 102400
    v_and_b32 v240, 15, v0
    v_mul_u32_u24 v240, 160, v240
    v_add_u32 v240, s48, v240
    v_lshrrev_b32_e64 v241, 4, v0
    v_lshl_add_u32 v253, v241, 4, v240
    v_bfe_u32 v241, v0, 4, 1
    v_lshl_add_u32 v240, v241, 4, v240
    v_lshrrev_b32 v241, 5, v0
    v_lshl_add_u32 v254, v241, 3, v240
    s_lshl_b32 s51, s24, 3
    s_add_u32 s51, s51, s3
    s_lshl_b32 s51, s51, 7
    s_add_u32 s51, s51, 344064
    s_mov_b32 s68, 1065369472
    v_and_b32 v252, 15, v0
    v_lshlrev_b32 v252, 3, v252
    v_lshrrev_b32 v240, 5, v0
    v_lshl_add_u32 v252, v240, 2, v252
    s_cmp_lg_u32 s22, 3
    s_cbranch_scc1 Lwm_11
    s_call_b64 s[0:1], Lpg_join_1
Lwm_11:
    s_cmp_lg_u32 s22, 2
    s_cbranch_scc1 Lwm_12
    s_call_b64 s[0:1], Lpg_join_2
Lwm_12:
    s_cmp_lg_u32 s22, 1
    s_cbranch_scc1 Lwm_13
    s_call_b64 s[0:1], Lpg_join_3
Lwm_13:
    s_waitcnt vmcnt(1)
    v_cmp_ne_u32 vcc, 8, v247
    s_mov_b32 s69, 1048576
    s_cbranch_vccz Lpollx_40
Lpoll_39:
    s_sleep 20
    buffer_load_dword v247, v15, s[4:7], 0 offen sc1
    s_sub_u32 s69, s69, 1
    s_waitcnt vmcnt(0)
    s_cbranch_scc1 Lpollx_40
    v_cmp_ne_u32 vcc, 8, v247
    s_cbranch_vccnz Lpoll_39
Lpollx_40:
    s_waitcnt vmcnt(0)
    v_cmp_ne_u32 vcc, 16, v245
    s_mov_b32 s69, 1048576
    s_cbranch_vccz Lpollx_42
Lpoll_41:
    s_sleep 4
    buffer_load_dword v245, v246, s[4:7], 0 offen sc1
    s_sub_u32 s69, s69, 1
    s_waitcnt vmcnt(0)
    s_cbranch_scc1 Lpollx_42
    v_cmp_ne_u32 vcc, 16, v245
    s_cbranch_vccnz Lpoll_41
Lpollx_42:
    s_nop 0
    buffer_load_dwordx4 v[128:131], v255, s[4:7], s52 offen sc1
    s_add_u32 s52, s52, 1024
    buffer_load_dwordx4 v[132:135], v255, s[4:7], s52 offen sc1
    s_add_u32 s52, s52, 1024
    buffer_load_dwordx4 v[136:139], v255, s[4:7], s52 offen sc1
    s_add_u32 s52, s52, 1024
    buffer_load_dwordx4 v[140:143], v255, s[4:7], s52 offen sc1
    s_add_u32 s52, s52, 1024
    buffer_load_dwordx4 v[144:147], v255, s[4:7], s52 offen sc1
    s_add_u32 s52, s52, 1024
    buffer_load_dwordx4 v[148:151], v255, s[4:7], s52 offen sc1
    s_add_u32 s52, s52, 1024
    buffer_load_dwordx4 v[152:155], v255, s[4:7], s52 offen sc1
    s_add_u32 s52, s52, 1024
    buffer_load_dwordx4 v[156:159], v255, s[4:7], s52 offen sc1
    s_add_u32 s52, s52, 1024
    buffer_load_dwordx4 v[184:187], v255, s[4:7], s52 offen sc1
    s_add_u32 s52, s52, 1024
    buffer_load_dwordx4 v[188:191], v255, s[4:7], s52 offen sc1
    s_add_u32 s52, s52, 1024
    buffer_load_dwordx4 v[204:207], v255, s[4:7], s52 offen sc1
    s_add_u32 s52, s52, 1024
    buffer_load_dwordx4 v[208:211], v255, s[4:7], s52 offen sc1
    s_add_u32 s52, s52, 1024
    buffer_load_dwordx4 v[216:219], v255, s[4:7], s52 offen sc1
    s_add_u32 s52, s52, 1024
    buffer_load_dwordx4 v[220:223], v255, s[4:7], s52 offen sc1
    s_add_u32 s52, s52, 1024
    buffer_load_dwordx4 v[224:227], v255, s[4:7], s52 offen sc1
    s_add_u32 s52, s52, 1024
    buffer_load_dwordx4 v[228:231], v255, s[4:7], s52 offen sc1
    s_lshl_b32 s59, s25, 2
    s_add_u32 s59, s59, s22
    s_mul_i32 s59, s59, 61440
    s_add_u32 s59, s59, 10485760
    buffer_load_dwordx4 a[0:3], v1, s[4:7], s59 offen offset:0 sc1
    buffer_load_dwordx4 a[4:7], v1, s[4:7], s59 offen offset:1024 sc1
    v_mov_b32 v88, v82
    v_mov_b32 v89, v83
    v_mov_b32 v100, v94
    v_mov_b32 v101, v95
    v_mov_b32 v112, v106
    v_mov_b32 v113, v107
    v_mov_b32 v124, v118
    v_mov_b32 v125, v119
    ds_read_b128 v[2:5], v253
    ds_read_b128 v[6:9], v253 offset:64
    ds_read_b64 v[10:11], v254 offset:128
    s_waitcnt vmcnt(10)
    v_cvt_pk_bf16_f32 v144, v144, v145
    v_cvt_pk_bf16_f32 v145, v146, v147
    v_cvt_pk_bf16_f32 v148, v148, v149
    v_cvt_pk_bf16_f32 v149, v150, v151
    v_cvt_pk_bf16_f32 v152, v152, v153
    v_cvt_pk_bf16_f32 v153, v154, v155
    v_cvt_pk_bf16_f32 v156, v156, v157
    v_cvt_pk_bf16_f32 v157, v158, v159
    v_cvt_pk_bf16_f32 v16, v128, v129
    v_cvt_pk_bf16_f32 v17, v130, v131
    v_cndmask_b32 v18, 0, v144, s[60:61]
    v_cndmask_b32 v20, 0, v148, s[72:73]
    v_cndmask_b32 v22, 0, v156, s[60:61]
    v_cndmask_b32 v19, 0, v145, s[60:61]
    v_cndmask_b32 v21, 0, v149, s[72:73]
    v_cndmask_b32 v23, 0, v157, s[60:61]
    v_cvt_pk_bf16_f32 v26, v132, v133
    v_cvt_pk_bf16_f32 v27, v134, v135
    v_cndmask_b32 v24, 0, v144, s[62:63]
    v_cndmask_b32 v30, v148, 0, s[72:73]
    v_cndmask_b32 v28, 0, v156, s[62:63]
    v_cndmask_b32 v25, 0, v145, s[62:63]
    v_cndmask_b32 v31, v149, 0, s[72:73]
    v_cndmask_b32 v29, 0, v157, s[62:63]
    v_cvt_pk_bf16_f32 v32, v136, v137
    v_cvt_pk_bf16_f32 v33, v138, v139
    v_cndmask_b32 v34, 0, v144, s[64:65]
    v_cndmask_b32 v36, 0, v152, s[72:73]
    v_cndmask_b32 v38, 0, v156, s[64:65]
    v_cndmask_b32 v35, 0, v145, s[64:65]
    v_cndmask_b32 v37, 0, v153, s[72:73]
    v_cndmask_b32 v39, 0, v157, s[64:65]
    v_cvt_pk_bf16_f32 v42, v140, v141
    v_cvt_pk_bf16_f32 v43, v142, v143
    v_cndmask_b32 v40, 0, v144, s[66:67]
    v_cndmask_b32 v46, v152, 0, s[72:73]
    v_cndmask_b32 v44, 0, v156, s[66:67]
    v_cndmask_b32 v41, 0, v145, s[66:67]
    v_cndmask_b32 v47, v153, 0, s[72:73]
    v_cndmask_b32 v45, 0, v157, s[66:67]
    v_mfma_f32_16x16x32_bf16 v[136:139], v[20:23], v[80:83], v[236:239]
    v_mfma_f32_16x16x32_bf16 v[136:139], v[28:31], v[82:85], v[136:139]
    v_mfma_f32_16x16x32_bf16 v[128:131], v[16:19], v[80:83], 0
    v_mfma_f32_16x16x32_bf16 v[132:135], v[24:27], v[82:85], 0
    v_mfma_f32_16x16x32_bf16 v[148:151], v[20:23], v[104:107], v[236:239]
    v_mfma_f32_16x16x32_bf16 v[148:151], v[28:31], v[106:109], v[148:151]
    v_mfma_f32_16x16x32_bf16 v[140:143], v[16:19], v[104:107], 0
    s_nop 2
    v_rcp_f32 v137, v137
    v_mfma_f32_16x16x32_bf16 v[144:147], v[24:27], v[106:109], 0
    v_rcp_f32 v139, v139
    v_mfma_f32_16x16x32_bf16 v[160:163], v[36:39], v[86:89], v[236:239]
    v_mul_f32 v136, v136, v137
    v_mul_f32 v138, v138, v139
    v_mfma_f32_16x16x32_bf16 v[160:163], v[44:47], v[88:91], v[160:163]
    v_cvt_pk_bf16_f32 v192, v136, v138
    buffer_load_dwordx4 a[8:11], v1, s[4:7], s59 offen offset:2048 sc1
    v_mfma_f32_16x16x32_bf16 v[152:155], v[32:35], v[86:89], 0
    v_mul_f32 v128, v128, v137
    v_mul_f32 v129, v129, v137
    v_mfma_f32_16x16x32_bf16 v[156:159], v[40:43], v[88:91], 0
    v_mul_f32 v130, v130, v137
    v_mul_f32 v131, v131, v137
    v_mfma_f32_16x16x32_bf16 v[172:175], v[36:39], v[110:113], v[236:239]
    v_cvt_pk_bf16_f32 v176, v128, v129
    v_cvt_pk_bf16_f32 v177, v130, v131
    v_mfma_f32_16x16x32_bf16 v[172:175], v[44:47], v[112:115], v[172:175]
    v_mul_f32 v132, v132, v139
    v_mul_f32 v133, v133, v139
    v_mfma_f32_16x16x32_bf16 v[164:167], v[32:35], v[110:113], 0
    v_mul_f32 v134, v134, v139
    v_mul_f32 v135, v135, v139
    v_mfma_f32_16x16x32_bf16 v[168:171], v[40:43], v[112:115], 0
    v_cvt_pk_bf16_f32 v178, v132, v133
    buffer_load_dwordx4 a[12:15], v1, s[4:7], s59 offen offset:3072 sc1
    v_cvt_pk_bf16_f32 v179, v134, v135
    v_rcp_f32 v149, v149
    v_rcp_f32 v151, v151
    v_mul_f32 v148, v148, v149
    v_mul_f32 v150, v150, v151
    v_cvt_pk_bf16_f32 v212, v148, v150
    v_mul_f32 v140, v140, v149
    v_mul_f32 v141, v141, v149
    v_mul_f32 v142, v142, v149
    v_mul_f32 v143, v143, v149
    v_cvt_pk_bf16_f32 v196, v140, v141
    s_add_u32 s59, s59, 4096
    buffer_load_dwordx4 a[16:19], v1, s[4:7], s59 offen offset:0 sc1
    v_cvt_pk_bf16_f32 v197, v142, v143
    v_mul_f32 v144, v144, v151
    v_mul_f32 v145, v145, v151
    v_mul_f32 v146, v146, v151
    v_mul_f32 v147, v147, v151
    v_cvt_pk_bf16_f32 v198, v144, v145
    v_cvt_pk_bf16_f32 v199, v146, v147
    s_waitcnt vmcnt(5)
    v_cvt_pk_bf16_f32 v216, v216, v217
    v_cvt_pk_bf16_f32 v217, v218, v219
    v_cvt_pk_bf16_f32 v220, v220, v221
    v_cvt_pk_bf16_f32 v221, v222, v223
    v_cvt_pk_bf16_f32 v224, v224, v225
    v_cvt_pk_bf16_f32 v225, v226, v227
    v_cvt_pk_bf16_f32 v228, v228, v229
    v_cvt_pk_bf16_f32 v229, v230, v231
    v_cvt_pk_bf16_f32 v48, v184, v185
    v_cvt_pk_bf16_f32 v49, v186, v187
    v_cndmask_b32 v50, 0, v216, s[60:61]
    v_cndmask_b32 v52, 0, v220, s[72:73]
    v_cndmask_b32 v54, 0, v228, s[60:61]
    v_cndmask_b32 v51, 0, v217, s[60:61]
    v_cndmask_b32 v53, 0, v221, s[72:73]
    v_cndmask_b32 v55, 0, v229, s[60:61]
    v_cvt_pk_bf16_f32 v58, v188, v189
    v_cvt_pk_bf16_f32 v59, v190, v191
    v_cndmask_b32 v56, 0, v216, s[62:63]
    v_cndmask_b32 v62, v220, 0, s[72:73]
    v_cndmask_b32 v60, 0, v228, s[62:63]
    v_cndmask_b32 v57, 0, v217, s[62:63]
    v_cndmask_b32 v63, v221, 0, s[72:73]
    v_cndmask_b32 v61, 0, v229, s[62:63]
    v_cvt_pk_bf16_f32 v64, v204, v205
    v_cvt_pk_bf16_f32 v65, v206, v207
    v_cndmask_b32 v66, 0, v216, s[64:65]
    v_cndmask_b32 v68, 0, v224, s[72:73]
    v_cndmask_b32 v70, 0, v228, s[64:65]
    v_cndmask_b32 v67, 0, v217, s[64:65]
    v_cndmask_b32 v69, 0, v225, s[72:73]
    v_cndmask_b32 v71, 0, v229, s[64:65]
    v_cvt_pk_bf16_f32 v74, v208, v209
    v_cvt_pk_bf16_f32 v75, v210, v211
    v_cndmask_b32 v72, 0, v216, s[66:67]
    v_cndmask_b32 v78, v224, 0, s[72:73]
    v_cndmask_b32 v76, 0, v228, s[66:67]
    v_cndmask_b32 v73, 0, v217, s[66:67]
    v_cndmask_b32 v79, v225, 0, s[72:73]
    v_cndmask_b32 v77, 0, v229, s[66:67]
    v_mfma_f32_16x16x32_bf16 v[136:139], v[52:55], v[92:95], v[236:239]
    ds_read_b128 v[216:219], v244 offset:0
    ds_read_b128 v[220:223], v244 offset:1024
    v_mfma_f32_16x16x32_bf16 v[136:139], v[60:63], v[94:97], v[136:139]
    ds_read_b128 v[224:227], v244 offset:2048
    ds_read_b128 v[228:231], v244 offset:3072
    v_mfma_f32_16x16x32_bf16 v[128:131], v[48:51], v[92:95], 0
    ds_read_b128 v[232:235], v244 offset:4096
    v_mfma_f32_16x16x32_bf16 v[132:135], v[56:59], v[94:97], 0
    v_rcp_f32 v161, v161
    v_mfma_f32_16x16x32_bf16 v[148:151], v[52:55], v[116:119], v[236:239]
    v_rcp_f32_e64 v163, v163
    v_mfma_f32_16x16x32_bf16 v[148:151], v[60:63], v[118:121], v[148:151]
    buffer_load_dwordx4 a[20:23], v1, s[4:7], s59 offen offset:1024 sc1
    v_mul_f32 v160, v160, v161
    v_mfma_f32_16x16x32_bf16 v[140:143], v[48:51], v[116:119], 0
    v_mul_f32 v162, v162, v163
    v_cvt_pk_bf16_f32 v193, v160, v162
    v_mfma_f32_16x16x32_bf16 v[144:147], v[56:59], v[118:121], 0
    s_waitcnt lgkmcnt(3)
    v_mul_f32 v152, v152, v161
    v_mul_f32_e64 v153, v153, v161
    v_mfma_f32_16x16x32_bf16 v[16:19], v[216:219], v[176:179], 0
    buffer_load_dwordx4 a[24:27], v1, s[4:7], s59 offen offset:2048 sc1
    v_mul_f32_e64 v154, v154, v161
    v_mfma_f32_16x16x32_bf16 v[32:35], v[216:219], v[196:199], 0
    ds_read_b128 v[216:219], v244 offset:5120
    v_mul_f32_e64 v155, v155, v161
    v_mfma_f32_16x16x32_bf16 v[20:23], v[220:223], v[176:179], 0
    v_cvt_pk_bf16_f32 v180, v152, v153
    v_cvt_pk_bf16_f32 v181, v154, v155
    v_mfma_f32_16x16x32_bf16 v[36:39], v[220:223], v[196:199], 0
    s_waitcnt lgkmcnt(2)
    ds_read_b128 v[220:223], v244 offset:6144
    v_mul_f32 v156, v156, v163
    v_mfma_f32_16x16x32_bf16 v[24:27], v[224:227], v[176:179], 0
    buffer_load_dwordx4 a[28:31], v1, s[4:7], s59 offen offset:3072 sc1
    v_mul_f32_e64 v157, v157, v163
    v_mfma_f32_16x16x32_bf16 v[40:43], v[224:227], v[196:199], 0
    ds_read_b128 v[224:227], v244 offset:7168
    v_mul_f32 v158, v158, v163
    v_mfma_f32_16x16x32_bf16 v[28:31], v[228:231], v[176:179], 0
    v_mul_f32 v159, v159, v163
    v_cvt_pk_bf16_f32 v182, v156, v157
    v_mfma_f32_16x16x32_bf16 v[44:47], v[228:231], v[196:199], 0
    s_waitcnt lgkmcnt(3)
    ds_read_b128 v[228:231], v244 offset:8192
    v_cvt_pk_bf16_f32 v183, v158, v159
    v_mfma_f32_16x16x32_bf16 v[80:83], v[232:235], v[176:179], 0
    s_add_u32 s59, s59, 4096
    buffer_load_dwordx4 a[32:35], v1, s[4:7], s59 offen offset:0 sc1
    v_mfma_f32_16x16x32_bf16 v[104:107], v[232:235], v[196:199], 0
    ds_read_b128 v[232:235], v244 offset:9216
    v_rcp_f32 v173, v173
    v_rcp_f32 v175, v175
    v_mul_f32 v172, v172, v173
    v_mul_f32_e64 v174, v174, v175
    v_cvt_pk_bf16_f32 v213, v172, v174
    buffer_load_dwordx4 a[36:39], v1, s[4:7], s59 offen offset:1024 sc1
    v_mul_f32 v164, v164, v173
    v_mul_f32 v165, v165, v173
    v_mul_f32 v166, v166, v173
    v_mul_f32 v167, v167, v173
    v_cvt_pk_bf16_f32 v200, v164, v165
    buffer_load_dwordx4 a[40:43], v1, s[4:7], s59 offen offset:2048 sc1
    v_cvt_pk_bf16_f32 v201, v166, v167
    v_mul_f32 v168, v168, v175
    v_mul_f32 v169, v169, v175
    v_mul_f32 v170, v170, v175
    v_mul_f32 v171, v171, v175
    v_cvt_pk_bf16_f32 v202, v168, v169
    v_cvt_pk_bf16_f32 v203, v170, v171
    v_mfma_f32_16x16x32_bf16 v[160:163], v[68:71], v[98:101], v[236:239]
    v_rcp_f32 v137, v137
    v_mfma_f32_16x16x32_bf16 v[160:163], v[76:79], v[100:103], v[160:163]
    v_rcp_f32 v139, v139
    v_mfma_f32_16x16x32_bf16 v[152:155], v[64:67], v[98:101], 0
    buffer_load_dwordx4 a[44:47], v1, s[4:7], s59 offen offset:3072 sc1
    v_mul_f32 v136, v136, v137
    v_mfma_f32_16x16x32_bf16 v[156:159], v[72:75], v[100:103], 0
    v_mul_f32 v138, v138, v139
    v_cvt_pk_bf16_f32 v194, v136, v138
    v_mfma_f32_16x16x32_bf16 v[172:175], v[68:71], v[122:125], v[236:239]
    v_mul_f32 v128, v128, v137
    v_mul_f32 v129, v129, v137
    v_mfma_f32_16x16x32_bf16 v[172:175], v[76:79], v[124:127], v[172:175]
    s_add_u32 s59, s59, 4096
    buffer_load_dwordx4 a[48:51], v1, s[4:7], s59 offen offset:0 sc1
    v_mul_f32 v130, v130, v137
    v_mfma_f32_16x16x32_bf16 v[164:167], v[64:67], v[122:125], 0
    v_mul_f32 v131, v131, v137
    v_cvt_pk_bf16_f32 v184, v128, v129
    v_mfma_f32_16x16x32_bf16 v[168:171], v[72:75], v[124:127], 0
    s_waitcnt lgkmcnt(3)
    v_cvt_pk_bf16_f32 v185, v130, v131
    v_mul_f32 v132, v132, v139
    v_mfma_f32_16x16x32_bf16 v[16:19], v[216:219], v[180:183], v[16:19]
    buffer_load_dwordx4 a[52:55], v1, s[4:7], s59 offen offset:1024 sc1
    v_mul_f32_e64 v133, v133, v139
    v_mfma_f32_16x16x32_bf16 v[32:35], v[216:219], v[200:203], v[32:35]
    ds_read_b128 v[216:219], v244 offset:10240
    v_mul_f32 v134, v134, v139
    v_mfma_f32_16x16x32_bf16 v[20:23], v[220:223], v[180:183], v[20:23]
    v_mul_f32 v135, v135, v139
    v_cvt_pk_bf16_f32 v186, v132, v133
    v_mfma_f32_16x16x32_bf16 v[36:39], v[220:223], v[200:203], v[36:39]
    s_waitcnt lgkmcnt(2)
    ds_read_b128 v[220:223], v244 offset:11264
    v_cvt_pk_bf16_f32 v187, v134, v135
    v_mfma_f32_16x16x32_bf16 v[24:27], v[224:227], v[180:183], v[24:27]
    buffer_load_dwordx4 a[56:59], v1, s[4:7], s59 offen offset:2048 sc1
    v_mfma_f32_16x16x32_bf16 v[40:43], v[224:227], v[200:203], v[40:43]
    ds_read_b128 v[224:227], v244 offset:12288
    v_mfma_f32_16x16x32_bf16 v[28:31], v[228:231], v[180:183], v[28:31]
    v_rcp_f32 v149, v149
    v_mfma_f32_16x16x32_bf16 v[44:47], v[228:231], v[200:203], v[44:47]
    s_waitcnt lgkmcnt(3)
    ds_read_b128 v[228:231], v244 offset:13312
    v_mfma_f32_16x16x32_bf16 v[80:83], v[232:235], v[180:183], v[80:83]
    v_rcp_f32 v151, v151
    v_mfma_f32_16x16x32_bf16 v[104:107], v[232:235], v[200:203], v[104:107]
    ds_read_b128 v[232:235], v244 offset:14336
    v_mul_f32 v148, v148, v149
    v_mul_f32 v150, v150, v151
    v_cvt_pk_bf16_f32 v214, v148, v150
    buffer_load_dwordx4 a[60:63], v1, s[4:7], s59 offen offset:3072 sc1
    v_mul_f32 v140, v140, v149
    v_mul_f32 v141, v141, v149
    v_mul_f32 v142, v142, v149
    v_mul_f32 v143, v143, v149
    v_cvt_pk_bf16_f32 v204, v140, v141
    s_add_u32 s59, s59, 4096
    buffer_load_dwordx4 a[64:67], v1, s[4:7], s59 offen offset:0 sc1
    v_cvt_pk_bf16_f32 v205, v142, v143
    v_mul_f32 v144, v144, v151
    v_mul_f32 v145, v145, v151
    v_mul_f32 v146, v146, v151
    v_mul_f32 v147, v147, v151
    v_cvt_pk_bf16_f32 v206, v144, v145
    v_cvt_pk_bf16_f32 v207, v146, v147
    s_waitcnt lgkmcnt(3)
    v_mfma_f32_16x16x32_bf16 v[16:19], v[216:219], v[184:187], v[16:19]
    v_rcp_f32 v161, v161
    v_mfma_f32_16x16x32_bf16 v[32:35], v[216:219], v[204:207], v[32:35]
    ds_read_b128 v[216:219], v244 offset:15360
    v_mfma_f32_16x16x32_bf16 v[20:23], v[220:223], v[184:187], v[20:23]
    v_rcp_f32 v163, v163
    v_mfma_f32_16x16x32_bf16 v[36:39], v[220:223], v[204:207], v[36:39]
    s_waitcnt lgkmcnt(2)
    ds_read_b128 v[220:223], v244 offset:16384
    buffer_load_dwordx4 a[68:71], v1, s[4:7], s59 offen offset:1024 sc1
    v_mfma_f32_16x16x32_bf16 v[24:27], v[224:227], v[184:187], v[24:27]
    v_mul_f32 v160, v160, v161
    v_mul_f32 v162, v162, v163
    v_mfma_f32_16x16x32_bf16 v[40:43], v[224:227], v[204:207], v[40:43]
    ds_read_b128 v[224:227], v244 offset:17408
    v_cvt_pk_bf16_f32 v195, v160, v162
    v_mfma_f32_16x16x32_bf16 v[28:31], v[228:231], v[184:187], v[28:31]
    v_mul_f32 v152, v152, v161
    v_mul_f32 v153, v153, v161
    v_mfma_f32_16x16x32_bf16 v[44:47], v[228:231], v[204:207], v[44:47]
    s_waitcnt lgkmcnt(3)
    ds_read_b128 v[228:231], v244 offset:18432
    buffer_load_dwordx4 a[72:75], v1, s[4:7], s59 offen offset:2048 sc1
    v_mfma_f32_16x16x32_bf16 v[80:83], v[232:235], v[184:187], v[80:83]
    v_mul_f32 v154, v154, v161
    v_mul_f32_e64 v155, v155, v161
    v_mfma_f32_16x16x32_bf16 v[104:107], v[232:235], v[204:207], v[104:107]
    ds_read_b128 v[232:235], v244 offset:19456
    v_cvt_pk_bf16_f32 v188, v152, v153
    v_mfma_f32_16x16x32_bf16 v[84:87], a[156:159], v[176:179], 0
    v_cvt_pk_bf16_f32 v189, v154, v155
    v_mul_f32_e64 v156, v156, v163
    v_mfma_f32_16x16x32_bf16 v[88:91], a[160:163], v[176:179], 0
    buffer_load_dwordx4 a[76:79], v1, s[4:7], s59 offen offset:3072 sc1
    v_mul_f32 v157, v157, v163
    v_mfma_f32_16x16x32_bf16 v[92:95], a[164:167], v[176:179], 0
    v_mul_f32 v158, v158, v163
    v_mul_f32_e64 v159, v159, v163
    v_mfma_f32_16x16x32_bf16 v[96:99], a[168:171], v[176:179], 0
    v_cvt_pk_bf16_f32 v190, v156, v157
    v_cvt_pk_bf16_f32 v191, v158, v159
    v_mfma_f32_16x16x32_bf16 v[100:103], a[172:175], v[176:179], 0
    s_add_u32 s59, s59, 4096
    buffer_load_dwordx4 a[80:83], v1, s[4:7], s59 offen offset:0 sc1
    v_mfma_f32_16x16x32_bf16 v[84:87], a[176:179], v[180:183], v[84:87]
    v_rcp_f32 v173, v173
    v_mfma_f32_16x16x32_bf16 v[88:91], a[180:183], v[180:183], v[88:91]
    v_rcp_f32 v175, v175
    v_mfma_f32_16x16x32_bf16 v[92:95], a[184:187], v[180:183], v[92:95]
    v_mul_f32 v172, v172, v173
    v_mul_f32 v174, v174, v175
    v_mfma_f32_16x16x32_bf16 v[96:99], a[188:191], v[180:183], v[96:99]
    v_cvt_pk_bf16_f32 v215, v172, v174
    buffer_load_dwordx4 a[84:87], v1, s[4:7], s59 offen offset:1024 sc1
    v_mfma_f32_16x16x32_bf16 v[100:103], a[192:195], v[180:183], v[100:103]
    v_mul_f32 v164, v164, v173
    v_mul_f32 v165, v165, v173
    v_mfma_f32_16x16x32_bf16 v[84:87], a[196:199], v[184:187], v[84:87]
    v_mul_f32 v166, v166, v173
    v_mul_f32 v167, v167, v173
    v_mfma_f32_16x16x32_bf16 v[88:91], a[200:203], v[184:187], v[88:91]
    v_cvt_pk_bf16_f32 v208, v164, v165
    buffer_load_dwordx4 a[88:91], v1, s[4:7], s59 offen offset:2048 sc1
    v_mfma_f32_16x16x32_bf16 v[92:95], a[204:207], v[184:187], v[92:95]
    v_cvt_pk_bf16_f32 v209, v166, v167
    v_mul_f32 v168, v168, v175
    v_mfma_f32_16x16x32_bf16 v[96:99], a[208:211], v[184:187], v[96:99]
    v_mul_f32 v169, v169, v175
    v_mul_f32 v170, v170, v175
    v_mfma_f32_16x16x32_bf16 v[100:103], a[212:215], v[184:187], v[100:103]
    v_mul_f32 v171, v171, v175
    v_cvt_pk_bf16_f32 v210, v168, v169
    v_cvt_pk_bf16_f32 v211, v170, v171
    s_waitcnt lgkmcnt(3)
    v_mfma_f32_16x16x32_bf16 v[16:19], v[216:219], v[188:191], v[16:19]
    v_lshlrev_b32 v128, 16, v2
    buffer_load_dwordx4 a[92:95], v1, s[4:7], s59 offen offset:3072 sc1
    v_mfma_f32_16x16x32_bf16 v[32:35], v[216:219], v[208:211], v[32:35]
    ds_read_b128 v[216:219], v244 offset:20480
    v_and_b32 v129, 0xffff0000, v2
    v_mfma_f32_16x16x32_bf16 v[20:23], v[220:223], v[188:191], v[20:23]
    v_lshlrev_b32_e64 v130, 16, v3
    v_and_b32 v131, 0xffff0000, v3
    v_mfma_f32_16x16x32_bf16 v[36:39], v[220:223], v[208:211], v[36:39]
    s_waitcnt lgkmcnt(2)
    ds_read_b128 v[220:223], v244 offset:21504
    s_add_u32 s59, s59, 4096
    buffer_load_dwordx4 a[96:99], v1, s[4:7], s59 offen offset:0 sc1
    v_mfma_f32_16x16x32_bf16 v[24:27], v[224:227], v[188:191], v[24:27]
    s_branch Lpg_join_1_go
.p2align 12
Lpg_join_1:
    s_setpc_b64 s[0:1]
.p2align 3
Lpg_join_1_go:
    v_lshlrev_b32 v132, 16, v4
    v_and_b32 v133, 0xffff0000, v4
    v_mfma_f32_16x16x32_bf16 v[40:43], v[224:227], v[208:211], v[40:43]
    ds_read_b128 v[224:227], v244 offset:22528
    v_lshlrev_b32_e64 v134, 16, v5
    v_mfma_f32_16x16x32_bf16 v[28:31], v[228:231], v[188:191], v[28:31]
    buffer_load_dwordx4 a[100:103], v1, s[4:7], s59 offen offset:1024 sc1
    v_and_b32 v135, 0xffff0000, v5
    v_mfma_f32_16x16x32_bf16 v[44:47], v[228:231], v[208:211], v[44:47]
    s_waitcnt lgkmcnt(3)
    ds_read_b128 v[228:231], v244 offset:23552
    v_lshlrev_b32 v136, 16, v6
    v_mfma_f32_16x16x32_bf16 v[80:83], v[232:235], v[188:191], v[80:83]
    v_and_b32 v137, 0xffff0000, v6
    buffer_load_dwordx4 a[104:107], v1, s[4:7], s59 offen offset:2048 sc1
    v_mfma_f32_16x16x32_bf16 v[104:107], v[232:235], v[208:211], v[104:107]
    s_waitcnt lgkmcnt(2)
    ds_read_b128 v[232:235], v244 offset:24576
    v_lshlrev_b32 v138, 16, v7
    v_mfma_f32_16x16x32_bf16 v[16:19], v[216:219], v[192:195], v[16:19]
    v_and_b32 v139, 0xffff0000, v7
    v_lshlrev_b32_e64 v140, 16, v8
    v_mfma_f32_16x16x32_bf16 v[32:35], v[216:219], v[212:215], v[32:35]
    buffer_load_dwordx4 a[108:111], v1, s[4:7], s59 offen offset:3072 sc1
    v_and_b32 v141, 0xffff0000, v8
    v_mfma_f32_16x16x32_bf16 v[20:23], v[220:223], v[192:195], v[20:23]
    v_lshlrev_b32_e64 v142, 16, v9
    v_and_b32 v143, 0xffff0000, v9
    v_mfma_f32_16x16x32_bf16 v[36:39], v[220:223], v[212:215], v[36:39]
    s_waitcnt lgkmcnt(1)
    s_add_u32 s59, s59, 4096
    buffer_load_dwordx4 a[112:115], v1, s[4:7], s59 offen offset:0 sc1
    v_lshlrev_b32 v144, 16, v10
    v_mfma_f32_16x16x32_bf16 v[24:27], v[224:227], v[192:195], v[24:27]
    v_and_b32 v145, 0xffff0000, v10
    v_lshlrev_b32_e64 v146, 16, v11
    v_mfma_f32_16x16x32_bf16 v[40:43], v[224:227], v[212:215], v[40:43]
    v_and_b32 v147, 0xffff0000, v11
    v_mfma_f32_16x16x32_bf16 v[28:31], v[228:231], v[192:195], v[28:31]
    v_mfma_f32_16x16x32_bf16 v[44:47], v[228:231], v[212:215], v[44:47]
    s_waitcnt lgkmcnt(0)
    v_mfma_f32_16x16x32_bf16 v[80:83], v[232:235], v[192:195], v[80:83]
    v_mfma_f32_16x16x32_bf16 v[104:107], v[232:235], v[212:215], v[104:107]
    v_mfma_f32_16x16x32_bf16 v[84:87], a[216:219], v[188:191], v[84:87]
    v_mfma_f32_16x16x32_bf16 v[88:91], a[220:223], v[188:191], v[88:91]
    ds_write_b128 v250, v[16:19] offset:0
    v_mfma_f32_16x16x32_bf16 v[92:95], a[224:227], v[188:191], v[92:95]
    ds_write_b128 v250, v[20:23] offset:1024
    v_mfma_f32_16x16x32_bf16 v[96:99], a[228:231], v[188:191], v[96:99]
    ds_write_b128 v250, v[24:27] offset:2048
    v_mfma_f32_16x16x32_bf16 v[100:103], a[232:235], v[188:191], v[100:103]
    ds_write_b128 v250, v[28:31] offset:3072
    v_mfma_f32_16x16x32_bf16 v[84:87], a[236:239], v[192:195], v[84:87]
    ds_write_b128 v250, v[80:83] offset:4096
    v_mfma_f32_16x16x32_bf16 v[88:91], a[240:243], v[192:195], v[88:91]
    ds_write_b128 v249, v[32:35] offset:0
    v_mfma_f32_16x16x32_bf16 v[92:95], a[244:247], v[192:195], v[92:95]
    ds_write_b128 v249, v[36:39] offset:1024
    v_mfma_f32_16x16x32_bf16 v[96:99], a[248:251], v[192:195], v[96:99]
    ds_write_b128 v249, v[40:43] offset:2048
    v_mfma_f32_16x16x32_bf16 v[100:103], a[252:255], v[192:195], v[100:103]
    ds_write_b128 v249, v[44:47] offset:3072
    ds_write_b128 v249, v[104:107] offset:4096
    v_mfma_f32_16x16x32_bf16 v[48:51], a[156:159], v[196:199], v[128:131]
    v_mfma_f32_16x16x32_bf16 v[52:55], a[160:163], v[196:199], v[132:135]
    v_mfma_f32_16x16x32_bf16 v[56:59], a[164:167], v[196:199], v[136:139]
    v_mfma_f32_16x16x32_bf16 v[60:63], a[168:171], v[196:199], v[140:143]
    v_mfma_f32_16x16x32_bf16 v[64:67], a[172:175], v[196:199], v[144:147]
    ds_write_b128 v248, v[84:87] offset:0
    v_mfma_f32_16x16x32_bf16 v[48:51], a[176:179], v[200:203], v[48:51]
    ds_write_b128 v248, v[88:91] offset:1024
    v_mfma_f32_16x16x32_bf16 v[52:55], a[180:183], v[200:203], v[52:55]
    ds_write_b128 v248, v[92:95] offset:2048
    v_mfma_f32_16x16x32_bf16 v[56:59], a[184:187], v[200:203], v[56:59]
    ds_write_b128 v248, v[96:99] offset:3072
    v_mfma_f32_16x16x32_bf16 v[60:63], a[188:191], v[200:203], v[60:63]
    ds_write_b128 v248, v[100:103] offset:4096
    v_mfma_f32_16x16x32_bf16 v[64:67], a[192:195], v[200:203], v[64:67]
    buffer_load_dwordx4 a[116:119], v1, s[4:7], s59 offen offset:1024 sc1
    buffer_load_dwordx4 a[120:123], v1, s[4:7], s59 offen offset:2048 sc1
    v_mfma_f32_16x16x32_bf16 v[48:51], a[196:199], v[204:207], v[48:51]
    buffer_load_dwordx4 a[124:127], v1, s[4:7], s59 offen offset:3072 sc1
    s_add_u32 s59, s59, 4096
    buffer_load_dwordx4 a[128:131], v1, s[4:7], s59 offen offset:0 sc1
    v_mfma_f32_16x16x32_bf16 v[52:55], a[200:203], v[204:207], v[52:55]
    buffer_load_dwordx4 a[132:135], v1, s[4:7], s59 offen offset:1024 sc1
    s_waitcnt lgkmcnt(0)
    s_barrier
    v_mfma_f32_16x16x32_bf16 v[56:59], a[204:207], v[204:207], v[56:59]
    ds_read_b128 v[148:151], v251 offset:0
    ds_read_b128 v[152:155], v251 offset:1024
    v_mfma_f32_16x16x32_bf16 v[60:63], a[208:211], v[204:207], v[60:63]
    ds_read_b128 v[156:159], v251 offset:2048
    ds_read_b128 v[160:163], v251 offset:3072
    v_mfma_f32_16x16x32_bf16 v[64:67], a[212:215], v[204:207], v[64:67]
    ds_read_b128 v[164:167], v251 offset:4096
    ds_read_b128 v[216:219], v251 offset:5120
    v_mfma_f32_16x16x32_bf16 v[48:51], a[216:219], v[208:211], v[48:51]
    ds_read_b128 v[220:223], v251 offset:6144
    ds_read_b128 v[224:227], v251 offset:7168
    v_mfma_f32_16x16x32_bf16 v[52:55], a[220:223], v[208:211], v[52:55]
    ds_read_b128 v[228:231], v251 offset:8192
    ds_read_b128 v[232:235], v251 offset:9216
    v_mfma_f32_16x16x32_bf16 v[56:59], a[224:227], v[208:211], v[56:59]
    ds_read_b128 v[176:179], v251 offset:10240
    ds_read_b128 v[180:183], v251 offset:11264
    v_mfma_f32_16x16x32_bf16 v[60:63], a[228:231], v[208:211], v[60:63]
    ds_read_b128 v[184:187], v251 offset:12288
    ds_read_b128 v[188:191], v251 offset:13312
    v_mfma_f32_16x16x32_bf16 v[64:67], a[232:235], v[208:211], v[64:67]
    ds_read_b128 v[192:195], v251 offset:14336
    v_mfma_f32_16x16x32_bf16 v[48:51], a[236:239], v[212:215], v[48:51]
    v_mfma_f32_16x16x32_bf16 v[52:55], a[240:243], v[212:215], v[52:55]
    v_mfma_f32_16x16x32_bf16 v[56:59], a[244:247], v[212:215], v[56:59]
    v_mfma_f32_16x16x32_bf16 v[60:63], a[248:251], v[212:215], v[60:63]
    v_mfma_f32_16x16x32_bf16 v[64:67], a[252:255], v[212:215], v[64:67]
    s_waitcnt lgkmcnt(5)
    v_pk_add_f32 v[148:149], v[148:149], v[216:217] op_sel:[0,0] op_sel_hi:[1,1]
    v_pk_add_f32 v[150:151], v[150:151], v[218:219] op_sel:[0,0] op_sel_hi:[1,1]
    v_pk_add_f32 v[152:153], v[152:153], v[220:221] op_sel:[0,0] op_sel_hi:[1,1]
    v_pk_add_f32 v[154:155], v[154:155], v[222:223] op_sel:[0,0] op_sel_hi:[1,1]
    v_pk_add_f32 v[156:157], v[156:157], v[224:225] op_sel:[0,0] op_sel_hi:[1,1]
    v_pk_add_f32 v[158:159], v[158:159], v[226:227] op_sel:[0,0] op_sel_hi:[1,1]
    v_pk_add_f32 v[160:161], v[160:161], v[228:229] op_sel:[0,0] op_sel_hi:[1,1]
    v_pk_add_f32 v[162:163], v[162:163], v[230:231] op_sel:[0,0] op_sel_hi:[1,1]
    v_pk_add_f32 v[164:165], v[164:165], v[232:233] op_sel:[0,0] op_sel_hi:[1,1]
    v_pk_add_f32 v[166:167], v[166:167], v[234:235] op_sel:[0,0] op_sel_hi:[1,1]
    s_waitcnt lgkmcnt(0)
    s_nop 0
    v_pk_add_f32 v[48:49], v[48:49], v[176:177] op_sel:[0,0] op_sel_hi:[1,1]
    v_pk_add_f32 v[48:49], v[48:49], v[148:149] op_sel:[0,0] op_sel_hi:[1,1]
    v_cvt_pk_bf16_f32 v2, v48, v49
    v_pk_add_f32 v[50:51], v[50:51], v[178:179] op_sel:[0,0] op_sel_hi:[1,1]
    v_pk_add_f32 v[50:51], v[50:51], v[150:151] op_sel:[0,0] op_sel_hi:[1,1]
    v_cvt_pk_bf16_f32 v3, v50, v51
    v_pk_add_f32 v[52:53], v[52:53], v[180:181] op_sel:[0,0] op_sel_hi:[1,1]
    v_pk_add_f32 v[52:53], v[52:53], v[152:153] op_sel:[0,0] op_sel_hi:[1,1]
    v_cvt_pk_bf16_f32 v4, v52, v53
    v_pk_add_f32 v[54:55], v[54:55], v[182:183] op_sel:[0,0] op_sel_hi:[1,1]
    v_pk_add_f32 v[54:55], v[54:55], v[154:155] op_sel:[0,0] op_sel_hi:[1,1]
    v_cvt_pk_bf16_f32 v5, v54, v55
    buffer_store_dwordx4 v[2:5], v12, s[4:7], 0 offen sc1
    v_pk_add_f32 v[56:57], v[56:57], v[184:185] op_sel:[0,0] op_sel_hi:[1,1]
    v_pk_add_f32 v[56:57], v[56:57], v[156:157] op_sel:[0,0] op_sel_hi:[1,1]
    v_cvt_pk_bf16_f32 v6, v56, v57
    v_pk_add_f32 v[58:59], v[58:59], v[186:187] op_sel:[0,0] op_sel_hi:[1,1]
    v_pk_add_f32 v[58:59], v[58:59], v[158:159] op_sel:[0,0] op_sel_hi:[1,1]
    v_cvt_pk_bf16_f32 v7, v58, v59
    v_pk_add_f32 v[60:61], v[60:61], v[188:189] op_sel:[0,0] op_sel_hi:[1,1]
    v_pk_add_f32 v[60:61], v[60:61], v[160:161] op_sel:[0,0] op_sel_hi:[1,1]
    v_cvt_pk_bf16_f32 v8, v60, v61
    v_pk_add_f32 v[62:63], v[62:63], v[190:191] op_sel:[0,0] op_sel_hi:[1,1]
    v_pk_add_f32 v[62:63], v[62:63], v[162:163] op_sel:[0,0] op_sel_hi:[1,1]
    v_cvt_pk_bf16_f32 v9, v62, v63
    buffer_store_dwordx4 v[6:9], v13, s[4:7], 0 offen sc1
    v_pk_add_f32 v[64:65], v[64:65], v[192:193] op_sel:[0,0] op_sel_hi:[1,1]
    v_pk_add_f32 v[64:65], v[64:65], v[164:165] op_sel:[0,0] op_sel_hi:[1,1]
    v_cvt_pk_bf16_f32 v10, v64, v65
    v_pk_add_f32 v[66:67], v[66:67], v[194:195] op_sel:[0,0] op_sel_hi:[1,1]
    v_pk_add_f32 v[66:67], v[66:67], v[166:167] op_sel:[0,0] op_sel_hi:[1,1]
    v_cvt_pk_bf16_f32 v11, v66, v67
    v_mov_b32 v128, 0
    v_mov_b32 v129, 0
    v_mov_b32 v132, v10
    v_mov_b32 v133, v11
    v_dot2c_f32_bf16 v128, s68, v2
    v_dot2c_f32_bf16 v129, v2, v2
    v_dot2c_f32_bf16 v128, s68, v3
    v_dot2c_f32_bf16 v129, v3, v3
    v_dot2c_f32_bf16 v128, s68, v4
    v_dot2c_f32_bf16 v129, v4, v4
    v_dot2c_f32_bf16 v128, s68, v5
    v_dot2c_f32_bf16 v129, v5, v5
    v_dot2c_f32_bf16 v128, s68, v6
    v_dot2c_f32_bf16 v129, v6, v6
    v_dot2c_f32_bf16 v128, s68, v7
    v_dot2c_f32_bf16 v129, v7, v7
    v_dot2c_f32_bf16 v128, s68, v8
    v_dot2c_f32_bf16 v129, v8, v8
    v_dot2c_f32_bf16 v128, s68, v9
    v_dot2c_f32_bf16 v129, v9, v9
    v_dot2c_f32_bf16 v128, s68, v10
    v_dot2c_f32_bf16 v129, v10, v10
    v_dot2c_f32_bf16 v128, s68, v11
    v_dot2c_f32_bf16 v129, v11, v11
    v_permlane32_swap_b32 v132, v134
    v_permlane32_swap_b32 v133, v135
    s_nop 0
    v_permlane32_swap_b32 v128, v129
    s_mov_b32 exec_hi, 0
    buffer_store_dwordx4 v[132:135], v14, s[4:7], 0 offen sc1
    s_mov_b32 exec_hi, -1
    v_add_f32 v128, v128, v129
    v_mov_b32 v129, v128
    s_nop 1
    v_permlane16_swap_b32 v128, v129
    v_add_f32_e64 v128, v128, v129
    s_mov_b32 exec_lo, 0xffff
    s_mov_b32 exec_hi, 0xffff
    buffer_atomic_add_f32 v128, v252, s[4:7], s51 offen
    s_mov_b64 exec, -1
    s_lshl_b32 s48, s24, 8
    s_add_u32 s48, s48, 73728
    s_cmp_lt_u32 s3, 2
    s_cselect_b32 s49, 0, 57344
    s_add_u32 s49, s49, s48
    buffer_load_dwordx4 a[136:139], v1, s[4:7], s59 offen offset:2048 sc1
    buffer_load_dwordx4 a[140:143], v1, s[4:7], s59 offen offset:3072 sc1
    s_add_u32 s59, s59, 4096
    buffer_load_dwordx4 a[144:147], v1, s[4:7], s59 offen offset:0 sc1
    buffer_load_dwordx4 a[148:151], v1, s[4:7], s59 offen offset:1024 sc1
    buffer_load_dwordx4 a[152:155], v1, s[4:7], s59 offen offset:2048 sc1
    buffer_load_dwordx4 a[156:159], v1, s[4:7], s59 offen offset:3072 sc1
    s_waitcnt vmcnt(6)
    s_barrier
    s_cmp_lg_u32 s22, 0
    s_cbranch_scc1 Lsig_43
    s_add_u32 s42, s4, s49
    s_addc_u32 s43, s5, 0
    s_mov_b32 s70, 1
    s_atomic_add s70, s[42:43], 0
Lsig_43:
    s_lshl_b32 s48, s26, 8
    s_add_u32 s48, s48, 73728
    v_mov_b32 v158, s48
    s_cmp_lt_u32 s2, 192
    s_cbranch_scc1 Lnow2_44
    s_lshl_b32 s49, s46, 8
    s_add_u32 s49, s49, 67584
    s_add_u32 s42, s4, s49
    s_addc_u32 s43, s5, 0
    s_atomic_add s47, s[42:43], 0
Lnow2_44:
    s_lshl_b32 s49, s25, 2
    s_add_u32 s49, s49, s22
    s_mul_i32 s49, s49, 192
    s_add_u32 s49, s49, 327680
    v_and_b32 v144, 48, v0
    buffer_load_dwordx4 v[96:99], v144, s[4:7], s49 offen offset:0 sc1
    buffer_load_dwordx4 v[100:103], v144, s[4:7], s49 offen offset:64 sc1
    buffer_load_dwordx4 v[104:107], v144, s[4:7], s49 offen offset:128 sc1
    s_add_u32 s59, s59, 4096
    buffer_load_dwordx4 a[160:163], v1, s[4:7], s59 offen offset:0 sc1
    buffer_load_dwordx4 a[164:167], v1, s[4:7], s59 offen offset:1024 sc1
    buffer_load_dwordx4 a[168:171], v1, s[4:7], s59 offen offset:2048 sc1
    buffer_load_dwordx4 a[172:175], v1, s[4:7], s59 offen offset:3072 sc1
    s_add_u32 s59, s59, 4096
    buffer_load_dwordx4 a[176:179], v1, s[4:7], s59 offen offset:0 sc1
    buffer_load_dwordx4 a[180:183], v1, s[4:7], s59 offen offset:1024 sc1
    s_mul_i32 s56, s26, 163840
    s_lshl_b32 s57, s22, 10
    s_add_u32 s56, s56, s57
    s_add_u32 s56, s56, 5242880
    v_add_u32 v153, 65536, v1
    v_add_u32 v154, 131072, v1
    s_lshl_b32 s58, s26, 10
    s_add_u32 s58, s58, 344064
    v_lshlrev_b32 v159, 3, v0
    s_mul_i32 s60, s26, 393216
    s_lshl_b32 s49, s25, 2
    s_add_u32 s49, s49, s22
    s_mul_i32 s49, s49, 768
    s_add_u32 s60, s60, s49
    s_add_u32 s60, s60, 16777216
    v_bfe_u32 v152, v0, 4, 1
    v_mul_u32_u24 v152, 49152, v152
    v_and_b32 v157, 15, v0
    v_lshl_add_u32 v152, v157, 4, v152
    v_lshrrev_b32 v157, 5, v0
    v_lshl_add_u32 v152, v157, 8, v152
    s_lshl_b32 s61, s26, 8
    s_add_u32 s61, s61, 98304
    s_lshl_b32 s62, s26, 8
    s_add_u32 s62, s62, 122880
    s_lshl_b32 s63, s26, 8
    s_add_u32 s63, s63, 77824
    s_lshl_b32 s48, s24, 3
    s_add_u32 s48, s48, s30
    s_mul_i32 s48, s48, 49152
    s_mul_i32 s49, s22, 12288
    s_add_u32 s48, s48, s49
    s_add_u32 s52, s48, 16777216
    s_add_u32 s53, s48, 16875520
    s_add_u32 s54, s48, 16973824
    s_add_u32 s55, s48, 17072128
    s_mul_i32 s64, s22, 10240
    v_add_u32 v140, s64, v1
    s_lshl_b32 s65, s26, 8
    s_add_u32 s65, s65, 126976
    v_and_b32 v144, 15, v0
    v_min_u32 v144, 9, v144
    v_lshrrev_b32 v145, 4, v0
    s_lshl_b32 s48, s22, 2
    v_add_u32 v145, s48, v145
    s_mul_i32 s49, s31, 10
    v_add_u32 v146, s49, v144
    v_lshrrev_b32 v147, 2, v146
    v_and_b32 v148, 3, v146
    v_lshlrev_b32_e64 v147, 11, v147
    v_lshl_add_u32 v147, v148, 8, v147
    v_lshl_add_u32 v14, v145, 4, v147
    v_mul_u32_u24 v147, 1280, v145
    v_lshl_add_u32 v15, v146, 4, v147
    s_mul_i32 s3, s24, 160
    s_add_u32 s3, s3, s30
    s_lshl_b32 s3, s3, 10
    s_add_u32 s3, s3, 5242880
    s_lshl_b32 s23, s24, 3
    s_add_u32 s23, s23, s30
    s_mul_i32 s23, s23, 20480
    s_mov_b32 s16, s38
    s_mov_b32 s17, s39
    s_mov_b32 s18, 2621440
    s_mov_b32 s19, 0x20000
    buffer_load_dwordx4 a[184:187], v1, s[4:7], s59 offen offset:2048 sc1
    buffer_load_dwordx4 a[188:191], v1, s[4:7], s59 offen offset:3072 sc1
    s_cmp_lg_u32 s22, 3
    s_cbranch_scc1 Lwm_14
    s_call_b64 s[0:1], Lpg_join_4
Lwm_14:
    s_cmp_lg_u32 s22, 2
    s_cbranch_scc1 Lwm_15
    s_call_b64 s[0:1], Lpg_join_5
Lwm_15:
    s_cmp_lg_u32 s22, 0
    s_cbranch_scc1 Lpw_45
    s_mov_b64 exec, 1
    s_mov_b32 s69, 1048576
Lpoll_46:
    buffer_load_dword v157, v158, s[4:7], 0 offen sc1
    s_sub_u32 s69, s69, 1
    s_cbranch_scc1 Lpollx_47
    s_waitcnt vmcnt(0)
    v_cmp_ne_u32 vcc, 4, v157
    s_cbranch_vccz Lpollx_47
    s_sleep 2
    s_branch Lpoll_46
Lpollx_47:
    s_waitcnt vmcnt(0)
    s_mov_b64 exec, -1
Lpw_45:
    s_barrier
    s_add_u32 m0, s57, 0
    s_nop 0
    s_nop 0
    buffer_load_dwordx4 v1, s[4:7], s56 offen sc1 lds
    s_add_u32 m0, s57, 4096
    s_add_u32 s56, s56, 4096
    buffer_load_dwordx4 v1, s[4:7], s56 offen sc1 lds
    s_add_u32 m0, s57, 8192
    s_add_u32 s56, s56, 4096
    buffer_load_dwordx4 v1, s[4:7], s56 offen sc1 lds
    s_add_u32 m0, s57, 12288
    s_add_u32 s56, s56, 4096
    buffer_load_dwordx4 v1, s[4:7], s56 offen sc1 lds
    s_add_u32 m0, s57, 16384
    s_add_u32 s56, s56, 4096
    buffer_load_dwordx4 v1, s[4:7], s56 offen sc1 lds
    s_add_u32 m0, s57, 20480
    s_add_u32 s56, s56, 4096
    buffer_load_dwordx4 v1, s[4:7], s56 offen sc1 lds
    s_add_u32 m0, s57, 24576
    s_add_u32 s56, s56, 4096
    buffer_load_dwordx4 v1, s[4:7], s56 offen sc1 lds
    s_add_u32 m0, s57, 28672
    s_add_u32 s56, s56, 4096
    buffer_load_dwordx4 v1, s[4:7], s56 offen sc1 lds
    s_waitcnt vmcnt(6)
    s_barrier
    ds_read_b128 v[64:67], v1 offset:0
    ds_read_b128 v[68:71], v1 offset:1024
    ds_read_b128 v[72:75], v1 offset:2048
    ds_read_b128 v[76:79], v1 offset:3072
    s_waitcnt lgkmcnt(2)
    v_mfma_f32_16x16x32_bf16 v[16:19], a[0:3], v[64:67], 0
    s_lshl_b32 s66, s26, 8
    s_add_u32 s66, s66, 131072
    v_mov_b32_e64 v155, s66
    buffer_load_dword v156, v155, s[4:7], 0 offen sc1
    v_mfma_f32_16x16x32_bf16 v[28:31], a[0:3], v[68:71], 0
    ds_read_b128 v[80:83], v1 offset:4096
    v_mfma_f32_16x16x32_bf16 v[20:23], a[4:7], v[64:67], 0
    ds_read_b128 v[84:87], v1 offset:5120
    v_mfma_f32_16x16x32_bf16 v[32:35], a[4:7], v[68:71], 0
    s_add_u32 m0, s57, 32768
    s_add_u32 s56, s56, 4096
    buffer_load_dwordx4 v1, s[4:7], s56 offen sc1 lds
    v_mfma_f32_16x16x32_bf16 v[24:27], a[8:11], v[64:67], 0
    v_mfma_f32_16x16x32_bf16 v[36:39], a[8:11], v[68:71], 0
    s_waitcnt lgkmcnt(2)
    v_mfma_f32_16x16x32_bf16 v[16:19], a[12:15], v[72:75], v[16:19]
    ds_read_b128 v[88:91], v1 offset:6144
    v_mfma_f32_16x16x32_bf16 v[28:31], a[12:15], v[76:79], v[28:31]
    ds_read_b128 v[92:95], v1 offset:7168
    v_mfma_f32_16x16x32_bf16 v[20:23], a[16:19], v[72:75], v[20:23]
    s_add_u32 m0, s57, 36864
    s_add_u32 s56, s56, 4096
    buffer_load_dwordx4 v1, s[4:7], s56 offen sc1 lds
    v_mfma_f32_16x16x32_bf16 v[32:35], a[16:19], v[76:79], v[32:35]
    s_add_u32 s59, s59, 4096
    buffer_load_dwordx4 a[192:195], v1, s[4:7], s59 offen offset:0 sc1
    v_mfma_f32_16x16x32_bf16 v[24:27], a[20:23], v[72:75], v[24:27]
    v_mfma_f32_16x16x32_bf16 v[36:39], a[20:23], v[76:79], v[36:39]
    s_waitcnt lgkmcnt(2)
    v_mfma_f32_16x16x32_bf16 v[16:19], a[24:27], v[80:83], v[16:19]
    s_waitcnt vmcnt(8)
    s_barrier
    v_mfma_f32_16x16x32_bf16 v[28:31], a[24:27], v[84:87], v[28:31]
    ds_read_b128 v[64:67], v1 offset:8192
    v_mfma_f32_16x16x32_bf16 v[20:23], a[28:31], v[80:83], v[20:23]
    ds_read_b128 v[68:71], v1 offset:9216
    v_mfma_f32_16x16x32_bf16 v[32:35], a[28:31], v[84:87], v[32:35]
    buffer_load_dwordx4 a[196:199], v1, s[4:7], s59 offen offset:1024 sc1
    v_mfma_f32_16x16x32_bf16 v[24:27], a[32:35], v[80:83], v[24:27]
    buffer_load_dwordx4 a[200:203], v1, s[4:7], s59 offen offset:2048 sc1
    v_mfma_f32_16x16x32_bf16 v[36:39], a[32:35], v[84:87], v[36:39]
    s_waitcnt lgkmcnt(2)
    v_mfma_f32_16x16x32_bf16 v[16:19], a[36:39], v[88:91], v[16:19]
    ds_read_b128 v[72:75], v1 offset:10240
    v_mfma_f32_16x16x32_bf16 v[28:31], a[36:39], v[92:95], v[28:31]
    ds_read_b128 v[76:79], v1 offset:11264
    v_mfma_f32_16x16x32_bf16 v[20:23], a[40:43], v[88:91], v[20:23]
    buffer_load_dwordx4 a[204:207], v1, s[4:7], s59 offen offset:3072 sc1
    v_mfma_f32_16x16x32_bf16 v[32:35], a[40:43], v[92:95], v[32:35]
    v_mfma_f32_16x16x32_bf16 v[24:27], a[44:47], v[88:91], v[24:27]
    v_mfma_f32_16x16x32_bf16 v[36:39], a[44:47], v[92:95], v[36:39]
    s_waitcnt lgkmcnt(2)
    v_mfma_f32_16x16x32_bf16 v[16:19], a[48:51], v[64:67], v[16:19]
    ds_read_b128 v[80:83], v1 offset:12288
    v_mfma_f32_16x16x32_bf16 v[28:31], a[48:51], v[68:71], v[28:31]
    ds_read_b128 v[84:87], v1 offset:13312
    v_mfma_f32_16x16x32_bf16 v[20:23], a[52:55], v[64:67], v[20:23]
    s_add_u32 s59, s59, 4096
    buffer_load_dwordx4 a[208:211], v1, s[4:7], s59 offen offset:0 sc1
    v_mfma_f32_16x16x32_bf16 v[32:35], a[52:55], v[68:71], v[32:35]
    buffer_load_dwordx4 a[212:215], v1, s[4:7], s59 offen offset:1024 sc1
    v_mfma_f32_16x16x32_bf16 v[24:27], a[56:59], v[64:67], v[24:27]
    v_mfma_f32_16x16x32_bf16 v[36:39], a[56:59], v[68:71], v[36:39]
    s_waitcnt lgkmcnt(2)
    v_mfma_f32_16x16x32_bf16 v[16:19], a[60:63], v[72:75], v[16:19]
    ds_read_b128 v[88:91], v1 offset:14336
    v_mfma_f32_16x16x32_bf16 v[28:31], a[60:63], v[76:79], v[28:31]
    ds_read_b128 v[92:95], v1 offset:15360
    v_mfma_f32_16x16x32_bf16 v[20:23], a[64:67], v[72:75], v[20:23]
    buffer_load_dwordx4 a[216:219], v1, s[4:7], s59 offen offset:2048 sc1
    v_mfma_f32_16x16x32_bf16 v[32:35], a[64:67], v[76:79], v[32:35]
    buffer_load_dwordx4 a[220:223], v1, s[4:7], s59 offen offset:3072 sc1
    v_mfma_f32_16x16x32_bf16 v[24:27], a[68:71], v[72:75], v[24:27]
    v_mfma_f32_16x16x32_bf16 v[36:39], a[68:71], v[76:79], v[36:39]
    s_waitcnt lgkmcnt(2)
    v_mfma_f32_16x16x32_bf16 v[16:19], a[72:75], v[80:83], v[16:19]
    s_waitcnt vmcnt(11)
    s_barrier
    v_mfma_f32_16x16x32_bf16 v[28:31], a[72:75], v[84:87], v[28:31]
    ds_read_b128 v[64:67], v1 offset:16384
    v_mfma_f32_16x16x32_bf16 v[20:23], a[76:79], v[80:83], v[20:23]
    ds_read_b128 v[68:71], v1 offset:17408
    v_mfma_f32_16x16x32_bf16 v[32:35], a[76:79], v[84:87], v[32:35]
    s_add_u32 s59, s59, 4096
    buffer_load_dwordx4 a[224:227], v1, s[4:7], s59 offen offset:0 sc1
    v_mfma_f32_16x16x32_bf16 v[24:27], a[80:83], v[80:83], v[24:27]
    s_waitcnt vmcnt(11)
    v_cmp_ne_u32 vcc, 12, v156
    s_mov_b32 s69, 1048576
    s_cbranch_vccz Lpollx_49
Lpoll_48:
    s_sleep 8
    buffer_load_dword v156, v155, s[4:7], 0 offen sc1
    s_sub_u32 s69, s69, 1
    s_waitcnt vmcnt(0)
    s_cbranch_scc1 Lpollx_49
    v_cmp_ne_u32 vcc, 12, v156
    s_cbranch_vccnz Lpoll_48
Lpollx_49:
    v_mfma_f32_16x16x32_bf16 v[36:39], a[80:83], v[84:87], v[36:39]
    s_waitcnt lgkmcnt(2)
    v_mfma_f32_16x16x32_bf16 v[16:19], a[84:87], v[88:91], v[16:19]
    ds_read_b128 v[72:75], v1 offset:18432
    v_mfma_f32_16x16x32_bf16 v[28:31], a[84:87], v[92:95], v[28:31]
    ds_read_b128 v[76:79], v1 offset:19456
    v_mfma_f32_16x16x32_bf16 v[20:23], a[88:91], v[88:91], v[20:23]
    buffer_load_dwordx2 v[160:161], v159, s[4:7], s58 offen offset:0 sc1
    v_mfma_f32_16x16x32_bf16 v[32:35], a[88:91], v[92:95], v[32:35]
    buffer_load_dwordx2 v[162:163], v159, s[4:7], s58 offen offset:512 sc1
    v_mfma_f32_16x16x32_bf16 v[24:27], a[92:95], v[88:91], v[24:27]
    s_add_u32 m0, s57, 40960
    s_add_u32 s56, s56, 4096
    buffer_load_dwordx4 v1, s[4:7], s56 offen sc1 lds
    v_mfma_f32_16x16x32_bf16 v[36:39], a[92:95], v[92:95], v[36:39]
    s_waitcnt lgkmcnt(2)
    v_mfma_f32_16x16x32_bf16 v[16:19], a[96:99], v[64:67], v[16:19]
    ds_read_b128 v[80:83], v1 offset:20480
    v_mfma_f32_16x16x32_bf16 v[28:31], a[96:99], v[68:71], v[28:31]
    ds_read_b128 v[84:87], v1 offset:21504
    v_mfma_f32_16x16x32_bf16 v[20:23], a[100:103], v[64:67], v[20:23]
    s_add_u32 m0, s57, 45056
    s_add_u32 s56, s56, 4096
    buffer_load_dwordx4 v1, s[4:7], s56 offen sc1 lds
    v_mfma_f32_16x16x32_bf16 v[32:35], a[100:103], v[68:71], v[32:35]
    buffer_load_dwordx4 a[228:231], v1, s[4:7], s59 offen offset:1024 sc1
    v_mfma_f32_16x16x32_bf16 v[24:27], a[104:107], v[64:67], v[24:27]
    v_mfma_f32_16x16x32_bf16 v[36:39], a[104:107], v[68:71], v[36:39]
    s_waitcnt lgkmcnt(2)
    v_mfma_f32_16x16x32_bf16 v[16:19], a[108:111], v[72:75], v[16:19]
    ds_read_b128 v[88:91], v1 offset:22528
    v_mfma_f32_16x16x32_bf16 v[28:31], a[108:111], v[76:79], v[28:31]
    ds_read_b128 v[92:95], v1 offset:23552
    v_mfma_f32_16x16x32_bf16 v[20:23], a[112:115], v[72:75], v[20:23]
    buffer_load_dwordx4 a[232:235], v1, s[4:7], s59 offen offset:2048 sc1
    v_mfma_f32_16x16x32_bf16 v[32:35], a[112:115], v[76:79], v[32:35]
    buffer_load_dwordx4 a[236:239], v1, s[4:7], s59 offen offset:3072 sc1
    v_mfma_f32_16x16x32_bf16 v[24:27], a[116:119], v[72:75], v[24:27]
    v_mfma_f32_16x16x32_bf16 v[36:39], a[116:119], v[76:79], v[36:39]
    s_waitcnt lgkmcnt(2)
    v_mfma_f32_16x16x32_bf16 v[16:19], a[120:123], v[80:83], v[16:19]
    ds_read_b128 v[64:67], v1 offset:24576
    v_mfma_f32_16x16x32_bf16 v[28:31], a[120:123], v[84:87], v[28:31]
    ds_read_b128 v[68:71], v1 offset:25600
    v_mfma_f32_16x16x32_bf16 v[20:23], a[124:127], v[80:83], v[20:23]
    s_add_u32 m0, s57, 49152
    s_add_u32 s56, s56, 4096
    buffer_load_dwordx4 v1, s[4:7], s56 offen sc1 lds
    v_mfma_f32_16x16x32_bf16 v[32:35], a[124:127], v[84:87], v[32:35]
    s_lshl_b32 s66, s31, 8
    s_add_u32 s66, s66, 67584
    v_mov_b32_e64 v155, s66
    buffer_load_dword v156, v155, s[4:7], 0 offen sc1
    v_mfma_f32_16x16x32_bf16 v[24:27], a[128:131], v[80:83], v[24:27]
    v_mfma_f32_16x16x32_bf16 v[36:39], a[128:131], v[84:87], v[36:39]
    s_waitcnt lgkmcnt(2)
    v_mfma_f32_16x16x32_bf16 v[16:19], a[132:135], v[88:91], v[16:19]
    ds_read_b128 v[72:75], v1 offset:26624
    v_mfma_f32_16x16x32_bf16 v[28:31], a[132:135], v[92:95], v[28:31]
    ds_read_b128 v[76:79], v1 offset:27648
    v_mfma_f32_16x16x32_bf16 v[20:23], a[136:139], v[88:91], v[20:23]
    s_add_u32 m0, s57, 53248
    s_add_u32 s56, s56, 4096
    buffer_load_dwordx4 v1, s[4:7], s56 offen sc1 lds
    v_mfma_f32_16x16x32_bf16 v[32:35], a[136:139], v[92:95], v[32:35]
    s_add_u32 m0, s57, 57344
    s_add_u32 s56, s56, 4096
    buffer_load_dwordx4 v1, s[4:7], s56 offen sc1 lds
    v_mfma_f32_16x16x32_bf16 v[24:27], a[140:143], v[88:91], v[24:27]
    v_mfma_f32_16x16x32_bf16 v[36:39], a[140:143], v[92:95], v[36:39]
    s_waitcnt lgkmcnt(2)
    v_mfma_f32_16x16x32_bf16 v[16:19], a[144:147], v[64:67], v[16:19]
    ds_read_b128 v[80:83], v1 offset:28672
    v_mfma_f32_16x16x32_bf16 v[28:31], a[144:147], v[68:71], v[28:31]
    ds_read_b128 v[84:87], v1 offset:29696
    v_mfma_f32_16x16x32_bf16 v[20:23], a[148:151], v[64:67], v[20:23]
    s_add_u32 m0, s57, 61440
    s_add_u32 s56, s56, 4096
    buffer_load_dwordx4 v1, s[4:7], s56 offen sc1 lds
    v_mfma_f32_16x16x32_bf16 v[32:35], a[148:151], v[68:71], v[32:35]
    s_add_u32 m0, s57, 65536
    s_add_u32 s56, s56, 4096
    buffer_load_dwordx4 v1, s[4:7], s56 offen sc1 lds
    v_mfma_f32_16x16x32_bf16 v[24:27], a[152:155], v[64:67], v[24:27]
    v_mfma_f32_16x16x32_bf16 v[36:39], a[152:155], v[68:71], v[36:39]
    s_waitcnt lgkmcnt(2)
    v_mfma_f32_16x16x32_bf16 v[16:19], a[156:159], v[72:75], v[16:19]
    ds_read_b128 v[88:91], v1 offset:30720
    v_mfma_f32_16x16x32_bf16 v[28:31], a[156:159], v[76:79], v[28:31]
    ds_read_b128 v[92:95], v1 offset:31744
    v_mfma_f32_16x16x32_bf16 v[20:23], a[160:163], v[72:75], v[20:23]
    s_add_u32 m0, s57, 69632
    s_add_u32 s56, s56, 4096
    buffer_load_dwordx4 v1, s[4:7], s56 offen sc1 lds
    v_mfma_f32_16x16x32_bf16 v[32:35], a[160:163], v[76:79], v[32:35]
    v_mfma_f32_16x16x32_bf16 v[24:27], a[164:167], v[72:75], v[24:27]
    v_mfma_f32_16x16x32_bf16 v[36:39], a[164:167], v[76:79], v[36:39]
    s_waitcnt lgkmcnt(2)
    v_mfma_f32_16x16x32_bf16 v[16:19], a[168:171], v[80:83], v[16:19]
    s_waitcnt vmcnt(23)
    s_barrier
    s_waitcnt vmcnt(12)
    v_mul_f32 v108, 986500301, v160
    v_mfma_f32_16x16x32_bf16 v[28:31], a[168:171], v[84:87], v[28:31]
    ds_read_b128 v[64:67], v1 offset:32768
    v_mul_f32 v116, 986500301, v161
    v_fma_f32 v116, -v108, v108, v116
    v_mfma_f32_16x16x32_bf16 v[20:23], a[172:175], v[80:83], v[20:23]
    ds_read_b128 v[68:71], v1 offset:33792
    v_max_f32 v116, 0, v116
    v_add_f32 v116, 925353388, v116
    v_mfma_f32_16x16x32_bf16 v[32:35], a[172:175], v[84:87], v[32:35]
    s_add_u32 m0, s57, 73728
    s_add_u32 s56, s56, 4096
    buffer_load_dwordx4 v1, s[4:7], s56 offen sc1 lds
    v_rsq_f32_e64 v124, v116
    v_mfma_f32_16x16x32_bf16 v[24:27], a[176:179], v[80:83], v[24:27]
    s_branch Lpg_join_2_go
.p2align 12
Lpg_join_2:
    s_setpc_b64 s[0:1]
.p2align 3
Lpg_join_2_go:
    s_add_u32 m0, s57, 77824
    s_add_u32 s56, s56, 4096
    buffer_load_dwordx4 v1, s[4:7], s56 offen sc1 lds
    v_mul_f32 v124, 3216550459, v124
    v_mul_f32 v112, 986500301, v162
    v_mfma_f32_16x16x32_bf16 v[36:39], a[176:179], v[84:87], v[36:39]
    s_waitcnt lgkmcnt(2)
    v_mul_f32 v120, 986500301, v163
    v_fma_f32 v120, -v112, v112, v120
    v_mfma_f32_16x16x32_bf16 v[16:19], a[180:183], v[88:91], v[16:19]
    ds_read_b128 v[72:75], v1 offset:34816
    v_max_f32 v120, 0, v120
    v_add_f32 v120, 925353388, v120
    v_mfma_f32_16x16x32_bf16 v[28:31], a[180:183], v[92:95], v[28:31]
    ds_read_b128 v[76:79], v1 offset:35840
    v_rsq_f32_e64 v128, v120
    v_mfma_f32_16x16x32_bf16 v[20:23], a[184:187], v[88:91], v[20:23]
    s_add_u32 m0, s57, 81920
    s_add_u32 s56, s56, 4096
    buffer_load_dwordx4 v1, s[4:7], s56 offen sc1 lds
    v_mul_f32 v128, 3216550459, v128
    v_mov_b32_e64 v110, v108
    v_mfma_f32_16x16x32_bf16 v[32:35], a[184:187], v[92:95], v[32:35]
    s_add_u32 m0, s57, 86016
    s_add_u32 s56, s56, 4096
    buffer_load_dwordx4 v1, s[4:7], s56 offen sc1 lds
    v_mov_b32 v114, v112
    v_mov_b32 v118, v116
    v_mfma_f32_16x16x32_bf16 v[24:27], a[188:191], v[88:91], v[24:27]
    v_mov_b32 v122, v120
    v_mov_b32 v126, v124
    v_mfma_f32_16x16x32_bf16 v[36:39], a[188:191], v[92:95], v[36:39]
    s_waitcnt lgkmcnt(2)
    v_mov_b32 v130, v128
    v_mfma_f32_16x16x32_bf16 v[16:19], a[192:195], v[64:67], v[16:19]
    ds_read_b128 v[80:83], v1 offset:36864
    v_permlane32_swap_b32_e64 v108, v110
    v_mfma_f32_16x16x32_bf16 v[28:31], a[192:195], v[68:71], v[28:31]
    ds_read_b128 v[84:87], v1 offset:37888
    v_permlane32_swap_b32_e64 v112, v114
    v_mfma_f32_16x16x32_bf16 v[20:23], a[196:199], v[64:67], v[20:23]
    s_add_u32 m0, s57, 90112
    s_add_u32 s56, s56, 4096
    buffer_load_dwordx4 v1, s[4:7], s56 offen sc1 lds
    v_permlane32_swap_b32 v116, v118
    v_mfma_f32_16x16x32_bf16 v[32:35], a[196:199], v[68:71], v[32:35]
    v_permlane32_swap_b32 v120, v122
    v_mfma_f32_16x16x32_bf16 v[24:27], a[200:203], v[64:67], v[24:27]
    v_permlane32_swap_b32 v124, v126
    v_mfma_f32_16x16x32_bf16 v[36:39], a[200:203], v[68:71], v[36:39]
    s_waitcnt lgkmcnt(2)
    v_permlane32_swap_b32_e64 v128, v130
    v_mfma_f32_16x16x32_bf16 v[16:19], a[204:207], v[72:75], v[16:19]
    ds_read_b128 v[88:91], v1 offset:38912
    v_mov_b32 v109, v108
    v_mov_b32 v111, v110
    v_mfma_f32_16x16x32_bf16 v[28:31], a[204:207], v[76:79], v[28:31]
    ds_read_b128 v[92:95], v1 offset:39936
    v_mov_b32 v113, v112
    v_mov_b32 v115, v114
    v_mfma_f32_16x16x32_bf16 v[20:23], a[208:211], v[72:75], v[20:23]
    s_add_u32 m0, s57, 94208
    s_add_u32 s56, s56, 4096
    buffer_load_dwordx4 v1, s[4:7], s56 offen sc1 lds
    v_mov_b32 v117, v116
    v_mov_b32 v119, v118
    v_mfma_f32_16x16x32_bf16 v[32:35], a[208:211], v[76:79], v[32:35]
    s_add_u32 m0, s57, 98304
    s_add_u32 s56, s56, 4096
    buffer_load_dwordx4 v1, s[4:7], s56 offen sc1 lds
    v_mov_b32 v121, v120
    v_mov_b32 v123, v122
    v_mfma_f32_16x16x32_bf16 v[24:27], a[212:215], v[72:75], v[24:27]
    v_mov_b32 v125, v124
    v_mov_b32 v127, v126
    v_mfma_f32_16x16x32_bf16 v[36:39], a[212:215], v[76:79], v[36:39]
    s_waitcnt lgkmcnt(2)
    v_mov_b32 v129, v128
    v_mov_b32 v131, v130
    v_mfma_f32_16x16x32_bf16 v[16:19], a[216:219], v[80:83], v[16:19]
    s_waitcnt vmcnt(17)
    s_barrier
    v_permlane16_swap_b32 v108, v109
    v_mfma_f32_16x16x32_bf16 v[28:31], a[216:219], v[84:87], v[28:31]
    ds_read_b128 v[64:67], v1 offset:40960
    v_permlane16_swap_b32_e64 v110, v111
    v_mfma_f32_16x16x32_bf16 v[20:23], a[220:223], v[80:83], v[20:23]
    ds_read_b128 v[68:71], v1 offset:41984
    v_permlane16_swap_b32_e64 v112, v113
    v_mfma_f32_16x16x32_bf16 v[32:35], a[220:223], v[84:87], v[32:35]
    s_add_u32 m0, s57, 102400
    s_add_u32 s56, s56, 4096
    buffer_load_dwordx4 v1, s[4:7], s56 offen sc1 lds
    v_permlane16_swap_b32_e64 v114, v115
    v_mfma_f32_16x16x32_bf16 v[24:27], a[224:227], v[80:83], v[24:27]
    s_add_u32 m0, s57, 106496
    s_add_u32 s56, s56, 4096
    buffer_load_dwordx4 v1, s[4:7], s56 offen sc1 lds
    v_permlane16_swap_b32 v116, v117
    v_mfma_f32_16x16x32_bf16 v[36:39], a[224:227], v[84:87], v[36:39]
    s_waitcnt lgkmcnt(2)
    s_waitcnt vmcnt(18)
    v_permlane16_swap_b32 v118, v119
    v_mfma_f32_16x16x32_bf16 v[16:19], a[228:231], v[88:91], v[16:19]
    ds_read_b128 v[72:75], v1 offset:43008
    v_permlane16_swap_b32 v120, v121
    v_mfma_f32_16x16x32_bf16 v[28:31], a[228:231], v[92:95], v[28:31]
    s_waitcnt vmcnt(17)
    ds_read_b128 v[76:79], v1 offset:44032
    v_permlane16_swap_b32_e64 v122, v123
    v_mfma_f32_16x16x32_bf16 v[20:23], a[232:235], v[88:91], v[20:23]
    s_add_u32 m0, s57, 110592
    s_add_u32 s56, s56, 4096
    buffer_load_dwordx4 v1, s[4:7], s56 offen sc1 lds
    v_permlane16_swap_b32 v124, v125
    v_mfma_f32_16x16x32_bf16 v[32:35], a[232:235], v[92:95], v[32:35]
    s_waitcnt vmcnt(17)
    v_permlane16_swap_b32 v126, v127
    v_mfma_f32_16x16x32_bf16 v[24:27], a[236:239], v[88:91], v[24:27]
    v_permlane16_swap_b32 v128, v129
    v_mfma_f32_16x16x32_bf16 v[36:39], a[236:239], v[92:95], v[36:39]
    s_waitcnt lgkmcnt(2)
    v_permlane16_swap_b32 v130, v131
    v_mfma_f32_16x16x32_bf16 v[40:43], a[0:3], v[64:67], 0
    ds_read_b128 v[80:83], v1 offset:45056
    v_mfma_f32_16x16x32_bf16 v[52:55], a[0:3], v[68:71], 0
    ds_read_b128 v[84:87], v1 offset:46080
    v_mfma_f32_16x16x32_bf16 v[44:47], a[4:7], v[64:67], 0
    s_add_u32 m0, s57, 114688
    s_add_u32 s56, s56, 4096
    buffer_load_dwordx4 v1, s[4:7], s56 offen sc1 lds
    v_mfma_f32_16x16x32_bf16 v[56:59], a[4:7], v[68:71], 0
    s_add_u32 m0, s57, 118784
    s_add_u32 s56, s56, 4096
    buffer_load_dwordx4 v1, s[4:7], s56 offen sc1 lds
    v_mfma_f32_16x16x32_bf16 v[48:51], a[8:11], v[64:67], 0
    s_waitcnt vmcnt(17)
    v_cmp_ne_u32 vcc, 48, v156
    s_mov_b32 s69, 1048576
    s_cbranch_vccz Lpollx_51
Lpoll_50:
    s_sleep 32
    buffer_load_dword v156, v155, s[4:7], 0 offen sc1
    s_sub_u32 s69, s69, 1
    s_waitcnt vmcnt(0)
    s_cbranch_scc1 Lpollx_51
    v_cmp_ne_u32 vcc, 48, v156
    s_cbranch_vccnz Lpoll_50
Lpollx_51:
    v_mfma_f32_16x16x32_bf16 v[60:63], a[8:11], v[68:71], 0
    s_waitcnt lgkmcnt(2)
    v_mfma_f32_16x16x32_bf16 v[40:43], a[12:15], v[72:75], v[40:43]
    ds_read_b128 v[88:91], v1 offset:47104
    v_fma_f32 v16, -v108, v96, v16
    v_fma_f32 v17, -v108, v97, v17
    v_mfma_f32_16x16x32_bf16 v[52:55], a[12:15], v[76:79], v[52:55]
    ds_read_b128 v[92:95], v1 offset:48128
    v_fma_f32 v18, -v108, v98, v18
    v_fma_f32 v19, -v108, v99, v19
    v_mfma_f32_16x16x32_bf16 v[44:47], a[16:19], v[72:75], v[44:47]
    s_lshl_b32 s51, s31, 2
    s_add_u32 s51, s51, s22
    s_mul_i32 s51, s51, 61440
    s_add_u32 s51, s51, 8388608
    buffer_load_dwordx4 a[240:243], v1, s[4:7], s51 offen offset:0 sc1
    v_mul_f32 v148, v16, v124
    v_mul_f32 v149, v17, v124
    v_mfma_f32_16x16x32_bf16 v[56:59], a[16:19], v[76:79], v[56:59]
    buffer_load_dwordx4 a[244:247], v1, s[4:7], s51 offen offset:1024 sc1
    v_exp_f32 v148, v148
    v_mfma_f32_16x16x32_bf16 v[48:51], a[20:23], v[72:75], v[48:51]
    v_exp_f32 v149, v149
    v_mfma_f32_16x16x32_bf16 v[60:63], a[20:23], v[76:79], v[60:63]
    s_waitcnt lgkmcnt(2)
    v_mul_f32 v16, v16, v18
    v_mul_f32 v17, v17, v19
    v_mfma_f32_16x16x32_bf16 v[40:43], a[24:27], v[80:83], v[40:43]
    s_waitcnt vmcnt(16)
    s_barrier
    v_fma_f32 v148, v148, v116, v116
    v_fma_f32 v149, v149, v116, v116
    v_mfma_f32_16x16x32_bf16 v[52:55], a[24:27], v[84:87], v[52:55]
    ds_read_b128 v[64:67], v1 offset:49152
    v_rcp_f32 v148, v148
    v_mfma_f32_16x16x32_bf16 v[44:47], a[28:31], v[80:83], v[44:47]
    ds_read_b128 v[68:71], v1 offset:50176
    v_rcp_f32_e64 v149, v149
    v_mfma_f32_16x16x32_bf16 v[56:59], a[28:31], v[84:87], v[56:59]
    buffer_load_dwordx4 a[248:251], v1, s[4:7], s51 offen offset:2048 sc1
    v_mul_f32 v16, v16, v148
    v_mul_f32 v17, v17, v149
    v_mfma_f32_16x16x32_bf16 v[48:51], a[32:35], v[80:83], v[48:51]
    buffer_load_dwordx4 a[252:255], v1, s[4:7], s51 offen offset:3072 sc1
    v_cvt_pk_bf16_f32 v132, v16, v17
    v_fma_f32 v28, -v109, v96, v28
    v_mfma_f32_16x16x32_bf16 v[60:63], a[32:35], v[84:87], v[60:63]
    s_waitcnt lgkmcnt(2)
    v_fma_f32 v29, -v109, v97, v29
    v_fma_f32 v30, -v109, v98, v30
    v_mfma_f32_16x16x32_bf16 v[40:43], a[36:39], v[88:91], v[40:43]
    ds_read_b128 v[72:75], v1 offset:51200
    v_fma_f32 v31, -v109, v99, v31
    v_mul_f32 v150, v28, v125
    v_mfma_f32_16x16x32_bf16 v[52:55], a[36:39], v[92:95], v[52:55]
    ds_read_b128 v[76:79], v1 offset:52224
    v_mul_f32_e64 v151, v29, v125
    v_mfma_f32_16x16x32_bf16 v[44:47], a[40:43], v[88:91], v[44:47]
    s_add_u32 s51, s51, 4096
    buffer_load_dwordx4 v[252:255], v1, s[4:7], s51 offen offset:0 sc1
    v_exp_f32 v150, v150
    v_mfma_f32_16x16x32_bf16 v[56:59], a[40:43], v[92:95], v[56:59]
    v_exp_f32 v151, v151
    v_mfma_f32_16x16x32_bf16 v[48:51], a[44:47], v[88:91], v[48:51]
    v_mul_f32 v28, v28, v30
    v_mul_f32 v29, v29, v31
    v_mfma_f32_16x16x32_bf16 v[60:63], a[44:47], v[92:95], v[60:63]
    s_waitcnt lgkmcnt(2)
    v_fma_f32 v150, v150, v117, v117
    v_fma_f32 v151, v151, v117, v117
    v_mfma_f32_16x16x32_bf16 v[40:43], a[48:51], v[64:67], v[40:43]
    ds_read_b128 v[80:83], v1 offset:53248
    v_rcp_f32 v150, v150
    v_mfma_f32_16x16x32_bf16 v[52:55], a[48:51], v[68:71], v[52:55]
    ds_read_b128 v[84:87], v1 offset:54272
    v_rcp_f32_e64 v151, v151
    v_mfma_f32_16x16x32_bf16 v[44:47], a[52:55], v[64:67], v[44:47]
    buffer_load_dwordx4 v[248:251], v1, s[4:7], s51 offen offset:1024 sc1
    v_mul_f32 v28, v28, v150
    v_mul_f32 v29, v29, v151
    v_mfma_f32_16x16x32_bf16 v[56:59], a[52:55], v[68:71], v[56:59]
    buffer_load_dwordx4 v[244:247], v1, s[4:7], s51 offen offset:2048 sc1
    v_cvt_pk_bf16_f32 v133, v28, v29
    v_mfma_f32_16x16x32_bf16 v[48:51], a[56:59], v[64:67], v[48:51]
    s_nop 0
    v_permlane16_swap_b32 v132, v133
    v_mfma_f32_16x16x32_bf16 v[60:63], a[56:59], v[68:71], v[60:63]
    s_waitcnt lgkmcnt(2)
    v_fma_f32 v20, -v108, v100, v20
    v_fma_f32 v21, -v108, v101, v21
    v_mfma_f32_16x16x32_bf16 v[40:43], a[60:63], v[72:75], v[40:43]
    ds_read_b128 v[88:91], v1 offset:55296
    v_fma_f32 v22, -v108, v102, v22
    v_fma_f32 v23, -v108, v103, v23
    v_mfma_f32_16x16x32_bf16 v[52:55], a[60:63], v[76:79], v[52:55]
    ds_read_b128 v[92:95], v1 offset:56320
    v_mul_f32 v148, v20, v124
    v_mul_f32_e64 v149, v21, v124
    v_mfma_f32_16x16x32_bf16 v[44:47], a[64:67], v[72:75], v[44:47]
    buffer_load_dwordx4 v[240:243], v1, s[4:7], s51 offen offset:3072 sc1
    v_exp_f32_e64 v148, v148
    v_mfma_f32_16x16x32_bf16 v[56:59], a[64:67], v[76:79], v[56:59]
    s_add_u32 s51, s51, 4096
    buffer_load_dwordx4 v[236:239], v1, s[4:7], s51 offen offset:0 sc1
    v_exp_f32 v149, v149
    v_mfma_f32_16x16x32_bf16 v[48:51], a[68:71], v[72:75], v[48:51]
    v_mul_f32 v20, v20, v22
    v_mul_f32 v21, v21, v23
    v_mfma_f32_16x16x32_bf16 v[60:63], a[68:71], v[76:79], v[60:63]
    s_waitcnt lgkmcnt(2)
    v_fma_f32 v148, v148, v116, v116
    v_fma_f32 v149, v149, v116, v116
    v_mfma_f32_16x16x32_bf16 v[40:43], a[72:75], v[80:83], v[40:43]
    ds_read_b128 v[64:67], v1 offset:57344
    v_rcp_f32_e64 v148, v148
    v_mfma_f32_16x16x32_bf16 v[52:55], a[72:75], v[84:87], v[52:55]
    ds_read_b128 v[68:71], v1 offset:58368
    v_rcp_f32_e64 v149, v149
    v_mfma_f32_16x16x32_bf16 v[44:47], a[76:79], v[80:83], v[44:47]
    buffer_load_dwordx4 v[232:235], v1, s[4:7], s51 offen offset:1024 sc1
    v_mul_f32 v20, v20, v148
    v_mul_f32 v21, v21, v149
    v_mfma_f32_16x16x32_bf16 v[56:59], a[76:79], v[84:87], v[56:59]
    v_cvt_pk_bf16_f32 v134, v20, v21
    v_fma_f32 v32, -v109, v100, v32
    v_mfma_f32_16x16x32_bf16 v[48:51], a[80:83], v[80:83], v[48:51]
    v_fma_f32 v33, -v109, v101, v33
    v_fma_f32 v34, -v109, v102, v34
    v_mfma_f32_16x16x32_bf16 v[60:63], a[80:83], v[84:87], v[60:63]
    s_waitcnt lgkmcnt(2)
    v_fma_f32 v35, -v109, v103, v35
    v_mul_f32 v150, v32, v125
    v_mfma_f32_16x16x32_bf16 v[40:43], a[84:87], v[88:91], v[40:43]
    ds_read_b128 v[72:75], v1 offset:59392
    v_mul_f32_e64 v151, v33, v125
    v_mfma_f32_16x16x32_bf16 v[52:55], a[84:87], v[92:95], v[52:55]
    ds_read_b128 v[76:79], v1 offset:60416
    v_exp_f32_e64 v150, v150
    v_mfma_f32_16x16x32_bf16 v[44:47], a[88:91], v[88:91], v[44:47]
    buffer_load_dwordx4 v[228:231], v1, s[4:7], s51 offen offset:2048 sc1
    v_exp_f32_e64 v151, v151
    v_mfma_f32_16x16x32_bf16 v[56:59], a[88:91], v[92:95], v[56:59]
    buffer_load_dwordx4 v[224:227], v1, s[4:7], s51 offen offset:3072 sc1
    v_mul_f32 v32, v32, v34
    v_mul_f32 v33, v33, v35
    v_mfma_f32_16x16x32_bf16 v[48:51], a[92:95], v[88:91], v[48:51]
    v_fma_f32 v150, v150, v117, v117
    v_fma_f32 v151, v151, v117, v117
    v_mfma_f32_16x16x32_bf16 v[60:63], a[92:95], v[92:95], v[60:63]
    s_waitcnt lgkmcnt(2)
    v_rcp_f32 v150, v150
    v_mfma_f32_16x16x32_bf16 v[40:43], a[96:99], v[64:67], v[40:43]
    ds_read_b128 v[80:83], v1 offset:61440
    v_rcp_f32_e64 v151, v151
    v_mfma_f32_16x16x32_bf16 v[52:55], a[96:99], v[68:71], v[52:55]
    ds_read_b128 v[84:87], v1 offset:62464
    v_mul_f32 v32, v32, v150
    v_mul_f32 v33, v33, v151
    v_mfma_f32_16x16x32_bf16 v[44:47], a[100:103], v[64:67], v[44:47]
    s_add_u32 s51, s51, 4096
    buffer_load_dwordx4 v[220:223], v1, s[4:7], s51 offen offset:0 sc1
    v_cvt_pk_bf16_f32 v135, v32, v33
    v_mfma_f32_16x16x32_bf16 v[56:59], a[100:103], v[68:71], v[56:59]
    buffer_load_dwordx4 v[216:219], v1, s[4:7], s51 offen offset:1024 sc1
    v_permlane16_swap_b32 v134, v135
    v_mfma_f32_16x16x32_bf16 v[48:51], a[104:107], v[64:67], v[48:51]
    s_nop 0
    v_permlane32_swap_b32 v132, v134
    v_mfma_f32_16x16x32_bf16 v[60:63], a[104:107], v[68:71], v[60:63]
    s_waitcnt lgkmcnt(2)
    v_permlane32_swap_b32_e64 v133, v135
    v_mfma_f32_16x16x32_bf16 v[40:43], a[108:111], v[72:75], v[40:43]
    ds_read_b128 v[88:91], v1 offset:63488
    v_fma_f32 v24, -v108, v104, v24
    v_fma_f32 v25, -v108, v105, v25
    v_mfma_f32_16x16x32_bf16 v[52:55], a[108:111], v[76:79], v[52:55]
    ds_read_b128 v[92:95], v1 offset:64512
    v_fma_f32 v26, -v108, v106, v26
    v_fma_f32 v27, -v108, v107, v27
    v_mfma_f32_16x16x32_bf16 v[44:47], a[112:115], v[72:75], v[44:47]
    s_add_u32 m0, s57, 122880
    s_add_u32 s56, s56, 4096
    buffer_load_dwordx4 v1, s[4:7], s56 offen sc1 lds
    v_mul_f32 v148, v24, v124
    v_mul_f32 v149, v25, v124
    v_mfma_f32_16x16x32_bf16 v[56:59], a[112:115], v[76:79], v[56:59]
    v_exp_f32 v148, v148
    v_mfma_f32_16x16x32_bf16 v[48:51], a[116:119], v[72:75], v[48:51]
    v_exp_f32 v149, v149
    v_mfma_f32_16x16x32_bf16 v[60:63], a[116:119], v[76:79], v[60:63]
    s_waitcnt lgkmcnt(2)
    v_mul_f32 v24, v24, v26
    v_mul_f32 v25, v25, v27
    v_mfma_f32_16x16x32_bf16 v[40:43], a[120:123], v[80:83], v[40:43]
    s_waitcnt vmcnt(23)
    s_barrier
    v_fma_f32 v148, v148, v116, v116
    v_fma_f32 v149, v149, v116, v116
    v_mfma_f32_16x16x32_bf16 v[52:55], a[120:123], v[84:87], v[52:55]
    ds_read_b128 v[64:67], v153 offset:0
    v_rcp_f32 v148, v148
    v_mfma_f32_16x16x32_bf16 v[44:47], a[124:127], v[80:83], v[44:47]
    ds_read_b128 v[68:71], v153 offset:1024
    v_rcp_f32 v149, v149
    v_mfma_f32_16x16x32_bf16 v[56:59], a[124:127], v[84:87], v[56:59]
    v_mul_f32 v24, v24, v148
    v_mul_f32_e64 v25, v25, v149
    v_mfma_f32_16x16x32_bf16 v[48:51], a[128:131], v[80:83], v[48:51]
    v_cvt_pk_bf16_f32 v136, v24, v25
    v_fma_f32 v36, -v109, v104, v36
    v_mfma_f32_16x16x32_bf16 v[60:63], a[128:131], v[84:87], v[60:63]
    s_waitcnt lgkmcnt(2)
    v_fma_f32 v37, -v109, v105, v37
    v_fma_f32 v38, -v109, v106, v38
    v_mfma_f32_16x16x32_bf16 v[40:43], a[132:135], v[88:91], v[40:43]
    ds_read_b128 v[72:75], v153 offset:2048
    v_fma_f32 v39, -v109, v107, v39
    v_mul_f32 v150, v36, v125
    v_mfma_f32_16x16x32_bf16 v[52:55], a[132:135], v[92:95], v[52:55]
    ds_read_b128 v[76:79], v153 offset:3072
    v_mul_f32 v151, v37, v125
    v_mfma_f32_16x16x32_bf16 v[44:47], a[136:139], v[88:91], v[44:47]
    v_exp_f32 v150, v150
    v_mfma_f32_16x16x32_bf16 v[56:59], a[136:139], v[92:95], v[56:59]
    v_exp_f32 v151, v151
    v_mfma_f32_16x16x32_bf16 v[48:51], a[140:143], v[88:91], v[48:51]
    v_mul_f32 v36, v36, v38
    v_mul_f32 v37, v37, v39
    v_mfma_f32_16x16x32_bf16 v[60:63], a[140:143], v[92:95], v[60:63]
    s_waitcnt lgkmcnt(2)
    v_fma_f32 v150, v150, v117, v117
    v_fma_f32 v151, v151, v117, v117
    v_mfma_f32_16x16x32_bf16 v[40:43], a[144:147], v[64:67], v[40:43]
    ds_read_b128 v[80:83], v153 offset:4096
    v_rcp_f32_e64 v150, v150
    v_mfma_f32_16x16x32_bf16 v[52:55], a[144:147], v[68:71], v[52:55]
    ds_read_b128 v[84:87], v153 offset:5120
    v_rcp_f32 v151, v151
    v_mfma_f32_16x16x32_bf16 v[44:47], a[148:151], v[64:67], v[44:47]
    v_mul_f32 v36, v36, v150
    v_mul_f32_e64 v37, v37, v151
    v_mfma_f32_16x16x32_bf16 v[56:59], a[148:151], v[68:71], v[56:59]
    v_cvt_pk_bf16_f32 v137, v36, v37
    v_mfma_f32_16x16x32_bf16 v[48:51], a[152:155], v[64:67], v[48:51]
    s_nop 0
    v_permlane16_swap_b32 v136, v137
    v_mfma_f32_16x16x32_bf16 v[60:63], a[152:155], v[68:71], v[60:63]
    s_waitcnt lgkmcnt(2)
    v_permlane32_swap_b32 v136, v138
    v_mfma_f32_16x16x32_bf16 v[40:43], a[156:159], v[72:75], v[40:43]
    ds_read_b128 v[88:91], v153 offset:6144
    v_permlane32_swap_b32_e64 v137, v139
    v_mfma_f32_16x16x32_bf16 v[52:55], a[156:159], v[76:79], v[52:55]
    ds_read_b128 v[92:95], v153 offset:7168
    buffer_store_dwordx4 v[132:135], v152, s[4:7], s60 offen sc1
    s_mov_b32 exec_hi, 0
    buffer_store_dwordx4 v[136:139], v152, s[4:7], s60 offen offset:512 sc1
    s_mov_b32 exec_hi, -1
    v_mfma_f32_16x16x32_bf16 v[44:47], a[160:163], v[72:75], v[44:47]
    s_add_u32 s60, s60, 98304
    v_mfma_f32_16x16x32_bf16 v[56:59], a[160:163], v[76:79], v[56:59]
    v_mfma_f32_16x16x32_bf16 v[48:51], a[164:167], v[72:75], v[48:51]
    v_mfma_f32_16x16x32_bf16 v[60:63], a[164:167], v[76:79], v[60:63]
    s_waitcnt lgkmcnt(2)
    v_mfma_f32_16x16x32_bf16 v[40:43], a[168:171], v[80:83], v[40:43]
    ds_read_b128 v[64:67], v153 offset:8192
    v_mfma_f32_16x16x32_bf16 v[52:55], a[168:171], v[84:87], v[52:55]
    ds_read_b128 v[68:71], v153 offset:9216
    v_mfma_f32_16x16x32_bf16 v[44:47], a[172:175], v[80:83], v[44:47]
    s_add_u32 m0, s57, 126976
    s_add_u32 s56, s56, 4096
    buffer_load_dwordx4 v1, s[4:7], s56 offen sc1 lds
    v_mfma_f32_16x16x32_bf16 v[56:59], a[172:175], v[84:87], v[56:59]
    v_mfma_f32_16x16x32_bf16 v[48:51], a[176:179], v[80:83], v[48:51]
    v_mfma_f32_16x16x32_bf16 v[60:63], a[176:179], v[84:87], v[60:63]
    s_waitcnt lgkmcnt(2)
    v_mfma_f32_16x16x32_bf16 v[40:43], a[180:183], v[88:91], v[40:43]
    ds_read_b128 v[72:75], v153 offset:10240
    v_mfma_f32_16x16x32_bf16 v[52:55], a[180:183], v[92:95], v[52:55]
    ds_read_b128 v[76:79], v153 offset:11264
    v_mfma_f32_16x16x32_bf16 v[44:47], a[184:187], v[88:91], v[44:47]
    s_add_u32 m0, s57, 131072
    s_add_u32 s56, s56, 4096
    buffer_load_dwordx4 v1, s[4:7], s56 offen sc1 lds
    v_mfma_f32_16x16x32_bf16 v[56:59], a[184:187], v[92:95], v[56:59]
    s_add_u32 m0, s57, 135168
    s_add_u32 s56, s56, 4096
    buffer_load_dwordx4 v1, s[4:7], s56 offen sc1 lds
    v_mfma_f32_16x16x32_bf16 v[48:51], a[188:191], v[88:91], v[48:51]
    v_mfma_f32_16x16x32_bf16 v[60:63], a[188:191], v[92:95], v[60:63]
    s_waitcnt lgkmcnt(2)
    v_mfma_f32_16x16x32_bf16 v[40:43], a[192:195], v[64:67], v[40:43]
    ds_read_b128 v[80:83], v153 offset:12288
    v_mfma_f32_16x16x32_bf16 v[52:55], a[192:195], v[68:71], v[52:55]
    ds_read_b128 v[84:87], v153 offset:13312
    v_mfma_f32_16x16x32_bf16 v[44:47], a[196:199], v[64:67], v[44:47]
    buffer_load_dwordx4 v[212:215], v1, s[4:7], s51 offen offset:2048 sc1
    v_mfma_f32_16x16x32_bf16 v[56:59], a[196:199], v[68:71], v[56:59]
    buffer_load_dwordx4 v[208:211], v1, s[4:7], s51 offen offset:3072 sc1
    v_mfma_f32_16x16x32_bf16 v[48:51], a[200:203], v[64:67], v[48:51]
    v_mfma_f32_16x16x32_bf16 v[60:63], a[200:203], v[68:71], v[60:63]
    s_waitcnt lgkmcnt(2)
    v_mfma_f32_16x16x32_bf16 v[40:43], a[204:207], v[72:75], v[40:43]
    ds_read_b128 v[88:91], v153 offset:14336
    v_mfma_f32_16x16x32_bf16 v[52:55], a[204:207], v[76:79], v[52:55]
    ds_read_b128 v[92:95], v153 offset:15360
    v_mfma_f32_16x16x32_bf16 v[44:47], a[208:211], v[72:75], v[44:47]
    s_add_u32 s51, s51, 4096
    s_add_u32 m0, s64, 0
    s_nop 0
    buffer_load_dwordx4 v1, s[4:7], s51 offen offset:0 sc1 lds
    v_mfma_f32_16x16x32_bf16 v[56:59], a[208:211], v[76:79], v[56:59]
    v_mfma_f32_16x16x32_bf16 v[48:51], a[212:215], v[72:75], v[48:51]
    v_mfma_f32_16x16x32_bf16 v[60:63], a[212:215], v[76:79], v[60:63]
    s_waitcnt lgkmcnt(2)
    v_mfma_f32_16x16x32_bf16 v[40:43], a[216:219], v[80:83], v[40:43]
    ds_read_b128 v[64:67], v153 offset:16384
    v_mfma_f32_16x16x32_bf16 v[52:55], a[216:219], v[84:87], v[52:55]
    ds_read_b128 v[68:71], v153 offset:17408
    v_mfma_f32_16x16x32_bf16 v[44:47], a[220:223], v[80:83], v[44:47]
    s_add_u32 m0, s64, 0
    s_nop 0
    buffer_load_dwordx4 v1, s[4:7], s51 offen offset:1024 sc1 lds
    v_mfma_f32_16x16x32_bf16 v[56:59], a[220:223], v[84:87], v[56:59]
    s_add_u32 m0, s64, 0
    s_nop 0
    buffer_load_dwordx4 v1, s[4:7], s51 offen offset:2048 sc1 lds
    v_mfma_f32_16x16x32_bf16 v[48:51], a[224:227], v[80:83], v[48:51]
    v_mfma_f32_16x16x32_bf16 v[60:63], a[224:227], v[84:87], v[60:63]
    s_waitcnt lgkmcnt(2)
    v_mfma_f32_16x16x32_bf16 v[40:43], a[228:231], v[88:91], v[40:43]
    ds_read_b128 v[72:75], v153 offset:18432
    v_mfma_f32_16x16x32_bf16 v[52:55], a[228:231], v[92:95], v[52:55]
    ds_read_b128 v[76:79], v153 offset:19456
    v_mfma_f32_16x16x32_bf16 v[44:47], a[232:235], v[88:91], v[44:47]
    s_add_u32 m0, s64, 0
    s_nop 0
    buffer_load_dwordx4 v1, s[4:7], s51 offen offset:3072 sc1 lds
    v_mfma_f32_16x16x32_bf16 v[56:59], a[232:235], v[92:95], v[56:59]
    s_add_u32 s51, s51, 4096
    s_add_u32 m0, s64, 4096
    s_nop 0
    buffer_load_dwordx4 v1, s[4:7], s51 offen offset:0 sc1 lds
    v_mfma_f32_16x16x32_bf16 v[48:51], a[236:239], v[88:91], v[48:51]
    v_mfma_f32_16x16x32_bf16 v[60:63], a[236:239], v[92:95], v[60:63]
    s_waitcnt lgkmcnt(2)
    v_mfma_f32_16x16x32_bf16 v[16:19], a[0:3], v[64:67], 0
    ds_read_b128 v[80:83], v153 offset:20480
    v_mfma_f32_16x16x32_bf16 v[28:31], a[0:3], v[68:71], 0
    ds_read_b128 v[84:87], v153 offset:21504
    v_mfma_f32_16x16x32_bf16 v[20:23], a[4:7], v[64:67], 0
    s_add_u32 m0, s64, 4096
    s_nop 0
    buffer_load_dwordx4 v1, s[4:7], s51 offen offset:1024 sc1 lds
    v_mfma_f32_16x16x32_bf16 v[32:35], a[4:7], v[68:71], 0
    v_mfma_f32_16x16x32_bf16 v[24:27], a[8:11], v[64:67], 0
    v_mfma_f32_16x16x32_bf16 v[36:39], a[8:11], v[68:71], 0
    s_waitcnt lgkmcnt(2)
    v_mfma_f32_16x16x32_bf16 v[16:19], a[12:15], v[72:75], v[16:19]
    ds_read_b128 v[88:91], v153 offset:22528
    v_fma_f32 v40, -v110, v96, v40
    v_fma_f32 v41, -v110, v97, v41
    v_mfma_f32_16x16x32_bf16 v[28:31], a[12:15], v[76:79], v[28:31]
    ds_read_b128 v[92:95], v153 offset:23552
    v_fma_f32 v42, -v110, v98, v42
    v_fma_f32 v43, -v110, v99, v43
    v_mfma_f32_16x16x32_bf16 v[20:23], a[16:19], v[72:75], v[20:23]
    s_add_u32 m0, s64, 4096
    s_nop 0
    buffer_load_dwordx4 v1, s[4:7], s51 offen offset:2048 sc1 lds
    v_mul_f32 v148, v40, v126
    v_mul_f32_e64 v149, v41, v126
    v_mfma_f32_16x16x32_bf16 v[32:35], a[16:19], v[76:79], v[32:35]
    s_add_u32 m0, s64, 4096
    s_nop 0
    buffer_load_dwordx4 v1, s[4:7], s51 offen offset:3072 sc1 lds
    v_exp_f32 v148, v148
    v_mfma_f32_16x16x32_bf16 v[24:27], a[20:23], v[72:75], v[24:27]
    v_exp_f32 v149, v149
    v_mfma_f32_16x16x32_bf16 v[36:39], a[20:23], v[76:79], v[36:39]
    s_waitcnt lgkmcnt(2)
    v_mul_f32 v40, v40, v42
    v_mul_f32 v41, v41, v43
    v_mfma_f32_16x16x32_bf16 v[16:19], a[24:27], v[80:83], v[16:19]
    s_waitcnt vmcnt(32)
    s_barrier
    v_fma_f32 v148, v148, v118, v118
    v_fma_f32 v149, v149, v118, v118
    v_mfma_f32_16x16x32_bf16 v[28:31], a[24:27], v[84:87], v[28:31]
    ds_read_b128 v[64:67], v153 offset:24576
    v_rcp_f32_e64 v148, v148
    v_mfma_f32_16x16x32_bf16 v[20:23], a[28:31], v[80:83], v[20:23]
    ds_read_b128 v[68:71], v153 offset:25600
    v_rcp_f32_e64 v149, v149
    v_mfma_f32_16x16x32_bf16 v[32:35], a[28:31], v[84:87], v[32:35]
    s_add_u32 s51, s51, 4096
    s_add_u32 m0, s64, 8192
    s_nop 0
    buffer_load_dwordx4 v1, s[4:7], s51 offen offset:0 sc1 lds
    v_mul_f32 v40, v40, v148
    v_mul_f32_e64 v41, v41, v149
    v_mfma_f32_16x16x32_bf16 v[24:27], a[32:35], v[80:83], v[24:27]
    s_add_u32 m0, s64, 8192
    s_nop 0
    buffer_load_dwordx4 v1, s[4:7], s51 offen offset:1024 sc1 lds
    v_cvt_pk_bf16_f32 v132, v40, v41
    v_fma_f32 v52, -v111, v96, v52
    v_mfma_f32_16x16x32_bf16 v[36:39], a[32:35], v[84:87], v[36:39]
    s_waitcnt lgkmcnt(2)
    v_fma_f32 v53, -v111, v97, v53
    v_fma_f32 v54, -v111, v98, v54
    v_mfma_f32_16x16x32_bf16 v[16:19], a[36:39], v[88:91], v[16:19]
    ds_read_b128 v[72:75], v153 offset:26624
    v_fma_f32 v55, -v111, v99, v55
    v_mul_f32_e64 v150, v52, v127
    v_mfma_f32_16x16x32_bf16 v[28:31], a[36:39], v[92:95], v[28:31]
    ds_read_b128 v[76:79], v153 offset:27648
    v_mul_f32_e64 v151, v53, v127
    v_mfma_f32_16x16x32_bf16 v[20:23], a[40:43], v[88:91], v[20:23]
    s_add_u32 m0, s57, 139264
    s_add_u32 s56, s56, 4096
    buffer_load_dwordx4 v1, s[4:7], s56 offen sc1 lds
    v_exp_f32 v150, v150
    v_mfma_f32_16x16x32_bf16 v[32:35], a[40:43], v[92:95], v[32:35]
    s_waitcnt vmcnt(16)
    s_barrier
    s_cmp_lg_u32 s22, 0
    s_cbranch_scc1 Lsig_52
    s_add_u32 s42, s4, s65
    s_addc_u32 s43, s5, 0
    s_mov_b32 s70, 1
    s_atomic_add s70, s[42:43], 0
Lsig_52:
    v_exp_f32 v151, v151
    v_mfma_f32_16x16x32_bf16 v[24:27], a[44:47], v[88:91], v[24:27]
    v_mul_f32 v52, v52, v54
    v_mul_f32 v53, v53, v55
    v_mfma_f32_16x16x32_bf16 v[36:39], a[44:47], v[92:95], v[36:39]
    s_waitcnt lgkmcnt(2)
    v_fma_f32 v150, v150, v119, v119
    v_fma_f32 v151, v151, v119, v119
    v_mfma_f32_16x16x32_bf16 v[16:19], a[48:51], v[64:67], v[16:19]
    ds_read_b128 v[80:83], v153 offset:28672
    v_rcp_f32_e64 v150, v150
    v_mfma_f32_16x16x32_bf16 v[28:31], a[48:51], v[68:71], v[28:31]
    ds_read_b128 v[84:87], v153 offset:29696
    v_rcp_f32_e64 v151, v151
    v_mfma_f32_16x16x32_bf16 v[20:23], a[52:55], v[64:67], v[20:23]
    s_branch Lpg_join_3_go
.p2align 12
Lpg_join_3:
    s_setpc_b64 s[0:1]
.p2align 3
Lpg_join_3_go:
    s_add_u32 m0, s57, 143360
    s_add_u32 s56, s56, 4096
    buffer_load_dwordx4 v1, s[4:7], s56 offen sc1 lds
    v_mul_f32 v52, v52, v150
    v_mul_f32 v53, v53, v151
    v_mfma_f32_16x16x32_bf16 v[32:35], a[52:55], v[68:71], v[32:35]
    s_add_u32 m0, s57, 147456
    s_add_u32 s56, s56, 4096
    buffer_load_dwordx4 v1, s[4:7], s56 offen sc1 lds
    v_cvt_pk_bf16_f32 v133, v52, v53
    v_mfma_f32_16x16x32_bf16 v[24:27], a[56:59], v[64:67], v[24:27]
    s_nop 0
    v_permlane16_swap_b32 v132, v133
    v_mfma_f32_16x16x32_bf16 v[36:39], a[56:59], v[68:71], v[36:39]
    s_waitcnt lgkmcnt(2)
    v_fma_f32 v44, -v110, v100, v44
    v_fma_f32 v45, -v110, v101, v45
    v_mfma_f32_16x16x32_bf16 v[16:19], a[60:63], v[72:75], v[16:19]
    ds_read_b128 v[88:91], v153 offset:30720
    v_fma_f32 v46, -v110, v102, v46
    v_fma_f32 v47, -v110, v103, v47
    v_mfma_f32_16x16x32_bf16 v[28:31], a[60:63], v[76:79], v[28:31]
    ds_read_b128 v[92:95], v153 offset:31744
    v_mul_f32 v148, v44, v126
    v_mul_f32_e64 v149, v45, v126
    v_mfma_f32_16x16x32_bf16 v[20:23], a[64:67], v[72:75], v[20:23]
    s_add_u32 m0, s57, 151552
    s_add_u32 s56, s56, 4096
    buffer_load_dwordx4 v1, s[4:7], s56 offen sc1 lds
    v_exp_f32_e64 v148, v148
    v_mfma_f32_16x16x32_bf16 v[32:35], a[64:67], v[76:79], v[32:35]
    s_add_u32 m0, s57, 155648
    s_add_u32 s56, s56, 4096
    buffer_load_dwordx4 v1, s[4:7], s56 offen sc1 lds
    v_exp_f32 v149, v149
    v_mfma_f32_16x16x32_bf16 v[24:27], a[68:71], v[72:75], v[24:27]
    v_mul_f32 v44, v44, v46
    v_mul_f32 v45, v45, v47
    v_mfma_f32_16x16x32_bf16 v[36:39], a[68:71], v[76:79], v[36:39]
    s_waitcnt lgkmcnt(2)
    v_fma_f32 v148, v148, v118, v118
    v_fma_f32 v149, v149, v118, v118
    v_mfma_f32_16x16x32_bf16 v[16:19], a[72:75], v[80:83], v[16:19]
    ds_read_b128 v[64:67], v153 offset:32768
    v_rcp_f32_e64 v148, v148
    v_mfma_f32_16x16x32_bf16 v[28:31], a[72:75], v[84:87], v[28:31]
    ds_read_b128 v[68:71], v153 offset:33792
    v_rcp_f32_e64 v149, v149
    v_mfma_f32_16x16x32_bf16 v[20:23], a[76:79], v[80:83], v[20:23]
    s_add_u32 m0, s57, 159744
    s_add_u32 s56, s56, 4096
    buffer_load_dwordx4 v1, s[4:7], s56 offen sc1 lds
    v_mul_f32 v44, v44, v148
    v_mul_f32 v45, v45, v149
    v_mfma_f32_16x16x32_bf16 v[32:35], a[76:79], v[84:87], v[32:35]
    s_add_u32 m0, s64, 38912
    s_nop 0
    buffer_load_dwordx4 v1, s[4:7], s51 offen offset:2048 sc1 lds
    v_cvt_pk_bf16_f32 v134, v44, v45
    v_fma_f32 v56, -v111, v100, v56
    v_mfma_f32_16x16x32_bf16 v[24:27], a[80:83], v[80:83], v[24:27]
    v_fma_f32 v57, -v111, v101, v57
    v_fma_f32 v58, -v111, v102, v58
    v_mfma_f32_16x16x32_bf16 v[36:39], a[80:83], v[84:87], v[36:39]
    s_waitcnt lgkmcnt(2)
    v_fma_f32 v59, -v111, v103, v59
    v_mul_f32_e64 v150, v56, v127
    v_mfma_f32_16x16x32_bf16 v[16:19], a[84:87], v[88:91], v[16:19]
    ds_read_b128 v[72:75], v153 offset:34816
    v_mul_f32_e64 v151, v57, v127
    v_mfma_f32_16x16x32_bf16 v[28:31], a[84:87], v[92:95], v[28:31]
    ds_read_b128 v[76:79], v153 offset:35840
    v_exp_f32_e64 v150, v150
    v_mfma_f32_16x16x32_bf16 v[20:23], a[88:91], v[88:91], v[20:23]
    s_add_u32 m0, s64, 38912
    s_nop 0
    buffer_load_dwordx4 v1, s[4:7], s51 offen offset:3072 sc1 lds
    v_exp_f32 v151, v151
    v_mfma_f32_16x16x32_bf16 v[32:35], a[88:91], v[92:95], v[32:35]
    v_mul_f32 v56, v56, v58
    v_mul_f32 v57, v57, v59
    v_mfma_f32_16x16x32_bf16 v[24:27], a[92:95], v[88:91], v[24:27]
    v_fma_f32 v150, v150, v119, v119
    v_fma_f32 v151, v151, v119, v119
    v_mfma_f32_16x16x32_bf16 v[36:39], a[92:95], v[92:95], v[36:39]
    s_waitcnt lgkmcnt(2)
    v_rcp_f32 v150, v150
    v_mfma_f32_16x16x32_bf16 v[16:19], a[96:99], v[64:67], v[16:19]
    ds_read_b128 v[80:83], v153 offset:36864
    v_rcp_f32_e64 v151, v151
    v_mfma_f32_16x16x32_bf16 v[28:31], a[96:99], v[68:71], v[28:31]
    ds_read_b128 v[84:87], v153 offset:37888
    v_mul_f32 v56, v56, v150
    v_mul_f32 v57, v57, v151
    v_mfma_f32_16x16x32_bf16 v[20:23], a[100:103], v[64:67], v[20:23]
    s_add_u32 s51, s51, 4096
    s_add_u32 m0, s64, 43008
    s_nop 0
    buffer_load_dwordx4 v1, s[4:7], s51 offen offset:0 sc1 lds
    v_cvt_pk_bf16_f32 v135, v56, v57
    v_mfma_f32_16x16x32_bf16 v[32:35], a[100:103], v[68:71], v[32:35]
    s_add_u32 m0, s64, 43008
    s_nop 0
    buffer_load_dwordx4 v1, s[4:7], s51 offen offset:1024 sc1 lds
    v_permlane16_swap_b32 v134, v135
    v_mfma_f32_16x16x32_bf16 v[24:27], a[104:107], v[64:67], v[24:27]
    s_nop 0
    v_permlane32_swap_b32 v132, v134
    v_mfma_f32_16x16x32_bf16 v[36:39], a[104:107], v[68:71], v[36:39]
    s_waitcnt lgkmcnt(2)
    v_permlane32_swap_b32_e64 v133, v135
    v_mfma_f32_16x16x32_bf16 v[16:19], a[108:111], v[72:75], v[16:19]
    ds_read_b128 v[88:91], v153 offset:38912
    v_fma_f32 v48, -v110, v104, v48
    v_fma_f32 v49, -v110, v105, v49
    v_mfma_f32_16x16x32_bf16 v[28:31], a[108:111], v[76:79], v[28:31]
    ds_read_b128 v[92:95], v153 offset:39936
    v_fma_f32 v50, -v110, v106, v50
    v_fma_f32 v51, -v110, v107, v51
    v_mfma_f32_16x16x32_bf16 v[20:23], a[112:115], v[72:75], v[20:23]
    s_add_u32 m0, s64, 43008
    s_nop 0
    buffer_load_dwordx4 v1, s[4:7], s51 offen offset:2048 sc1 lds
    v_mul_f32 v148, v48, v126
    v_mul_f32_e64 v149, v49, v126
    v_mfma_f32_16x16x32_bf16 v[32:35], a[112:115], v[76:79], v[32:35]
    s_add_u32 m0, s64, 43008
    s_nop 0
    buffer_load_dwordx4 v1, s[4:7], s51 offen offset:3072 sc1 lds
    v_exp_f32 v148, v148
    v_mfma_f32_16x16x32_bf16 v[24:27], a[116:119], v[72:75], v[24:27]
    v_exp_f32 v149, v149
    v_mfma_f32_16x16x32_bf16 v[36:39], a[116:119], v[76:79], v[36:39]
    s_waitcnt lgkmcnt(2)
    v_mul_f32 v48, v48, v50
    v_mul_f32 v49, v49, v51
    v_mfma_f32_16x16x32_bf16 v[16:19], a[120:123], v[80:83], v[16:19]
    ds_read_b128 v[64:67], v153 offset:40960
    v_fma_f32 v148, v148, v118, v118
    v_fma_f32 v149, v149, v118, v118
    v_mfma_f32_16x16x32_bf16 v[28:31], a[120:123], v[84:87], v[28:31]
    ds_read_b128 v[68:71], v153 offset:41984
    v_rcp_f32 v148, v148
    v_mfma_f32_16x16x32_bf16 v[20:23], a[124:127], v[80:83], v[20:23]
    v_rcp_f32 v149, v149
    v_mfma_f32_16x16x32_bf16 v[32:35], a[124:127], v[84:87], v[32:35]
    v_mul_f32 v48, v48, v148
    v_mul_f32 v49, v49, v149
    v_mfma_f32_16x16x32_bf16 v[24:27], a[128:131], v[80:83], v[24:27]
    v_cvt_pk_bf16_f32 v136, v48, v49
    v_fma_f32 v60, -v111, v104, v60
    v_mfma_f32_16x16x32_bf16 v[36:39], a[128:131], v[84:87], v[36:39]
    s_waitcnt lgkmcnt(2)
    v_fma_f32 v61, -v111, v105, v61
    v_fma_f32 v62, -v111, v106, v62
    v_mfma_f32_16x16x32_bf16 v[16:19], a[132:135], v[88:91], v[16:19]
    ds_read_b128 v[72:75], v153 offset:43008
    v_fma_f32 v63, -v111, v107, v63
    v_mul_f32 v150, v60, v127
    v_mfma_f32_16x16x32_bf16 v[28:31], a[132:135], v[92:95], v[28:31]
    ds_read_b128 v[76:79], v153 offset:44032
    v_mul_f32 v151, v61, v127
    v_mfma_f32_16x16x32_bf16 v[20:23], a[136:139], v[88:91], v[20:23]
    v_exp_f32 v150, v150
    v_mfma_f32_16x16x32_bf16 v[32:35], a[136:139], v[92:95], v[32:35]
    v_exp_f32 v151, v151
    v_mfma_f32_16x16x32_bf16 v[24:27], a[140:143], v[88:91], v[24:27]
    v_mul_f32 v60, v60, v62
    v_mul_f32 v61, v61, v63
    v_mfma_f32_16x16x32_bf16 v[36:39], a[140:143], v[92:95], v[36:39]
    s_waitcnt lgkmcnt(2)
    v_fma_f32 v150, v150, v119, v119
    v_fma_f32 v151, v151, v119, v119
    v_mfma_f32_16x16x32_bf16 v[16:19], a[144:147], v[64:67], v[16:19]
    ds_read_b128 v[80:83], v153 offset:45056
    v_rcp_f32_e64 v150, v150
    v_mfma_f32_16x16x32_bf16 v[28:31], a[144:147], v[68:71], v[28:31]
    ds_read_b128 v[84:87], v153 offset:46080
    v_rcp_f32 v151, v151
    v_mfma_f32_16x16x32_bf16 v[20:23], a[148:151], v[64:67], v[20:23]
    s_lshl_b32 s66, s24, 8
    s_add_u32 s66, s66, 126976
    v_mov_b32 v155, s66
    buffer_load_dword v156, v155, s[4:7], 0 offen sc1
    v_mul_f32 v60, v60, v150
    v_mul_f32_e64 v61, v61, v151
    v_mfma_f32_16x16x32_bf16 v[32:35], a[148:151], v[68:71], v[32:35]
    v_cvt_pk_bf16_f32 v137, v60, v61
    v_mfma_f32_16x16x32_bf16 v[24:27], a[152:155], v[64:67], v[24:27]
    s_nop 0
    v_permlane16_swap_b32 v136, v137
    v_mfma_f32_16x16x32_bf16 v[36:39], a[152:155], v[68:71], v[36:39]
    s_waitcnt lgkmcnt(2)
    v_permlane32_swap_b32 v136, v138
    v_mfma_f32_16x16x32_bf16 v[16:19], a[156:159], v[72:75], v[16:19]
    ds_read_b128 v[88:91], v153 offset:47104
    v_permlane32_swap_b32_e64 v137, v139
    v_mfma_f32_16x16x32_bf16 v[28:31], a[156:159], v[76:79], v[28:31]
    ds_read_b128 v[92:95], v153 offset:48128
    buffer_store_dwordx4 v[132:135], v152, s[4:7], s60 offen sc1
    s_mov_b32 exec_hi, 0
    buffer_store_dwordx4 v[136:139], v152, s[4:7], s60 offen offset:512 sc1
    s_mov_b32 exec_hi, -1
    v_mfma_f32_16x16x32_bf16 v[20:23], a[160:163], v[72:75], v[20:23]
    s_add_u32 s60, s60, 98304
    v_mfma_f32_16x16x32_bf16 v[32:35], a[160:163], v[76:79], v[32:35]
    v_mfma_f32_16x16x32_bf16 v[24:27], a[164:167], v[72:75], v[24:27]
    v_mfma_f32_16x16x32_bf16 v[36:39], a[164:167], v[76:79], v[36:39]
    s_waitcnt lgkmcnt(2)
    v_mfma_f32_16x16x32_bf16 v[16:19], a[168:171], v[80:83], v[16:19]
    s_waitcnt vmcnt(27)
    s_barrier
    v_mfma_f32_16x16x32_bf16 v[28:31], a[168:171], v[84:87], v[28:31]
    ds_read_b128 v[64:67], v153 offset:49152
    v_mfma_f32_16x16x32_bf16 v[20:23], a[172:175], v[80:83], v[20:23]
    ds_read_b128 v[68:71], v153 offset:50176
    v_mfma_f32_16x16x32_bf16 v[32:35], a[172:175], v[84:87], v[32:35]
    s_add_u32 s51, s51, 4096
    s_add_u32 m0, s64, 47104
    s_nop 0
    buffer_load_dwordx4 v1, s[4:7], s51 offen offset:0 sc1 lds
    v_mfma_f32_16x16x32_bf16 v[24:27], a[176:179], v[80:83], v[24:27]
    v_mfma_f32_16x16x32_bf16 v[36:39], a[176:179], v[84:87], v[36:39]
    s_waitcnt lgkmcnt(2)
    v_mfma_f32_16x16x32_bf16 v[16:19], a[180:183], v[88:91], v[16:19]
    ds_read_b128 v[72:75], v153 offset:51200
    v_mfma_f32_16x16x32_bf16 v[28:31], a[180:183], v[92:95], v[28:31]
    ds_read_b128 v[76:79], v153 offset:52224
    v_mfma_f32_16x16x32_bf16 v[20:23], a[184:187], v[88:91], v[20:23]
    s_add_u32 m0, s64, 47104
    s_nop 0
    buffer_load_dwordx4 v1, s[4:7], s51 offen offset:1024 sc1 lds
    v_mfma_f32_16x16x32_bf16 v[32:35], a[184:187], v[92:95], v[32:35]
    s_add_u32 m0, s64, 47104
    s_nop 0
    buffer_load_dwordx4 v1, s[4:7], s51 offen offset:2048 sc1 lds
    v_mfma_f32_16x16x32_bf16 v[24:27], a[188:191], v[88:91], v[24:27]
    v_mfma_f32_16x16x32_bf16 v[36:39], a[188:191], v[92:95], v[36:39]
    s_waitcnt lgkmcnt(2)
    v_mfma_f32_16x16x32_bf16 v[16:19], a[192:195], v[64:67], v[16:19]
    ds_read_b128 v[80:83], v153 offset:53248
    v_mfma_f32_16x16x32_bf16 v[28:31], a[192:195], v[68:71], v[28:31]
    ds_read_b128 v[84:87], v153 offset:54272
    v_mfma_f32_16x16x32_bf16 v[20:23], a[196:199], v[64:67], v[20:23]
    s_add_u32 m0, s64, 47104
    s_nop 0
    buffer_load_dwordx4 v1, s[4:7], s51 offen offset:3072 sc1 lds
    v_mfma_f32_16x16x32_bf16 v[32:35], a[196:199], v[68:71], v[32:35]
    v_mfma_f32_16x16x32_bf16 v[24:27], a[200:203], v[64:67], v[24:27]
    v_mfma_f32_16x16x32_bf16 v[36:39], a[200:203], v[68:71], v[36:39]
    s_waitcnt lgkmcnt(2)
    v_mfma_f32_16x16x32_bf16 v[16:19], a[204:207], v[72:75], v[16:19]
    ds_read_b128 v[88:91], v153 offset:55296
    v_mfma_f32_16x16x32_bf16 v[28:31], a[204:207], v[76:79], v[28:31]
    ds_read_b128 v[92:95], v153 offset:56320
    v_mfma_f32_16x16x32_bf16 v[20:23], a[208:211], v[72:75], v[20:23]
    v_mfma_f32_16x16x32_bf16 v[32:35], a[208:211], v[76:79], v[32:35]
    v_mfma_f32_16x16x32_bf16 v[24:27], a[212:215], v[72:75], v[24:27]
    v_mfma_f32_16x16x32_bf16 v[36:39], a[212:215], v[76:79], v[36:39]
    s_waitcnt lgkmcnt(2)
    v_mfma_f32_16x16x32_bf16 v[16:19], a[216:219], v[80:83], v[16:19]
    ds_read_b128 v[64:67], v153 offset:57344
    v_mfma_f32_16x16x32_bf16 v[28:31], a[216:219], v[84:87], v[28:31]
    ds_read_b128 v[68:71], v153 offset:58368
    v_mfma_f32_16x16x32_bf16 v[20:23], a[220:223], v[80:83], v[20:23]
    s_waitcnt vmcnt(6)
    v_cmp_ne_u32 vcc, 16, v156
    s_mov_b32 s69, 1048576
    s_cbranch_vccz Lpollx_54
Lpoll_53:
    s_sleep 4
    buffer_load_dword v156, v155, s[4:7], 0 offen sc1
    s_sub_u32 s69, s69, 1
    s_waitcnt vmcnt(0)
    s_cbranch_scc1 Lpollx_54
    v_cmp_ne_u32 vcc, 16, v156
    s_cbranch_vccnz Lpoll_53
Lpollx_54:
    v_mfma_f32_16x16x32_bf16 v[32:35], a[220:223], v[84:87], v[32:35]
    v_mfma_f32_16x16x32_bf16 v[24:27], a[224:227], v[80:83], v[24:27]
    v_mfma_f32_16x16x32_bf16 v[36:39], a[224:227], v[84:87], v[36:39]
    s_waitcnt lgkmcnt(2)
    v_mfma_f32_16x16x32_bf16 v[16:19], a[228:231], v[88:91], v[16:19]
    ds_read_b128 v[72:75], v153 offset:59392
    v_mfma_f32_16x16x32_bf16 v[28:31], a[228:231], v[92:95], v[28:31]
    ds_read_b128 v[76:79], v153 offset:60416
    v_mfma_f32_16x16x32_bf16 v[20:23], a[232:235], v[88:91], v[20:23]
    buffer_load_dwordx4 v[160:163], v1, s[4:7], s52 offen offset:0 sc1
    v_mfma_f32_16x16x32_bf16 v[32:35], a[232:235], v[92:95], v[32:35]
    buffer_load_dwordx4 v[164:167], v1, s[4:7], s52 offen offset:1024 sc1
    v_mfma_f32_16x16x32_bf16 v[24:27], a[236:239], v[88:91], v[24:27]
    v_mfma_f32_16x16x32_bf16 v[36:39], a[236:239], v[92:95], v[36:39]
    s_waitcnt lgkmcnt(2)
    v_mfma_f32_16x16x32_bf16 v[40:43], a[0:3], v[64:67], 0
    ds_read_b128 v[80:83], v153 offset:61440
    v_mfma_f32_16x16x32_bf16 v[52:55], a[0:3], v[68:71], 0
    ds_read_b128 v[84:87], v153 offset:62464
    v_mfma_f32_16x16x32_bf16 v[44:47], a[4:7], v[64:67], 0
    buffer_load_dwordx4 v[168:171], v1, s[4:7], s52 offen offset:2048 sc1
    v_mfma_f32_16x16x32_bf16 v[56:59], a[4:7], v[68:71], 0
    buffer_load_dwordx4 v[172:175], v1, s[4:7], s52 offen offset:3072 sc1
    v_mfma_f32_16x16x32_bf16 v[48:51], a[8:11], v[64:67], 0
    v_mfma_f32_16x16x32_bf16 v[60:63], a[8:11], v[68:71], 0
    s_waitcnt lgkmcnt(2)
    v_mfma_f32_16x16x32_bf16 v[40:43], a[12:15], v[72:75], v[40:43]
    ds_read_b128 v[88:91], v153 offset:63488
    v_fma_f32 v16, -v112, v96, v16
    v_fma_f32 v17, -v112, v97, v17
    v_mfma_f32_16x16x32_bf16 v[52:55], a[12:15], v[76:79], v[52:55]
    ds_read_b128 v[92:95], v153 offset:64512
    v_fma_f32 v18, -v112, v98, v18
    v_fma_f32 v19, -v112, v99, v19
    v_mfma_f32_16x16x32_bf16 v[44:47], a[16:19], v[72:75], v[44:47]
    s_add_u32 s51, s51, 4096
    buffer_load_dwordx4 a[0:3], v1, s[4:7], s51 offen offset:0 sc1
    v_mul_f32 v148, v16, v128
    v_mul_f32 v149, v17, v128
    v_mfma_f32_16x16x32_bf16 v[56:59], a[16:19], v[76:79], v[56:59]
    v_exp_f32 v148, v148
    v_mfma_f32_16x16x32_bf16 v[48:51], a[20:23], v[72:75], v[48:51]
    v_exp_f32 v149, v149
    v_mfma_f32_16x16x32_bf16 v[60:63], a[20:23], v[76:79], v[60:63]
    s_waitcnt lgkmcnt(2)
    v_mul_f32 v16, v16, v18
    v_mul_f32 v17, v17, v19
    v_mfma_f32_16x16x32_bf16 v[40:43], a[24:27], v[80:83], v[40:43]
    ds_read_b128 v[64:67], v154 offset:0
    v_fma_f32 v148, v148, v120, v120
    v_fma_f32 v149, v149, v120, v120
    v_mfma_f32_16x16x32_bf16 v[52:55], a[24:27], v[84:87], v[52:55]
    ds_read_b128 v[68:71], v154 offset:1024
    v_rcp_f32_e64 v148, v148
    v_mfma_f32_16x16x32_bf16 v[44:47], a[28:31], v[80:83], v[44:47]
    s_add_u32 s52, s52, 4096
    buffer_load_dwordx4 v[176:179], v1, s[4:7], s52 offen offset:0 sc1
    v_rcp_f32_e64 v149, v149
    v_mfma_f32_16x16x32_bf16 v[56:59], a[28:31], v[84:87], v[56:59]
    buffer_load_dwordx4 v[180:183], v1, s[4:7], s52 offen offset:1024 sc1
    v_mul_f32 v16, v16, v148
    v_mul_f32 v17, v17, v149
    v_mfma_f32_16x16x32_bf16 v[48:51], a[32:35], v[80:83], v[48:51]
    v_cvt_pk_bf16_f32 v132, v16, v17
    v_fma_f32 v28, -v113, v96, v28
    v_mfma_f32_16x16x32_bf16 v[60:63], a[32:35], v[84:87], v[60:63]
    s_waitcnt lgkmcnt(2)
    v_fma_f32 v29, -v113, v97, v29
    v_fma_f32 v30, -v113, v98, v30
    v_mfma_f32_16x16x32_bf16 v[40:43], a[36:39], v[88:91], v[40:43]
    ds_read_b128 v[72:75], v154 offset:2048
    v_fma_f32 v31, -v113, v99, v31
    v_mul_f32 v150, v28, v129
    v_mfma_f32_16x16x32_bf16 v[52:55], a[36:39], v[92:95], v[52:55]
    ds_read_b128 v[76:79], v154 offset:3072
    v_mul_f32_e64 v151, v29, v129
    v_mfma_f32_16x16x32_bf16 v[44:47], a[40:43], v[88:91], v[44:47]
    buffer_load_dwordx4 v[184:187], v1, s[4:7], s52 offen offset:2048 sc1
    v_exp_f32_e64 v150, v150
    v_mfma_f32_16x16x32_bf16 v[56:59], a[40:43], v[92:95], v[56:59]
    buffer_load_dwordx4 v[188:191], v1, s[4:7], s52 offen offset:3072 sc1
    v_exp_f32 v151, v151
    v_mfma_f32_16x16x32_bf16 v[48:51], a[44:47], v[88:91], v[48:51]
    s_waitcnt vmcnt(13)
    s_barrier
    s_cmp_lg_u32 s22, 0
    s_cbranch_scc1 Lsig_55
    s_add_u32 s42, s4, s61
    s_addc_u32 s43, s5, 0
    s_mov_b32 s70, 1
    s_atomic_add s70, s[42:43], 0
Lsig_55:
    v_mul_f32 v28, v28, v30
    v_mul_f32 v29, v29, v31
    v_mfma_f32_16x16x32_bf16 v[60:63], a[44:47], v[92:95], v[60:63]
    s_waitcnt lgkmcnt(2)
    v_fma_f32 v150, v150, v121, v121
    v_fma_f32 v151, v151, v121, v121
    v_mfma_f32_16x16x32_bf16 v[40:43], a[48:51], v[64:67], v[40:43]
    ds_read_b128 v[80:83], v154 offset:4096
    v_rcp_f32 v150, v150
    v_mfma_f32_16x16x32_bf16 v[52:55], a[48:51], v[68:71], v[52:55]
    ds_read_b128 v[84:87], v154 offset:5120
    v_rcp_f32_e64 v151, v151
    v_mfma_f32_16x16x32_bf16 v[44:47], a[52:55], v[64:67], v[44:47]
    s_add_u32 s52, s52, 4096
    buffer_load_dwordx4 v[192:195], v1, s[4:7], s52 offen offset:0 sc1
    v_mul_f32 v28, v28, v150
    v_mul_f32 v29, v29, v151
    v_mfma_f32_16x16x32_bf16 v[56:59], a[52:55], v[68:71], v[56:59]
    v_cvt_pk_bf16_f32 v133, v28, v29
    v_mfma_f32_16x16x32_bf16 v[48:51], a[56:59], v[64:67], v[48:51]
    s_nop 0
    v_permlane16_swap_b32 v132, v133
    v_mfma_f32_16x16x32_bf16 v[60:63], a[56:59], v[68:71], v[60:63]
    s_waitcnt lgkmcnt(2)
    v_fma_f32 v20, -v112, v100, v20
    v_fma_f32 v21, -v112, v101, v21
    v_mfma_f32_16x16x32_bf16 v[40:43], a[60:63], v[72:75], v[40:43]
    ds_read_b128 v[88:91], v154 offset:6144
    v_fma_f32 v22, -v112, v102, v22
    v_fma_f32 v23, -v112, v103, v23
    v_mfma_f32_16x16x32_bf16 v[52:55], a[60:63], v[76:79], v[52:55]
    ds_read_b128 v[92:95], v154 offset:7168
    v_mul_f32 v148, v20, v128
    v_mul_f32_e64 v149, v21, v128
    v_mfma_f32_16x16x32_bf16 v[44:47], a[64:67], v[72:75], v[44:47]
    buffer_load_dwordx4 v[196:199], v1, s[4:7], s52 offen offset:1024 sc1
    v_exp_f32_e64 v148, v148
    v_mfma_f32_16x16x32_bf16 v[56:59], a[64:67], v[76:79], v[56:59]
    buffer_load_dwordx4 v[200:203], v1, s[4:7], s52 offen offset:2048 sc1
    v_exp_f32 v149, v149
    v_mfma_f32_16x16x32_bf16 v[48:51], a[68:71], v[72:75], v[48:51]
    v_mul_f32 v20, v20, v22
    v_mul_f32 v21, v21, v23
    v_mfma_f32_16x16x32_bf16 v[60:63], a[68:71], v[76:79], v[60:63]
    s_waitcnt lgkmcnt(2)
    v_fma_f32 v148, v148, v120, v120
    v_fma_f32 v149, v149, v120, v120
    v_mfma_f32_16x16x32_bf16 v[40:43], a[72:75], v[80:83], v[40:43]
    s_barrier
    v_rcp_f32 v148, v148
    v_mfma_f32_16x16x32_bf16 v[52:55], a[72:75], v[84:87], v[52:55]
    ds_read_b128 v[64:67], v154 offset:8192
    v_rcp_f32_e64 v149, v149
    v_mfma_f32_16x16x32_bf16 v[44:47], a[76:79], v[80:83], v[44:47]
    ds_read_b128 v[68:71], v154 offset:9216
    v_mul_f32 v20, v20, v148
    v_mul_f32 v21, v21, v149
    v_mfma_f32_16x16x32_bf16 v[56:59], a[76:79], v[84:87], v[56:59]
    buffer_load_dwordx4 v[204:207], v1, s[4:7], s52 offen offset:3072 sc1
    v_cvt_pk_bf16_f32 v134, v20, v21
    v_fma_f32 v32, -v113, v100, v32
    v_mfma_f32_16x16x32_bf16 v[48:51], a[80:83], v[80:83], v[48:51]
    v_fma_f32 v33, -v113, v101, v33
    v_fma_f32 v34, -v113, v102, v34
    v_mfma_f32_16x16x32_bf16 v[60:63], a[80:83], v[84:87], v[60:63]
    s_waitcnt lgkmcnt(2)
    v_fma_f32 v35, -v113, v103, v35
    v_mul_f32 v150, v32, v129
    v_mfma_f32_16x16x32_bf16 v[40:43], a[84:87], v[88:91], v[40:43]
    ds_read_b128 v[72:75], v154 offset:10240
    v_mul_f32_e64 v151, v33, v129
    v_mfma_f32_16x16x32_bf16 v[52:55], a[84:87], v[92:95], v[52:55]
    ds_read_b128 v[76:79], v154 offset:11264
    v_exp_f32_e64 v150, v150
    v_mfma_f32_16x16x32_bf16 v[44:47], a[88:91], v[88:91], v[44:47]
    buffer_load_dwordx4 a[4:7], v1, s[4:7], s51 offen offset:1024 sc1
    v_exp_f32_e64 v151, v151
    v_mfma_f32_16x16x32_bf16 v[56:59], a[88:91], v[92:95], v[56:59]
    buffer_load_dwordx4 a[8:11], v1, s[4:7], s51 offen offset:2048 sc1
    v_mul_f32 v32, v32, v34
    v_mul_f32 v33, v33, v35
    v_mfma_f32_16x16x32_bf16 v[48:51], a[92:95], v[88:91], v[48:51]
    v_fma_f32 v150, v150, v121, v121
    v_fma_f32 v151, v151, v121, v121
    v_mfma_f32_16x16x32_bf16 v[60:63], a[92:95], v[92:95], v[60:63]
    s_waitcnt lgkmcnt(2)
    v_rcp_f32 v150, v150
    v_mfma_f32_16x16x32_bf16 v[40:43], a[96:99], v[64:67], v[40:43]
    ds_read_b128 v[80:83], v154 offset:12288
    v_rcp_f32_e64 v151, v151
    v_mfma_f32_16x16x32_bf16 v[52:55], a[96:99], v[68:71], v[52:55]
    ds_read_b128 v[84:87], v154 offset:13312
    v_mul_f32 v32, v32, v150
    v_mul_f32 v33, v33, v151
    v_mfma_f32_16x16x32_bf16 v[44:47], a[100:103], v[64:67], v[44:47]
    buffer_load_dwordx4 a[12:15], v1, s[4:7], s51 offen offset:3072 sc1
    v_cvt_pk_bf16_f32 v135, v32, v33
    v_mfma_f32_16x16x32_bf16 v[56:59], a[100:103], v[68:71], v[56:59]
    s_add_u32 s51, s51, 4096
    buffer_load_dwordx4 a[16:19], v1, s[4:7], s51 offen offset:0 sc1
    v_permlane16_swap_b32 v134, v135
    v_mfma_f32_16x16x32_bf16 v[48:51], a[104:107], v[64:67], v[48:51]
    s_nop 0
    v_permlane32_swap_b32 v132, v134
    v_mfma_f32_16x16x32_bf16 v[60:63], a[104:107], v[68:71], v[60:63]
    s_waitcnt lgkmcnt(2)
    v_permlane32_swap_b32_e64 v133, v135
    v_mfma_f32_16x16x32_bf16 v[40:43], a[108:111], v[72:75], v[40:43]
    ds_read_b128 v[88:91], v154 offset:14336
    v_fma_f32 v24, -v112, v104, v24
    v_fma_f32 v25, -v112, v105, v25
    v_mfma_f32_16x16x32_bf16 v[52:55], a[108:111], v[76:79], v[52:55]
    ds_read_b128 v[92:95], v154 offset:15360
    v_fma_f32 v26, -v112, v106, v26
    v_fma_f32 v27, -v112, v107, v27
    v_mfma_f32_16x16x32_bf16 v[44:47], a[112:115], v[72:75], v[44:47]
    buffer_load_dwordx4 a[20:23], v1, s[4:7], s51 offen offset:1024 sc1
    v_mul_f32 v148, v24, v128
    v_mul_f32 v149, v25, v128
    v_mfma_f32_16x16x32_bf16 v[56:59], a[112:115], v[76:79], v[56:59]
    v_exp_f32 v148, v148
    v_mfma_f32_16x16x32_bf16 v[48:51], a[116:119], v[72:75], v[48:51]
    v_exp_f32 v149, v149
    v_mfma_f32_16x16x32_bf16 v[60:63], a[116:119], v[76:79], v[60:63]
    s_waitcnt lgkmcnt(2)
    v_mul_f32 v24, v24, v26
    v_mul_f32_e64 v25, v25, v27
    v_mfma_f32_16x16x32_bf16 v[40:43], a[120:123], v[80:83], v[40:43]
    ds_read_b128 v[64:67], v154 offset:16384
    v_fma_f32 v148, v148, v120, v120
    v_fma_f32 v149, v149, v120, v120
    v_mfma_f32_16x16x32_bf16 v[52:55], a[120:123], v[84:87], v[52:55]
    ds_read_b128 v[68:71], v154 offset:17408
    v_rcp_f32_e64 v148, v148
    v_mfma_f32_16x16x32_bf16 v[44:47], a[124:127], v[80:83], v[44:47]
    ds_read_b128 a[96:99], v140 offset:0
    v_rcp_f32_e64 v149, v149
    v_mfma_f32_16x16x32_bf16 v[56:59], a[124:127], v[84:87], v[56:59]
    ds_read_b128 a[100:103], v140 offset:1024
    v_mul_f32 v24, v24, v148
    v_mul_f32 v25, v25, v149
    v_mfma_f32_16x16x32_bf16 v[48:51], a[128:131], v[80:83], v[48:51]
    v_cvt_pk_bf16_f32 v136, v24, v25
    v_fma_f32 v36, -v113, v104, v36
    v_mfma_f32_16x16x32_bf16 v[60:63], a[128:131], v[84:87], v[60:63]
    s_waitcnt lgkmcnt(4)
    v_fma_f32 v37, -v113, v105, v37
    v_fma_f32 v38, -v113, v106, v38
    v_mfma_f32_16x16x32_bf16 v[40:43], a[132:135], v[88:91], v[40:43]
    ds_read_b128 v[72:75], v154 offset:18432
    v_fma_f32 v39, -v113, v107, v39
    v_mul_f32 v150, v36, v129
    v_mfma_f32_16x16x32_bf16 v[52:55], a[132:135], v[92:95], v[52:55]
    ds_read_b128 v[76:79], v154 offset:19456
    v_mul_f32_e64 v151, v37, v129
    v_mfma_f32_16x16x32_bf16 v[44:47], a[136:139], v[88:91], v[44:47]
    ds_read_b128 a[104:107], v140 offset:2048
    v_exp_f32_e64 v150, v150
    v_mfma_f32_16x16x32_bf16 v[56:59], a[136:139], v[92:95], v[56:59]
    ds_read_b128 a[108:111], v140 offset:3072
    v_exp_f32 v151, v151
    v_mfma_f32_16x16x32_bf16 v[48:51], a[140:143], v[88:91], v[48:51]
    v_mul_f32 v36, v36, v38
    v_mul_f32 v37, v37, v39
    v_mfma_f32_16x16x32_bf16 v[60:63], a[140:143], v[92:95], v[60:63]
    s_waitcnt lgkmcnt(6)
    v_fma_f32 v150, v150, v121, v121
    v_fma_f32 v151, v151, v121, v121
    v_mfma_f32_16x16x32_bf16 v[40:43], a[144:147], v[64:67], v[40:43]
    ds_read_b128 v[80:83], v154 offset:20480
    v_rcp_f32_e64 v150, v150
    v_mfma_f32_16x16x32_bf16 v[52:55], a[144:147], v[68:71], v[52:55]
    ds_read_b128 v[84:87], v154 offset:21504
    v_rcp_f32_e64 v151, v151
    v_mfma_f32_16x16x32_bf16 v[44:47], a[148:151], v[64:67], v[44:47]
    ds_read_b128 a[112:115], v140 offset:4096
    v_mul_f32 v36, v36, v150
    v_mul_f32 v37, v37, v151
    v_mfma_f32_16x16x32_bf16 v[56:59], a[148:151], v[68:71], v[56:59]
    ds_read_b128 a[116:119], v140 offset:5120
    v_cvt_pk_bf16_f32 v137, v36, v37
    v_mfma_f32_16x16x32_bf16 v[48:51], a[152:155], v[64:67], v[48:51]
    s_nop 0
    v_permlane16_swap_b32 v136, v137
    v_mfma_f32_16x16x32_bf16 v[60:63], a[152:155], v[68:71], v[60:63]
    s_waitcnt lgkmcnt(6)
    v_permlane32_swap_b32 v136, v138
    v_mfma_f32_16x16x32_bf16 v[40:43], a[156:159], v[72:75], v[40:43]
    ds_read_b128 v[88:91], v154 offset:22528
    v_permlane32_swap_b32_e64 v137, v139
    v_mfma_f32_16x16x32_bf16 v[52:55], a[156:159], v[76:79], v[52:55]
    ds_read_b128 v[92:95], v154 offset:23552
    buffer_store_dwordx4 v[132:135], v152, s[4:7], s60 offen sc1
    s_mov_b32 exec_hi, 0
    buffer_store_dwordx4 v[136:139], v152, s[4:7], s60 offen offset:512 sc1
    s_mov_b32 exec_hi, -1
    v_mfma_f32_16x16x32_bf16 v[44:47], a[160:163], v[72:75], v[44:47]
    ds_read_b128 a[120:123], v140 offset:6144
    s_add_u32 s60, s60, 98304
    v_mfma_f32_16x16x32_bf16 v[56:59], a[160:163], v[76:79], v[56:59]
    ds_read_b128 a[124:127], v140 offset:7168
    v_mfma_f32_16x16x32_bf16 v[48:51], a[164:167], v[72:75], v[48:51]
    s_lshl_b32 s66, s24, 8
    s_add_u32 s66, s66, 98304
    v_mov_b32 v155, s66
    buffer_load_dword v156, v155, s[4:7], 0 offen sc1
    v_mfma_f32_16x16x32_bf16 v[60:63], a[164:167], v[76:79], v[60:63]
    s_waitcnt lgkmcnt(6)
    v_mfma_f32_16x16x32_bf16 v[40:43], a[168:171], v[80:83], v[40:43]
    ds_read_b128 v[64:67], v154 offset:24576
    v_mfma_f32_16x16x32_bf16 v[52:55], a[168:171], v[84:87], v[52:55]
    ds_read_b128 v[68:71], v154 offset:25600
    v_mfma_f32_16x16x32_bf16 v[44:47], a[172:175], v[80:83], v[44:47]
    buffer_load_dwordx4 a[24:27], v1, s[4:7], s51 offen offset:2048 sc1
    v_mfma_f32_16x16x32_bf16 v[56:59], a[172:175], v[84:87], v[56:59]
    ds_read_b128 a[128:131], v140 offset:8192
    v_mfma_f32_16x16x32_bf16 v[48:51], a[176:179], v[80:83], v[48:51]
    ds_read_b128 a[132:135], v140 offset:9216
    v_mfma_f32_16x16x32_bf16 v[60:63], a[176:179], v[84:87], v[60:63]
    s_waitcnt lgkmcnt(6)
    v_mfma_f32_16x16x32_bf16 v[40:43], a[180:183], v[88:91], v[40:43]
    s_branch Lpg_join_4_go
.p2align 12
Lpg_join_4:
    s_setpc_b64 s[0:1]
.p2align 3
Lpg_join_4_go:
    ds_read_b128 v[72:75], v154 offset:26624
    v_mfma_f32_16x16x32_bf16 v[52:55], a[180:183], v[92:95], v[52:55]
    ds_read_b128 v[76:79], v154 offset:27648
    v_mfma_f32_16x16x32_bf16 v[44:47], a[184:187], v[88:91], v[44:47]
    buffer_load_dwordx4 a[28:31], v1, s[4:7], s51 offen offset:3072 sc1
    v_mfma_f32_16x16x32_bf16 v[56:59], a[184:187], v[92:95], v[56:59]
    s_add_u32 s51, s51, 4096
    buffer_load_dwordx4 a[32:35], v1, s[4:7], s51 offen offset:0 sc1
    v_mfma_f32_16x16x32_bf16 v[48:51], a[188:191], v[88:91], v[48:51]
    ds_read_b128 a[136:139], v140 offset:40960
    v_mfma_f32_16x16x32_bf16 v[60:63], a[188:191], v[92:95], v[60:63]
    s_waitcnt lgkmcnt(5)
    ds_read_b128 a[140:143], v140 offset:41984
    v_mfma_f32_16x16x32_bf16 v[40:43], a[192:195], v[64:67], v[40:43]
    ds_read_b128 v[80:83], v154 offset:28672
    v_mfma_f32_16x16x32_bf16 v[52:55], a[192:195], v[68:71], v[52:55]
    ds_read_b128 v[84:87], v154 offset:29696
    v_mfma_f32_16x16x32_bf16 v[44:47], a[196:199], v[64:67], v[44:47]
    buffer_load_dwordx4 a[36:39], v1, s[4:7], s51 offen offset:1024 sc1
    v_mfma_f32_16x16x32_bf16 v[56:59], a[196:199], v[68:71], v[56:59]
    ds_read_b128 a[144:147], v140 offset:43008
    v_mfma_f32_16x16x32_bf16 v[48:51], a[200:203], v[64:67], v[48:51]
    ds_read_b128 a[148:151], v140 offset:44032
    v_mfma_f32_16x16x32_bf16 v[60:63], a[200:203], v[68:71], v[60:63]
    s_waitcnt lgkmcnt(6)
    v_mfma_f32_16x16x32_bf16 v[40:43], a[204:207], v[72:75], v[40:43]
    ds_read_b128 v[88:91], v154 offset:30720
    v_mfma_f32_16x16x32_bf16 v[52:55], a[204:207], v[76:79], v[52:55]
    ds_read_b128 v[92:95], v154 offset:31744
    v_mfma_f32_16x16x32_bf16 v[44:47], a[208:211], v[72:75], v[44:47]
    buffer_load_dwordx4 a[40:43], v1, s[4:7], s51 offen offset:2048 sc1
    v_mfma_f32_16x16x32_bf16 v[56:59], a[208:211], v[76:79], v[56:59]
    buffer_load_dwordx4 a[44:47], v1, s[4:7], s51 offen offset:3072 sc1
    v_mfma_f32_16x16x32_bf16 v[48:51], a[212:215], v[72:75], v[48:51]
    ds_read_b128 a[152:155], v140 offset:45056
    v_mfma_f32_16x16x32_bf16 v[60:63], a[212:215], v[76:79], v[60:63]
    s_waitcnt lgkmcnt(5)
    ds_read_b128 a[156:159], v140 offset:46080
    v_mfma_f32_16x16x32_bf16 v[40:43], a[216:219], v[80:83], v[40:43]
    s_add_u32 s51, s51, 4096
    buffer_load_dwordx4 a[48:51], v1, s[4:7], s51 offen offset:0 sc1
    v_mfma_f32_16x16x32_bf16 v[52:55], a[216:219], v[84:87], v[52:55]
    buffer_load_dwordx4 v[2:5], v14, s[4:7], s3 offen sc1
    s_add_u32 s3, s3, 40960
    v_mfma_f32_16x16x32_bf16 v[44:47], a[220:223], v[80:83], v[44:47]
    s_waitcnt vmcnt(32)
    ds_read_b128 a[160:163], v140 offset:47104
    v_mfma_f32_16x16x32_bf16 v[56:59], a[220:223], v[84:87], v[56:59]
    s_waitcnt vmcnt(31)
    ds_read_b128 a[164:167], v140 offset:48128
    v_mfma_f32_16x16x32_bf16 v[48:51], a[224:227], v[80:83], v[48:51]
    v_mfma_f32_16x16x32_bf16 v[60:63], a[224:227], v[84:87], v[60:63]
    s_waitcnt lgkmcnt(4)
    v_mfma_f32_16x16x32_bf16 v[40:43], a[228:231], v[88:91], v[40:43]
    buffer_load_dwordx4 v[6:9], v14, s[4:7], s3 offen sc1
    s_add_u32 s3, s3, 40960
    v_mfma_f32_16x16x32_bf16 v[52:55], a[228:231], v[92:95], v[52:55]
    buffer_load_dwordx4 v[10:13], v14, s[4:7], s3 offen sc1
    s_add_u32 s3, s3, 40960
    v_mfma_f32_16x16x32_bf16 v[44:47], a[232:235], v[88:91], v[44:47]
    s_waitcnt vmcnt(32)
    ds_read_b128 a[168:171], v140 offset:49152
    v_mfma_f32_16x16x32_bf16 v[56:59], a[232:235], v[92:95], v[56:59]
    s_waitcnt vmcnt(31)
    ds_read_b128 a[172:175], v140 offset:50176
    v_mfma_f32_16x16x32_bf16 v[48:51], a[236:239], v[88:91], v[48:51]
    v_mfma_f32_16x16x32_bf16 v[60:63], a[236:239], v[92:95], v[60:63]
    s_waitcnt vmcnt(10)
    v_cmp_ne_u32 vcc, 16, v156
    s_mov_b32 s69, 1048576
    s_cbranch_vccz Lpollx_57
Lpoll_56:
    s_sleep 4
    buffer_load_dword v156, v155, s[4:7], 0 offen sc1
    s_sub_u32 s69, s69, 1
    s_waitcnt vmcnt(0)
    s_cbranch_scc1 Lpollx_57
    v_cmp_ne_u32 vcc, 16, v156
    s_cbranch_vccnz Lpoll_56
Lpollx_57:
    v_pk_fma_f32 v[40:41], v[114:115], v[96:97], v[40:41] op_sel:[0,0,0] op_sel_hi:[0,1,1] neg_lo:[1,0,0] neg_hi:[1,0,0]
    v_pk_fma_f32 v[42:43], v[114:115], v[98:99], v[42:43] op_sel:[0,0,0] op_sel_hi:[0,1,1] neg_lo:[1,0,0] neg_hi:[1,0,0]
    v_pk_mul_f32 v[148:149], v[40:41], v[130:131] op_sel:[0,0] op_sel_hi:[1,0]
    v_exp_f32 v148, v148
    v_exp_f32_e64 v149, v149
    v_pk_mul_f32 v[40:41], v[40:41], v[42:43] op_sel:[0,0] op_sel_hi:[1,1]
    v_pk_fma_f32 v[148:149], v[148:149], v[122:123], v[122:123] op_sel:[0,0,0] op_sel_hi:[1,0,0]
    v_rcp_f32 v148, v148
    v_rcp_f32_e64 v149, v149
    s_nop 0
    v_pk_mul_f32 v[40:41], v[40:41], v[148:149] op_sel:[0,0] op_sel_hi:[1,1]
    v_cvt_pk_bf16_f32 v132, v40, v41
    buffer_load_dwordx4 a[52:55], v1, s[4:7], s51 offen offset:1024 sc1
    v_pk_fma_f32 v[52:53], v[114:115], v[96:97], v[52:53] op_sel:[1,0,0] op_sel_hi:[1,1,1] neg_lo:[1,0,0] neg_hi:[1,0,0]
    v_pk_fma_f32 v[54:55], v[114:115], v[98:99], v[54:55] op_sel:[1,0,0] op_sel_hi:[1,1,1] neg_lo:[1,0,0] neg_hi:[1,0,0]
    v_pk_mul_f32 v[150:151], v[52:53], v[130:131] op_sel:[0,1] op_sel_hi:[1,1]
    v_exp_f32 v150, v150
    v_exp_f32 v151, v151
    v_pk_mul_f32 v[52:53], v[52:53], v[54:55] op_sel:[0,0] op_sel_hi:[1,1]
    v_pk_fma_f32 v[150:151], v[150:151], v[122:123], v[122:123] op_sel:[0,1,1] op_sel_hi:[1,1,1]
    v_rcp_f32 v150, v150
    v_rcp_f32_e64 v151, v151
    s_nop 0
    v_pk_mul_f32 v[52:53], v[52:53], v[150:151] op_sel:[0,0] op_sel_hi:[1,1]
    v_cvt_pk_bf16_f32 v133, v52, v53
    buffer_load_dwordx4 a[56:59], v1, s[4:7], s51 offen offset:2048 sc1
    s_nop 0
    v_permlane16_swap_b32 v132, v133
    v_pk_fma_f32 v[44:45], v[114:115], v[100:101], v[44:45] op_sel:[0,0,0] op_sel_hi:[0,1,1] neg_lo:[1,0,0] neg_hi:[1,0,0]
    v_pk_fma_f32 v[46:47], v[114:115], v[102:103], v[46:47] op_sel:[0,0,0] op_sel_hi:[0,1,1] neg_lo:[1,0,0] neg_hi:[1,0,0]
    v_pk_mul_f32 v[148:149], v[44:45], v[130:131] op_sel:[0,0] op_sel_hi:[1,0]
    v_exp_f32 v148, v148
    v_exp_f32 v149, v149
    v_pk_mul_f32 v[44:45], v[44:45], v[46:47] op_sel:[0,0] op_sel_hi:[1,1]
    v_pk_fma_f32 v[148:149], v[148:149], v[122:123], v[122:123] op_sel:[0,0,0] op_sel_hi:[1,0,0]
    v_rcp_f32 v148, v148
    v_rcp_f32_e64 v149, v149
    s_nop 0
    v_pk_mul_f32 v[44:45], v[44:45], v[148:149] op_sel:[0,0] op_sel_hi:[1,1]
    v_cvt_pk_bf16_f32 v134, v44, v45
    s_barrier
    s_cmp_lg_u32 s22, 0
    s_cbranch_scc1 Lsig_58
    s_add_u32 s42, s4, s62
    s_addc_u32 s43, s5, 0
    s_mov_b32 s70, 1
    s_atomic_add s70, s[42:43], 0
Lsig_58:
    buffer_load_dwordx4 a[60:63], v1, s[4:7], s51 offen offset:3072 sc1
    v_pk_fma_f32 v[56:57], v[114:115], v[100:101], v[56:57] op_sel:[1,0,0] op_sel_hi:[1,1,1] neg_lo:[1,0,0] neg_hi:[1,0,0]
    v_pk_fma_f32 v[58:59], v[114:115], v[102:103], v[58:59] op_sel:[1,0,0] op_sel_hi:[1,1,1] neg_lo:[1,0,0] neg_hi:[1,0,0]
    v_pk_mul_f32 v[150:151], v[56:57], v[130:131] op_sel:[0,1] op_sel_hi:[1,1]
    v_exp_f32 v150, v150
    v_exp_f32 v151, v151
    v_pk_mul_f32 v[56:57], v[56:57], v[58:59] op_sel:[0,0] op_sel_hi:[1,1]
    v_pk_fma_f32 v[150:151], v[150:151], v[122:123], v[122:123] op_sel:[0,1,1] op_sel_hi:[1,1,1]
    v_rcp_f32 v150, v150
    v_rcp_f32_e64 v151, v151
    s_nop 0
    v_pk_mul_f32 v[56:57], v[56:57], v[150:151] op_sel:[0,0] op_sel_hi:[1,1]
    v_cvt_pk_bf16_f32 v135, v56, v57
    s_add_u32 s51, s51, 4096
    buffer_load_dwordx4 a[64:67], v1, s[4:7], s51 offen offset:0 sc1
    v_permlane16_swap_b32 v134, v135
    s_nop 1
    v_permlane32_swap_b32 v132, v134
    v_permlane32_swap_b32 v133, v135
    buffer_store_dwordx4 v[132:135], v152, s[4:7], s60 offen sc1
    v_pk_fma_f32 v[48:49], v[114:115], v[104:105], v[48:49] op_sel:[0,0,0] op_sel_hi:[0,1,1] neg_lo:[1,0,0] neg_hi:[1,0,0]
    v_pk_fma_f32 v[50:51], v[114:115], v[106:107], v[50:51] op_sel:[0,0,0] op_sel_hi:[0,1,1] neg_lo:[1,0,0] neg_hi:[1,0,0]
    v_pk_mul_f32 v[148:149], v[48:49], v[130:131] op_sel:[0,0] op_sel_hi:[1,0]
    v_exp_f32 v148, v148
    v_exp_f32 v149, v149
    v_pk_mul_f32 v[48:49], v[48:49], v[50:51] op_sel:[0,0] op_sel_hi:[1,1]
    v_pk_fma_f32 v[148:149], v[148:149], v[122:123], v[122:123] op_sel:[0,0,0] op_sel_hi:[1,0,0]
    v_rcp_f32 v148, v148
    v_rcp_f32_e64 v149, v149
    s_nop 0
    v_pk_mul_f32 v[48:49], v[48:49], v[148:149] op_sel:[0,0] op_sel_hi:[1,1]
    v_cvt_pk_bf16_f32 v136, v48, v49
    buffer_load_dwordx4 a[68:71], v1, s[4:7], s51 offen offset:1024 sc1
    v_pk_fma_f32 v[60:61], v[114:115], v[104:105], v[60:61] op_sel:[1,0,0] op_sel_hi:[1,1,1] neg_lo:[1,0,0] neg_hi:[1,0,0]
    v_pk_fma_f32 v[62:63], v[114:115], v[106:107], v[62:63] op_sel:[1,0,0] op_sel_hi:[1,1,1] neg_lo:[1,0,0] neg_hi:[1,0,0]
    v_pk_mul_f32 v[150:151], v[60:61], v[130:131] op_sel:[0,1] op_sel_hi:[1,1]
    v_exp_f32 v150, v150
    v_exp_f32 v151, v151
    v_pk_mul_f32 v[60:61], v[60:61], v[62:63] op_sel:[0,0] op_sel_hi:[1,1]
    v_pk_fma_f32 v[150:151], v[150:151], v[122:123], v[122:123] op_sel:[0,1,1] op_sel_hi:[1,1,1]
    v_rcp_f32 v150, v150
    v_rcp_f32_e64 v151, v151
    s_nop 0
    v_pk_mul_f32 v[60:61], v[60:61], v[150:151] op_sel:[0,0] op_sel_hi:[1,1]
    v_cvt_pk_bf16_f32 v137, v60, v61
    buffer_load_dwordx4 a[72:75], v1, s[4:7], s51 offen offset:2048 sc1
    s_nop 0
    v_permlane16_swap_b32 v136, v137
    s_nop 1
    v_permlane32_swap_b32 v136, v138
    v_permlane32_swap_b32 v137, v139
    s_mov_b32 exec_hi, 0
    buffer_store_dwordx4 v[136:139], v152, s[4:7], s60 offen offset:512 sc1
    s_mov_b32 exec_hi, -1
    s_add_u32 s60, s60, 98304
    s_waitcnt lgkmcnt(0)
    buffer_load_dwordx4 a[76:79], v1, s[4:7], s51 offen offset:3072 sc1
    s_add_u32 s51, s51, 4096
    buffer_load_dwordx4 a[80:83], v1, s[4:7], s51 offen offset:0 sc1
    buffer_load_dwordx4 a[84:87], v1, s[4:7], s51 offen offset:1024 sc1
    buffer_load_dwordx4 a[88:91], v1, s[4:7], s51 offen offset:2048 sc1
    v_lshrrev_b32_e64 v144, 4, v0
    v_lshl_add_u32 v145, v144, 2, v0
    s_mul_i32 s48, s22, 5120
    v_lshl_add_u32 v146, v144, 8, s48
    v_and_b32 v147, 15, v145
    v_lshl_add_u32 v153, v147, 4, v146
    v_add_u32 v145, 2, v145
    v_and_b32_e64 v147, 15, v145
    v_lshl_add_u32 v154, v147, 4, v146
    v_mfma_f32_16x16x32_bf16 v[112:115], a[240:243], v[160:163], 0
    buffer_load_dwordx4 a[92:95], v1, s[4:7], s51 offen offset:3072 sc1
    v_mfma_f32_16x16x32_bf16 v[116:119], a[244:247], v[160:163], 0
    v_mfma_f32_16x16x32_bf16 v[120:123], a[248:251], v[160:163], 0
    v_mfma_f32_16x16x32_bf16 v[124:127], a[252:255], v[160:163], 0
    v_mfma_f32_16x16x32_bf16 v[128:131], v[252:255], v[160:163], 0
    v_mfma_f32_16x16x32_bf16 v[112:115], v[248:251], v[164:167], v[112:115]
    buffer_load_dwordx4 v[16:19], v1, s[4:7], s53 offen offset:0 sc1
    v_mfma_f32_16x16x32_bf16 v[116:119], v[244:247], v[164:167], v[116:119]
    v_and_b32 v145, 15, v0
    v_subrev_u32 v146, 12, v145
    v_mfma_f32_16x16x32_bf16 v[120:123], v[240:243], v[164:167], v[120:123]
    v_min3_u32 v145, v145, v146, 9
    v_and_b32 v146, 3, v145
    v_mfma_f32_16x16x32_bf16 v[124:127], v[236:239], v[164:167], v[124:127]
    v_lshrrev_b32 v145, 2, v145
    s_lshl_b32 s48, s22, 2
    v_mfma_f32_16x16x32_bf16 v[128:131], v[232:235], v[164:167], v[128:131]
    v_add_u32 v144, s48, v144
    v_lshl_add_u32 v144, v146, 2, v144
    v_mfma_f32_16x16x32_bf16 v[112:115], v[228:231], v[168:171], v[112:115]
    buffer_load_dwordx4 v[20:23], v1, s[4:7], s53 offen offset:1024 sc1
    v_and_b32_e64 v147, 1, v145
    v_mfma_f32_16x16x32_bf16 v[116:119], v[224:227], v[168:171], v[116:119]
    v_lshl_add_u32 v144, v147, 1, v144
    v_lshlrev_b32_e64 v146, 8, v146
    v_mfma_f32_16x16x32_bf16 v[120:123], v[220:223], v[168:171], v[120:123]
    v_lshl_add_u32 v146, v145, 11, v146
    v_and_b32_e64 v147, 15, v144
    v_mfma_f32_16x16x32_bf16 v[124:127], v[216:219], v[168:171], v[124:127]
    v_lshl_add_u32 v152, v147, 4, v146
    v_lshrrev_b32_e64 v145, 1, v145
    v_mfma_f32_16x16x32_bf16 v[128:131], v[212:215], v[168:171], v[128:131]
    v_lshl_add_u32 v144, v145, 3, v144
    v_and_b32_e64 v147, 15, v144
    v_mfma_f32_16x16x32_bf16 v[112:115], v[208:211], v[172:175], v[112:115]
    buffer_load_dwordx4 v[24:27], v1, s[4:7], s53 offen offset:2048 sc1
    v_lshl_add_u32 v146, v147, 4, v146
    v_mfma_f32_16x16x32_bf16 v[116:119], a[96:99], v[172:175], v[116:119]
    v_lshlrev_b32 v145, 9, v145
    v_sub_u32 v146, v146, v145
    v_mfma_f32_16x16x32_bf16 v[120:123], a[100:103], v[172:175], v[120:123]
    v_add_u32 v157, 1024, v146
    v_mfma_f32_16x16x32_bf16 v[124:127], a[104:107], v[172:175], v[124:127]
    v_mfma_f32_16x16x32_bf16 v[128:131], a[108:111], v[172:175], v[128:131]
    v_mfma_f32_16x16x32_bf16 v[112:115], a[112:115], v[176:179], v[112:115]
    buffer_load_dwordx4 v[28:31], v1, s[4:7], s53 offen offset:3072 sc1
    v_mfma_f32_16x16x32_bf16 v[116:119], a[116:119], v[176:179], v[116:119]
    v_mfma_f32_16x16x32_bf16 v[120:123], a[120:123], v[176:179], v[120:123]
    v_mfma_f32_16x16x32_bf16 v[124:127], a[124:127], v[176:179], v[124:127]
    v_mfma_f32_16x16x32_bf16 v[128:131], a[128:131], v[176:179], v[128:131]
    s_lshl_b32 s66, s24, 8
    s_add_u32 s66, s66, 122880
    v_mov_b32 v155, s66
    buffer_load_dword v156, v155, s[4:7], 0 offen sc1
    v_mfma_f32_16x16x32_bf16 v[112:115], a[132:135], v[180:183], v[112:115]
    s_add_u32 s53, s53, 4096
    buffer_load_dwordx4 v[32:35], v1, s[4:7], s53 offen offset:0 sc1
    v_mfma_f32_16x16x32_bf16 v[116:119], a[136:139], v[180:183], v[116:119]
    v_mfma_f32_16x16x32_bf16 v[120:123], a[140:143], v[180:183], v[120:123]
    v_mfma_f32_16x16x32_bf16 v[124:127], a[144:147], v[180:183], v[124:127]
    v_mfma_f32_16x16x32_bf16 v[128:131], a[148:151], v[180:183], v[128:131]
    v_mfma_f32_16x16x32_bf16 v[112:115], a[152:155], v[184:187], v[112:115]
    buffer_load_dwordx4 v[36:39], v1, s[4:7], s53 offen offset:1024 sc1
    v_mfma_f32_16x16x32_bf16 v[116:119], a[156:159], v[184:187], v[116:119]
    v_mfma_f32_16x16x32_bf16 v[120:123], a[160:163], v[184:187], v[120:123]
    v_mfma_f32_16x16x32_bf16 v[124:127], a[164:167], v[184:187], v[124:127]
    v_mfma_f32_16x16x32_bf16 v[128:131], a[168:171], v[184:187], v[128:131]
    v_mfma_f32_16x16x32_bf16 v[112:115], a[172:175], v[188:191], v[112:115]
    buffer_load_dwordx4 v[40:43], v1, s[4:7], s53 offen offset:2048 sc1
    v_mfma_f32_16x16x32_bf16 v[116:119], a[0:3], v[188:191], v[116:119]
    v_mfma_f32_16x16x32_bf16 v[120:123], a[4:7], v[188:191], v[120:123]
    v_mfma_f32_16x16x32_bf16 v[124:127], a[8:11], v[188:191], v[124:127]
    v_mfma_f32_16x16x32_bf16 v[128:131], a[12:15], v[188:191], v[128:131]
    s_waitcnt vmcnt(28)
    v_mfma_f32_16x16x32_bf16 v[112:115], a[16:19], v[192:195], v[112:115]
    buffer_load_dwordx4 v[44:47], v1, s[4:7], s53 offen offset:3072 sc1
    v_mfma_f32_16x16x32_bf16 v[116:119], a[20:23], v[192:195], v[116:119]
    v_mfma_f32_16x16x32_bf16 v[120:123], a[24:27], v[192:195], v[120:123]
    v_mfma_f32_16x16x32_bf16 v[124:127], a[28:31], v[192:195], v[124:127]
    v_mfma_f32_16x16x32_bf16 v[128:131], a[32:35], v[192:195], v[128:131]
    s_waitcnt vmcnt(21)
    v_mfma_f32_16x16x32_bf16 v[112:115], a[36:39], v[196:199], v[112:115]
    s_add_u32 s53, s53, 4096
    buffer_load_dwordx4 v[48:51], v1, s[4:7], s53 offen offset:0 sc1
    v_mfma_f32_16x16x32_bf16 v[116:119], a[40:43], v[196:199], v[116:119]
    v_mfma_f32_16x16x32_bf16 v[120:123], a[44:47], v[196:199], v[120:123]
    v_mfma_f32_16x16x32_bf16 v[124:127], a[48:51], v[196:199], v[124:127]
    v_mfma_f32_16x16x32_bf16 v[128:131], a[52:55], v[196:199], v[128:131]
    s_waitcnt vmcnt(16)
    v_mfma_f32_16x16x32_bf16 v[112:115], a[56:59], v[200:203], v[112:115]
    buffer_load_dwordx4 v[52:55], v1, s[4:7], s53 offen offset:1024 sc1
    v_mfma_f32_16x16x32_bf16 v[116:119], a[60:63], v[200:203], v[116:119]
    v_mfma_f32_16x16x32_bf16 v[120:123], a[64:67], v[200:203], v[120:123]
    v_mfma_f32_16x16x32_bf16 v[124:127], a[68:71], v[200:203], v[124:127]
    v_mfma_f32_16x16x32_bf16 v[128:131], a[72:75], v[200:203], v[128:131]
    s_waitcnt vmcnt(16)
    s_barrier
    s_cmp_lg_u32 s22, 0
    s_cbranch_scc1 Lsig_59
    s_add_u32 s42, s4, s63
    s_addc_u32 s43, s5, 0
    s_mov_b32 s70, 1
    s_atomic_add s70, s[42:43], 0
Lsig_59:
    s_waitcnt vmcnt(11)
    v_mfma_f32_16x16x32_bf16 v[112:115], a[76:79], v[204:207], v[112:115]
    buffer_load_dwordx4 v[56:59], v1, s[4:7], s53 offen offset:2048 sc1
    v_mfma_f32_16x16x32_bf16 v[116:119], a[80:83], v[204:207], v[116:119]
    v_mfma_f32_16x16x32_bf16 v[120:123], a[84:87], v[204:207], v[120:123]
    v_mfma_f32_16x16x32_bf16 v[124:127], a[88:91], v[204:207], v[124:127]
    v_mfma_f32_16x16x32_bf16 v[128:131], a[92:95], v[204:207], v[128:131]
    s_waitcnt vmcnt(7)
    v_cmp_ne_u32 vcc, 16, v156
    s_mov_b32 s69, 1048576
    s_cbranch_vccz Lpollx_61
Lpoll_60:
    s_sleep 4
    buffer_load_dword v156, v155, s[4:7], 0 offen sc1
    s_sub_u32 s69, s69, 1
    s_waitcnt vmcnt(0)
    s_cbranch_scc1 Lpollx_61
    v_cmp_ne_u32 vcc, 16, v156
    s_cbranch_vccnz Lpoll_60
Lpollx_61:
    v_mfma_f32_16x16x32_bf16 v[132:135], a[240:243], v[16:19], 0
    buffer_load_dwordx4 v[60:63], v1, s[4:7], s53 offen offset:3072 sc1
    v_mfma_f32_16x16x32_bf16 v[136:139], a[244:247], v[16:19], 0
    v_mfma_f32_16x16x32_bf16 v[140:143], a[248:251], v[16:19], 0
    buffer_load_dwordx4 v[64:67], v1, s[4:7], s54 offen offset:0 sc1
    v_mfma_f32_16x16x32_bf16 v[144:147], a[252:255], v[16:19], 0
    v_mfma_f32_16x16x32_bf16 v[148:151], v[252:255], v[16:19], 0
    v_mfma_f32_16x16x32_bf16 v[132:135], v[248:251], v[20:23], v[132:135]
    buffer_load_dwordx4 v[68:71], v1, s[4:7], s54 offen offset:1024 sc1
    v_mfma_f32_16x16x32_bf16 v[136:139], v[244:247], v[20:23], v[136:139]
    ds_write_b128 v153, v[112:115] offset:0
    v_mfma_f32_16x16x32_bf16 v[140:143], v[240:243], v[20:23], v[140:143]
    ds_write_b128 v153, v[116:119] offset:1024
    v_mfma_f32_16x16x32_bf16 v[144:147], v[236:239], v[20:23], v[144:147]
    ds_write_b128 v154, v[120:123] offset:2048
    v_mfma_f32_16x16x32_bf16 v[148:151], v[232:235], v[20:23], v[148:151]
    ds_write_b128 v154, v[124:127] offset:3072
    v_mfma_f32_16x16x32_bf16 v[132:135], v[228:231], v[24:27], v[132:135]
    buffer_load_dwordx4 v[72:75], v1, s[4:7], s54 offen offset:2048 sc1
    v_mfma_f32_16x16x32_bf16 v[136:139], v[224:227], v[24:27], v[136:139]
    ds_write_b128 v153, v[128:131] offset:4096
    v_mfma_f32_16x16x32_bf16 v[140:143], v[220:223], v[24:27], v[140:143]
    v_lshlrev_b32_e64 v192, 16, v2
    v_and_b32 v193, 0xffff0000, v2
    v_mfma_f32_16x16x32_bf16 v[144:147], v[216:219], v[24:27], v[144:147]
    v_lshlrev_b32_e64 v194, 16, v3
    v_and_b32 v195, 0xffff0000, v3
    v_mfma_f32_16x16x32_bf16 v[148:151], v[212:215], v[24:27], v[148:151]
    v_lshlrev_b32_e64 v196, 16, v4
    v_and_b32 v197, 0xffff0000, v4
    v_mfma_f32_16x16x32_bf16 v[132:135], v[208:211], v[28:31], v[132:135]
    buffer_load_dwordx4 v[76:79], v1, s[4:7], s54 offen offset:3072 sc1
    v_lshlrev_b32_e64 v198, 16, v5
    v_mfma_f32_16x16x32_bf16 v[136:139], a[96:99], v[28:31], v[136:139]
    v_and_b32 v199, 0xffff0000, v5
    buffer_load_dwordx4 v[2:5], v14, s[4:7], s3 offen sc1
    s_add_u32 s3, s3, 40960
    v_mfma_f32_16x16x32_bf16 v[140:143], a[100:103], v[28:31], v[140:143]
    s_waitcnt lgkmcnt(0)
    s_barrier
    ds_read_b128 v[160:163], v152 offset:0
    ds_read_b128 v[164:167], v157 offset:0
    v_mfma_f32_16x16x32_bf16 v[144:147], a[104:107], v[28:31], v[144:147]
    ds_read_b128 v[168:171], v152 offset:5120
    ds_read_b128 v[172:175], v157 offset:5120
    v_mfma_f32_16x16x32_bf16 v[148:151], a[108:111], v[28:31], v[148:151]
    ds_read_b128 v[176:179], v152 offset:10240
    ds_read_b128 v[180:183], v157 offset:10240
    s_waitcnt vmcnt(12)
    v_mfma_f32_16x16x32_bf16 v[132:135], a[112:115], v[32:35], v[132:135]
    s_add_u32 s54, s54, 4096
    buffer_load_dwordx4 v[80:83], v1, s[4:7], s54 offen offset:0 sc1
    ds_read_b128 v[184:187], v152 offset:15360
    v_mfma_f32_16x16x32_bf16 v[136:139], a[116:119], v[32:35], v[136:139]
    ds_read_b128 v[188:191], v157 offset:15360
    s_waitcnt lgkmcnt(6)
    v_mfma_f32_16x16x32_bf16 v[140:143], a[120:123], v[32:35], v[140:143]
    v_add_f32 v192, v192, v160
    v_add_f32 v193, v193, v161
    v_mfma_f32_16x16x32_bf16 v[144:147], a[124:127], v[32:35], v[144:147]
    v_add_f32 v194, v194, v162
    v_add_f32 v195, v195, v163
    v_mfma_f32_16x16x32_bf16 v[148:151], a[128:131], v[32:35], v[148:151]
    v_add_f32 v196, v196, v164
    v_add_f32_e64 v197, v197, v165
    s_waitcnt vmcnt(12)
    v_mfma_f32_16x16x32_bf16 v[132:135], a[132:135], v[36:39], v[132:135]
    buffer_load_dwordx4 v[84:87], v1, s[4:7], s54 offen offset:1024 sc1
    v_add_f32 v198, v198, v166
    v_mfma_f32_16x16x32_bf16 v[136:139], a[136:139], v[36:39], v[136:139]
    v_add_f32 v199, v199, v167
    s_waitcnt lgkmcnt(4)
    v_mfma_f32_16x16x32_bf16 v[140:143], a[140:143], v[36:39], v[140:143]
    v_add_f32 v192, v192, v168
    v_add_f32 v193, v193, v169
    v_mfma_f32_16x16x32_bf16 v[144:147], a[144:147], v[36:39], v[144:147]
    v_add_f32 v194, v194, v170
    v_add_f32 v195, v195, v171
    v_mfma_f32_16x16x32_bf16 v[148:151], a[148:151], v[36:39], v[148:151]
    v_add_f32 v196, v196, v172
    v_add_f32 v197, v197, v173
    s_waitcnt vmcnt(12)
    v_mfma_f32_16x16x32_bf16 v[132:135], a[152:155], v[40:43], v[132:135]
    buffer_load_dwordx4 v[88:91], v1, s[4:7], s54 offen offset:2048 sc1
    v_add_f32 v198, v198, v174
    v_mfma_f32_16x16x32_bf16 v[136:139], a[156:159], v[40:43], v[136:139]
    v_add_f32 v199, v199, v175
    s_waitcnt lgkmcnt(2)
    v_mfma_f32_16x16x32_bf16 v[140:143], a[160:163], v[40:43], v[140:143]
    v_add_f32 v192, v192, v176
    v_add_f32 v193, v193, v177
    v_mfma_f32_16x16x32_bf16 v[144:147], a[164:167], v[40:43], v[144:147]
    v_add_f32 v194, v194, v178
    v_add_f32 v195, v195, v179
    v_mfma_f32_16x16x32_bf16 v[148:151], a[168:171], v[40:43], v[148:151]
    v_add_f32 v196, v196, v180
    v_add_f32 v197, v197, v181
    s_waitcnt vmcnt(12)
    v_mfma_f32_16x16x32_bf16 v[132:135], a[172:175], v[44:47], v[132:135]
    buffer_load_dwordx4 v[92:95], v1, s[4:7], s54 offen offset:3072 sc1
    v_add_f32 v198, v198, v182
    v_mfma_f32_16x16x32_bf16 v[136:139], a[0:3], v[44:47], v[136:139]
    v_add_f32 v199, v199, v183
    s_waitcnt lgkmcnt(0)
    v_mfma_f32_16x16x32_bf16 v[140:143], a[4:7], v[44:47], v[140:143]
    v_add_f32 v192, v192, v184
    v_add_f32 v193, v193, v185
    v_mfma_f32_16x16x32_bf16 v[144:147], a[8:11], v[44:47], v[144:147]
    v_add_f32 v194, v194, v186
    v_add_f32 v195, v195, v187
    v_mfma_f32_16x16x32_bf16 v[148:151], a[12:15], v[44:47], v[148:151]
    v_add_f32 v196, v196, v188
    v_add_f32 v197, v197, v189
    s_waitcnt vmcnt(12)
    v_mfma_f32_16x16x32_bf16 v[132:135], a[16:19], v[48:51], v[132:135]
    s_add_u32 s54, s54, 4096
    buffer_load_dwordx4 v[96:99], v1, s[4:7], s54 offen offset:0 sc1
    v_add_f32 v198, v198, v190
    v_mfma_f32_16x16x32_bf16 v[136:139], a[20:23], v[48:51], v[136:139]
    v_add_f32 v199, v199, v191
    v_cvt_pk_bf16_f32 v200, v192, v193
    v_mfma_f32_16x16x32_bf16 v[140:143], a[24:27], v[48:51], v[140:143]
    v_cvt_pk_bf16_f32 v201, v194, v195
    v_cvt_pk_bf16_f32 v202, v196, v197
    v_mfma_f32_16x16x32_bf16 v[144:147], a[28:31], v[48:51], v[144:147]
    v_cvt_pk_bf16_f32 v203, v198, v199
    s_mov_b32 exec_lo, 0x03ff03ff
    s_mov_b32 exec_hi, 0x03ff03ff
    buffer_store_dwordx4 v[200:203], v15, s[16:19], s23 offen nt
    s_mov_b64 exec, -1
    s_add_u32 s23, s23, 40960
    v_mfma_f32_16x16x32_bf16 v[148:151], a[32:35], v[48:51], v[148:151]
    s_waitcnt vmcnt(13)
    v_mfma_f32_16x16x32_bf16 v[132:135], a[36:39], v[52:55], v[132:135]
    buffer_load_dwordx4 v[100:103], v1, s[4:7], s54 offen offset:1024 sc1
    v_mfma_f32_16x16x32_bf16 v[136:139], a[40:43], v[52:55], v[136:139]
    v_mfma_f32_16x16x32_bf16 v[140:143], a[44:47], v[52:55], v[140:143]
    v_mfma_f32_16x16x32_bf16 v[144:147], a[48:51], v[52:55], v[144:147]
    v_mfma_f32_16x16x32_bf16 v[148:151], a[52:55], v[52:55], v[148:151]
    s_lshl_b32 s66, s24, 8
    s_add_u32 s66, s66, 77824
    v_mov_b32 v155, s66
    buffer_load_dword v156, v155, s[4:7], 0 offen sc1
    s_waitcnt vmcnt(14)
    v_mfma_f32_16x16x32_bf16 v[132:135], a[56:59], v[56:59], v[132:135]
    buffer_load_dwordx4 v[104:107], v1, s[4:7], s54 offen offset:2048 sc1
    v_mfma_f32_16x16x32_bf16 v[136:139], a[60:63], v[56:59], v[136:139]
    v_mfma_f32_16x16x32_bf16 v[140:143], a[64:67], v[56:59], v[140:143]
    v_mfma_f32_16x16x32_bf16 v[144:147], a[68:71], v[56:59], v[144:147]
    v_mfma_f32_16x16x32_bf16 v[148:151], a[72:75], v[56:59], v[148:151]
    s_waitcnt vmcnt(14)
    v_mfma_f32_16x16x32_bf16 v[132:135], a[76:79], v[60:63], v[132:135]
    buffer_load_dwordx4 v[108:111], v1, s[4:7], s54 offen offset:3072 sc1
    v_mfma_f32_16x16x32_bf16 v[136:139], a[80:83], v[60:63], v[136:139]
    v_mfma_f32_16x16x32_bf16 v[140:143], a[84:87], v[60:63], v[140:143]
    v_mfma_f32_16x16x32_bf16 v[144:147], a[88:91], v[60:63], v[144:147]
    v_mfma_f32_16x16x32_bf16 v[148:151], a[92:95], v[60:63], v[148:151]
    s_waitcnt vmcnt(14)
    v_mfma_f32_16x16x32_bf16 v[112:115], a[240:243], v[64:67], 0
    v_mfma_f32_16x16x32_bf16 v[116:119], a[244:247], v[64:67], 0
    v_mfma_f32_16x16x32_bf16 v[120:123], a[248:251], v[64:67], 0
    v_mfma_f32_16x16x32_bf16 v[124:127], a[252:255], v[64:67], 0
    v_mfma_f32_16x16x32_bf16 v[128:131], v[252:255], v[64:67], 0
    s_waitcnt vmcnt(13)
    v_mfma_f32_16x16x32_bf16 v[112:115], v[248:251], v[68:71], v[112:115]
    v_mfma_f32_16x16x32_bf16 v[116:119], v[244:247], v[68:71], v[116:119]
    ds_write_b128 v153, v[132:135] offset:20480
    v_mfma_f32_16x16x32_bf16 v[120:123], v[240:243], v[68:71], v[120:123]
    ds_write_b128 v153, v[136:139] offset:21504
    v_mfma_f32_16x16x32_bf16 v[124:127], v[236:239], v[68:71], v[124:127]
    ds_write_b128 v154, v[140:143] offset:22528
    v_mfma_f32_16x16x32_bf16 v[128:131], v[232:235], v[68:71], v[128:131]
    ds_write_b128 v154, v[144:147] offset:23552
    s_waitcnt vmcnt(12)
    v_mfma_f32_16x16x32_bf16 v[112:115], v[228:231], v[72:75], v[112:115]
    ds_write_b128 v153, v[148:151] offset:24576
    v_mfma_f32_16x16x32_bf16 v[116:119], v[224:227], v[72:75], v[116:119]
    v_lshlrev_b32 v48, 16, v6
    v_and_b32 v49, 0xffff0000, v6
    v_mfma_f32_16x16x32_bf16 v[120:123], v[220:223], v[72:75], v[120:123]
    v_lshlrev_b32_e64 v50, 16, v7
    v_and_b32 v51, 0xffff0000, v7
    v_mfma_f32_16x16x32_bf16 v[124:127], v[216:219], v[72:75], v[124:127]
    v_lshlrev_b32_e64 v52, 16, v8
    v_and_b32 v53, 0xffff0000, v8
    v_mfma_f32_16x16x32_bf16 v[128:131], v[212:215], v[72:75], v[128:131]
    v_lshlrev_b32 v54, 16, v9
    v_and_b32 v55, 0xffff0000, v9
    s_waitcnt vmcnt(11)
    v_mfma_f32_16x16x32_bf16 v[112:115], v[208:211], v[76:79], v[112:115]
    s_waitcnt lgkmcnt(0)
    s_barrier
    ds_read_b128 v[16:19], v152 offset:20480
    ds_read_b128 v[20:23], v157 offset:20480
    v_mfma_f32_16x16x32_bf16 v[116:119], a[96:99], v[76:79], v[116:119]
    ds_read_b128 v[24:27], v152 offset:25600
    ds_read_b128 v[28:31], v157 offset:25600
    v_mfma_f32_16x16x32_bf16 v[120:123], a[100:103], v[76:79], v[120:123]
    ds_read_b128 v[32:35], v152 offset:30720
    ds_read_b128 v[36:39], v157 offset:30720
    v_mfma_f32_16x16x32_bf16 v[124:127], a[104:107], v[76:79], v[124:127]
    ds_read_b128 v[40:43], v152 offset:35840
    ds_read_b128 v[44:47], v157 offset:35840
    v_mfma_f32_16x16x32_bf16 v[128:131], a[108:111], v[76:79], v[128:131]
    s_waitcnt lgkmcnt(6)
    v_add_f32 v48, v48, v16
    v_add_f32 v49, v49, v17
    s_waitcnt vmcnt(2)
    v_cmp_ne_u32 vcc, 16, v156
    s_mov_b32 s69, 1048576
    s_cbranch_vccz Lpollx_63
Lpoll_62:
    s_sleep 4
    buffer_load_dword v156, v155, s[4:7], 0 offen sc1
    s_sub_u32 s69, s69, 1
    s_waitcnt vmcnt(0)
    s_cbranch_scc1 Lpollx_63
    v_cmp_ne_u32 vcc, 16, v156
    s_cbranch_vccnz Lpoll_62
Lpollx_63:
    v_mfma_f32_16x16x32_bf16 v[112:115], a[112:115], v[80:83], v[112:115]
    buffer_load_dwordx4 v[160:163], v1, s[4:7], s55 offen offset:0 sc1
    v_add_f32 v50, v50, v18
    v_mfma_f32_16x16x32_bf16 v[116:119], a[116:119], v[80:83], v[116:119]
    v_add_f32 v51, v51, v19
    v_add_f32_e64 v52, v52, v20
    v_mfma_f32_16x16x32_bf16 v[120:123], a[120:123], v[80:83], v[120:123]
    buffer_load_dwordx4 v[164:167], v1, s[4:7], s55 offen offset:1024 sc1
    v_add_f32 v53, v53, v21
    v_mfma_f32_16x16x32_bf16 v[124:127], a[124:127], v[80:83], v[124:127]
    v_add_f32 v54, v54, v22
    v_add_f32 v55, v55, v23
    v_mfma_f32_16x16x32_bf16 v[128:131], a[128:131], v[80:83], v[128:131]
    s_waitcnt lgkmcnt(4)
    v_add_f32 v48, v48, v24
    v_add_f32 v49, v49, v25
    v_mfma_f32_16x16x32_bf16 v[112:115], a[132:135], v[84:87], v[112:115]
    buffer_load_dwordx4 v[168:171], v1, s[4:7], s55 offen offset:2048 sc1
    v_add_f32 v50, v50, v26
    v_mfma_f32_16x16x32_bf16 v[116:119], a[136:139], v[84:87], v[116:119]
    v_add_f32 v51, v51, v27
    v_add_f32_e64 v52, v52, v28
    v_mfma_f32_16x16x32_bf16 v[120:123], a[140:143], v[84:87], v[120:123]
    buffer_load_dwordx4 v[172:175], v1, s[4:7], s55 offen offset:3072 sc1
    v_add_f32 v53, v53, v29
    v_mfma_f32_16x16x32_bf16 v[124:127], a[144:147], v[84:87], v[124:127]
    v_add_f32 v54, v54, v30
    v_add_f32 v55, v55, v31
    v_mfma_f32_16x16x32_bf16 v[128:131], a[148:151], v[84:87], v[128:131]
    s_waitcnt lgkmcnt(2)
    v_add_f32 v48, v48, v32
    v_add_f32 v49, v49, v33
    v_mfma_f32_16x16x32_bf16 v[112:115], a[152:155], v[88:91], v[112:115]
    s_add_u32 s55, s55, 4096
    buffer_load_dwordx4 v[176:179], v1, s[4:7], s55 offen offset:0 sc1
    v_add_f32 v50, v50, v34
    v_mfma_f32_16x16x32_bf16 v[116:119], a[156:159], v[88:91], v[116:119]
    v_add_f32 v51, v51, v35
    v_add_f32_e64 v52, v52, v36
    v_mfma_f32_16x16x32_bf16 v[120:123], a[160:163], v[88:91], v[120:123]
    buffer_load_dwordx4 v[180:183], v1, s[4:7], s55 offen offset:1024 sc1
    v_add_f32 v53, v53, v37
    v_mfma_f32_16x16x32_bf16 v[124:127], a[164:167], v[88:91], v[124:127]
    v_add_f32 v54, v54, v38
    v_add_f32 v55, v55, v39
    v_mfma_f32_16x16x32_bf16 v[128:131], a[168:171], v[88:91], v[128:131]
    s_waitcnt lgkmcnt(0)
    v_add_f32 v48, v48, v40
    v_add_f32 v49, v49, v41
    v_mfma_f32_16x16x32_bf16 v[112:115], a[172:175], v[92:95], v[112:115]
    buffer_load_dwordx4 v[184:187], v1, s[4:7], s55 offen offset:2048 sc1
    v_add_f32 v50, v50, v42
    v_mfma_f32_16x16x32_bf16 v[116:119], a[0:3], v[92:95], v[116:119]
    v_add_f32 v51, v51, v43
    v_add_f32 v52, v52, v44
    v_mfma_f32_16x16x32_bf16 v[120:123], a[4:7], v[92:95], v[120:123]
    v_add_f32 v53, v53, v45
    v_add_f32 v54, v54, v46
    v_mfma_f32_16x16x32_bf16 v[124:127], a[8:11], v[92:95], v[124:127]
    v_add_f32 v55, v55, v47
    v_cvt_pk_bf16_f32 v56, v48, v49
    v_mfma_f32_16x16x32_bf16 v[128:131], a[12:15], v[92:95], v[128:131]
    v_cvt_pk_bf16_f32 v57, v50, v51
    v_cvt_pk_bf16_f32 v58, v52, v53
    v_mfma_f32_16x16x32_bf16 v[112:115], a[16:19], v[96:99], v[112:115]
    buffer_load_dwordx4 v[188:191], v1, s[4:7], s55 offen offset:3072 sc1
    v_cvt_pk_bf16_f32 v59, v54, v55
    v_mfma_f32_16x16x32_bf16 v[116:119], a[20:23], v[96:99], v[116:119]
    s_branch Lpg_join_5_go
.p2align 12
Lpg_join_5:
    s_setpc_b64 s[0:1]
.p2align 3
Lpg_join_5_go:
    s_mov_b32 exec_lo, 0x03ff03ff
    s_mov_b32 exec_hi, 0x03ff03ff
    buffer_store_dwordx4 v[56:59], v15, s[16:19], s23 offen nt
    s_mov_b64 exec, -1
    s_add_u32 s23, s23, 40960
    v_mfma_f32_16x16x32_bf16 v[120:123], a[24:27], v[96:99], v[120:123]
    v_mfma_f32_16x16x32_bf16 v[124:127], a[28:31], v[96:99], v[124:127]
    v_mfma_f32_16x16x32_bf16 v[128:131], a[32:35], v[96:99], v[128:131]
    v_mfma_f32_16x16x32_bf16 v[112:115], a[36:39], v[100:103], v[112:115]
    s_add_u32 s55, s55, 4096
    buffer_load_dwordx4 v[192:195], v1, s[4:7], s55 offen offset:0 sc1
    v_mfma_f32_16x16x32_bf16 v[116:119], a[40:43], v[100:103], v[116:119]
    v_mfma_f32_16x16x32_bf16 v[120:123], a[44:47], v[100:103], v[120:123]
    v_mfma_f32_16x16x32_bf16 v[124:127], a[48:51], v[100:103], v[124:127]
    v_mfma_f32_16x16x32_bf16 v[128:131], a[52:55], v[100:103], v[128:131]
    s_waitcnt vmcnt(11)
    v_mfma_f32_16x16x32_bf16 v[112:115], a[56:59], v[104:107], v[112:115]
    buffer_load_dwordx4 v[196:199], v1, s[4:7], s55 offen offset:1024 sc1
    v_mfma_f32_16x16x32_bf16 v[116:119], a[60:63], v[104:107], v[116:119]
    v_mfma_f32_16x16x32_bf16 v[120:123], a[64:67], v[104:107], v[120:123]
    v_mfma_f32_16x16x32_bf16 v[124:127], a[68:71], v[104:107], v[124:127]
    v_mfma_f32_16x16x32_bf16 v[128:131], a[72:75], v[104:107], v[128:131]
    s_waitcnt vmcnt(11)
    v_mfma_f32_16x16x32_bf16 v[112:115], a[76:79], v[108:111], v[112:115]
    buffer_load_dwordx4 v[200:203], v1, s[4:7], s55 offen offset:2048 sc1
    v_mfma_f32_16x16x32_bf16 v[116:119], a[80:83], v[108:111], v[116:119]
    v_mfma_f32_16x16x32_bf16 v[120:123], a[84:87], v[108:111], v[120:123]
    v_mfma_f32_16x16x32_bf16 v[124:127], a[88:91], v[108:111], v[124:127]
    v_mfma_f32_16x16x32_bf16 v[128:131], a[92:95], v[108:111], v[128:131]
    s_waitcnt vmcnt(11)
    v_mfma_f32_16x16x32_bf16 v[132:135], a[240:243], v[160:163], 0
    buffer_load_dwordx4 v[204:207], v1, s[4:7], s55 offen offset:3072 sc1
    v_mfma_f32_16x16x32_bf16 v[136:139], a[244:247], v[160:163], 0
    v_mfma_f32_16x16x32_bf16 v[140:143], a[248:251], v[160:163], 0
    v_mfma_f32_16x16x32_bf16 v[144:147], a[252:255], v[160:163], 0
    v_mfma_f32_16x16x32_bf16 v[148:151], v[252:255], v[160:163], 0
    s_waitcnt vmcnt(11)
    v_mfma_f32_16x16x32_bf16 v[132:135], v[248:251], v[164:167], v[132:135]
    v_mfma_f32_16x16x32_bf16 v[136:139], v[244:247], v[164:167], v[136:139]
    ds_write_b128 v153, v[112:115] offset:40960
    v_mfma_f32_16x16x32_bf16 v[140:143], v[240:243], v[164:167], v[140:143]
    ds_write_b128 v153, v[116:119] offset:41984
    v_mfma_f32_16x16x32_bf16 v[144:147], v[236:239], v[164:167], v[144:147]
    ds_write_b128 v154, v[120:123] offset:43008
    v_mfma_f32_16x16x32_bf16 v[148:151], v[232:235], v[164:167], v[148:151]
    ds_write_b128 v154, v[124:127] offset:44032
    s_waitcnt vmcnt(10)
    v_mfma_f32_16x16x32_bf16 v[132:135], v[228:231], v[168:171], v[132:135]
    ds_write_b128 v153, v[128:131] offset:45056
    v_mfma_f32_16x16x32_bf16 v[136:139], v[224:227], v[168:171], v[136:139]
    v_lshlrev_b32_e64 v48, 16, v10
    v_and_b32 v49, 0xffff0000, v10
    v_mfma_f32_16x16x32_bf16 v[140:143], v[220:223], v[168:171], v[140:143]
    v_lshlrev_b32_e64 v50, 16, v11
    v_and_b32 v51, 0xffff0000, v11
    v_mfma_f32_16x16x32_bf16 v[144:147], v[216:219], v[168:171], v[144:147]
    v_lshlrev_b32_e64 v52, 16, v12
    v_and_b32 v53, 0xffff0000, v12
    v_mfma_f32_16x16x32_bf16 v[148:151], v[212:215], v[168:171], v[148:151]
    v_lshlrev_b32 v54, 16, v13
    v_and_b32 v55, 0xffff0000, v13
    s_waitcnt vmcnt(9)
    v_mfma_f32_16x16x32_bf16 v[132:135], v[208:211], v[172:175], v[132:135]
    s_waitcnt lgkmcnt(0)
    s_barrier
    ds_read_b128 v[16:19], v152 offset:40960
    ds_read_b128 v[20:23], v157 offset:40960
    v_mfma_f32_16x16x32_bf16 v[136:139], a[96:99], v[172:175], v[136:139]
    ds_read_b128 v[24:27], v152 offset:46080
    ds_read_b128 v[28:31], v157 offset:46080
    v_mfma_f32_16x16x32_bf16 v[140:143], a[100:103], v[172:175], v[140:143]
    ds_read_b128 v[32:35], v152 offset:51200
    ds_read_b128 v[36:39], v157 offset:51200
    v_mfma_f32_16x16x32_bf16 v[144:147], a[104:107], v[172:175], v[144:147]
    ds_read_b128 v[40:43], v152 offset:56320
    ds_read_b128 v[44:47], v157 offset:56320
    v_mfma_f32_16x16x32_bf16 v[148:151], a[108:111], v[172:175], v[148:151]
    s_waitcnt lgkmcnt(6)
    v_add_f32 v48, v48, v16
    v_add_f32 v49, v49, v17
    s_waitcnt vmcnt(8)
    v_mfma_f32_16x16x32_bf16 v[132:135], a[112:115], v[176:179], v[132:135]
    v_add_f32 v50, v50, v18
    v_add_f32 v51, v51, v19
    v_mfma_f32_16x16x32_bf16 v[136:139], a[116:119], v[176:179], v[136:139]
    v_add_f32 v52, v52, v20
    v_add_f32 v53, v53, v21
    v_mfma_f32_16x16x32_bf16 v[140:143], a[120:123], v[176:179], v[140:143]
    v_add_f32 v54, v54, v22
    v_add_f32 v55, v55, v23
    v_mfma_f32_16x16x32_bf16 v[144:147], a[124:127], v[176:179], v[144:147]
    s_waitcnt lgkmcnt(4)
    v_add_f32 v48, v48, v24
    v_add_f32 v49, v49, v25
    v_mfma_f32_16x16x32_bf16 v[148:151], a[128:131], v[176:179], v[148:151]
    v_add_f32 v50, v50, v26
    v_add_f32 v51, v51, v27
    s_waitcnt vmcnt(7)
    v_mfma_f32_16x16x32_bf16 v[132:135], a[132:135], v[180:183], v[132:135]
    v_add_f32 v52, v52, v28
    v_add_f32 v53, v53, v29
    v_mfma_f32_16x16x32_bf16 v[136:139], a[136:139], v[180:183], v[136:139]
    v_add_f32 v54, v54, v30
    v_add_f32 v55, v55, v31
    v_mfma_f32_16x16x32_bf16 v[140:143], a[140:143], v[180:183], v[140:143]
    s_waitcnt lgkmcnt(2)
    v_add_f32 v48, v48, v32
    v_add_f32 v49, v49, v33
    v_mfma_f32_16x16x32_bf16 v[144:147], a[144:147], v[180:183], v[144:147]
    v_add_f32 v50, v50, v34
    v_add_f32 v51, v51, v35
    v_mfma_f32_16x16x32_bf16 v[148:151], a[148:151], v[180:183], v[148:151]
    v_add_f32 v52, v52, v36
    v_add_f32 v53, v53, v37
    s_waitcnt vmcnt(6)
    v_mfma_f32_16x16x32_bf16 v[132:135], a[152:155], v[184:187], v[132:135]
    v_add_f32 v54, v54, v38
    v_add_f32 v55, v55, v39
    v_mfma_f32_16x16x32_bf16 v[136:139], a[156:159], v[184:187], v[136:139]
    s_waitcnt lgkmcnt(0)
    v_add_f32 v48, v48, v40
    v_add_f32 v49, v49, v41
    v_mfma_f32_16x16x32_bf16 v[140:143], a[160:163], v[184:187], v[140:143]
    v_add_f32 v50, v50, v42
    v_add_f32 v51, v51, v43
    v_mfma_f32_16x16x32_bf16 v[144:147], a[164:167], v[184:187], v[144:147]
    v_add_f32 v52, v52, v44
    v_add_f32 v53, v53, v45
    v_mfma_f32_16x16x32_bf16 v[148:151], a[168:171], v[184:187], v[148:151]
    v_add_f32 v54, v54, v46
    v_add_f32 v55, v55, v47
    s_waitcnt vmcnt(5)
    v_mfma_f32_16x16x32_bf16 v[132:135], a[172:175], v[188:191], v[132:135]
    v_cvt_pk_bf16_f32 v56, v48, v49
    v_cvt_pk_bf16_f32 v57, v50, v51
    v_mfma_f32_16x16x32_bf16 v[136:139], a[0:3], v[188:191], v[136:139]
    v_cvt_pk_bf16_f32 v58, v52, v53
    v_cvt_pk_bf16_f32 v59, v54, v55
    v_mfma_f32_16x16x32_bf16 v[140:143], a[4:7], v[188:191], v[140:143]
    s_mov_b32 exec_lo, 0x03ff03ff
    s_mov_b32 exec_hi, 0x03ff03ff
    buffer_store_dwordx4 v[56:59], v15, s[16:19], s23 offen nt
    s_mov_b64 exec, -1
    s_add_u32 s23, s23, 40960
    v_mfma_f32_16x16x32_bf16 v[144:147], a[8:11], v[188:191], v[144:147]
    v_mfma_f32_16x16x32_bf16 v[148:151], a[12:15], v[188:191], v[148:151]
    s_waitcnt vmcnt(4)
    v_mfma_f32_16x16x32_bf16 v[132:135], a[16:19], v[192:195], v[132:135]
    v_mfma_f32_16x16x32_bf16 v[136:139], a[20:23], v[192:195], v[136:139]
    v_mfma_f32_16x16x32_bf16 v[140:143], a[24:27], v[192:195], v[140:143]
    v_mfma_f32_16x16x32_bf16 v[144:147], a[28:31], v[192:195], v[144:147]
    v_mfma_f32_16x16x32_bf16 v[148:151], a[32:35], v[192:195], v[148:151]
    s_waitcnt vmcnt(3)
    v_mfma_f32_16x16x32_bf16 v[132:135], a[36:39], v[196:199], v[132:135]
    v_mfma_f32_16x16x32_bf16 v[136:139], a[40:43], v[196:199], v[136:139]
    v_mfma_f32_16x16x32_bf16 v[140:143], a[44:47], v[196:199], v[140:143]
    v_mfma_f32_16x16x32_bf16 v[144:147], a[48:51], v[196:199], v[144:147]
    v_mfma_f32_16x16x32_bf16 v[148:151], a[52:55], v[196:199], v[148:151]
    s_waitcnt vmcnt(2)
    v_mfma_f32_16x16x32_bf16 v[132:135], a[56:59], v[200:203], v[132:135]
    v_mfma_f32_16x16x32_bf16 v[136:139], a[60:63], v[200:203], v[136:139]
    v_mfma_f32_16x16x32_bf16 v[140:143], a[64:67], v[200:203], v[140:143]
    v_mfma_f32_16x16x32_bf16 v[144:147], a[68:71], v[200:203], v[144:147]
    v_mfma_f32_16x16x32_bf16 v[148:151], a[72:75], v[200:203], v[148:151]
    s_waitcnt vmcnt(1)
    v_mfma_f32_16x16x32_bf16 v[132:135], a[76:79], v[204:207], v[132:135]
    v_mfma_f32_16x16x32_bf16 v[136:139], a[80:83], v[204:207], v[136:139]
    v_mfma_f32_16x16x32_bf16 v[140:143], a[84:87], v[204:207], v[140:143]
    v_mfma_f32_16x16x32_bf16 v[144:147], a[88:91], v[204:207], v[144:147]
    v_mfma_f32_16x16x32_bf16 v[148:151], a[92:95], v[204:207], v[148:151]
    v_lshlrev_b32 v48, 16, v2
    v_and_b32 v49, 0xffff0000, v2
    v_lshlrev_b32 v50, 16, v3
    v_and_b32 v51, 0xffff0000, v3
    v_lshlrev_b32 v52, 16, v4
    v_and_b32 v53, 0xffff0000, v4
    v_lshlrev_b32_e64 v54, 16, v5
    v_and_b32 v55, 0xffff0000, v5
    ds_write_b128 v153, v[132:135] offset:0
    ds_write_b128 v153, v[136:139] offset:1024
    ds_write_b128 v154, v[140:143] offset:2048
    ds_write_b128 v154, v[144:147] offset:3072
    ds_write_b128 v153, v[148:151] offset:4096
    s_waitcnt lgkmcnt(0)
    s_barrier
    ds_read_b128 v[16:19], v152 offset:0
    ds_read_b128 v[20:23], v157 offset:0
    ds_read_b128 v[24:27], v152 offset:5120
    ds_read_b128 v[28:31], v157 offset:5120
    ds_read_b128 v[32:35], v152 offset:10240
    ds_read_b128 v[36:39], v157 offset:10240
    ds_read_b128 v[40:43], v152 offset:15360
    ds_read_b128 v[44:47], v157 offset:15360
    s_waitcnt lgkmcnt(6)
    v_pk_add_f32 v[48:49], v[48:49], v[16:17] op_sel:[0,0] op_sel_hi:[1,1]
    v_pk_add_f32 v[50:51], v[50:51], v[18:19] op_sel:[0,0] op_sel_hi:[1,1]
    v_pk_add_f32 v[52:53], v[52:53], v[20:21] op_sel:[0,0] op_sel_hi:[1,1]
    v_pk_add_f32 v[54:55], v[54:55], v[22:23] op_sel:[0,0] op_sel_hi:[1,1]
    s_waitcnt lgkmcnt(4)
    v_pk_add_f32 v[48:49], v[48:49], v[24:25] op_sel:[0,0] op_sel_hi:[1,1]
    v_pk_add_f32 v[50:51], v[50:51], v[26:27] op_sel:[0,0] op_sel_hi:[1,1]
    v_pk_add_f32 v[52:53], v[52:53], v[28:29] op_sel:[0,0] op_sel_hi:[1,1]
    v_pk_add_f32 v[54:55], v[54:55], v[30:31] op_sel:[0,0] op_sel_hi:[1,1]
    s_waitcnt lgkmcnt(2)
    v_pk_add_f32 v[48:49], v[48:49], v[32:33] op_sel:[0,0] op_sel_hi:[1,1]
    v_pk_add_f32 v[50:51], v[50:51], v[34:35] op_sel:[0,0] op_sel_hi:[1,1]
    v_pk_add_f32 v[52:53], v[52:53], v[36:37] op_sel:[0,0] op_sel_hi:[1,1]
    v_pk_add_f32 v[54:55], v[54:55], v[38:39] op_sel:[0,0] op_sel_hi:[1,1]
    s_waitcnt lgkmcnt(0)
    v_pk_add_f32 v[48:49], v[48:49], v[40:41] op_sel:[0,0] op_sel_hi:[1,1]
    v_pk_add_f32 v[50:51], v[50:51], v[42:43] op_sel:[0,0] op_sel_hi:[1,1]
    v_pk_add_f32 v[52:53], v[52:53], v[44:45] op_sel:[0,0] op_sel_hi:[1,1]
    v_pk_add_f32 v[54:55], v[54:55], v[46:47] op_sel:[0,0] op_sel_hi:[1,1]
    v_cvt_pk_bf16_f32 v56, v48, v49
    v_cvt_pk_bf16_f32 v57, v50, v51
    v_cvt_pk_bf16_f32 v58, v52, v53
    v_cvt_pk_bf16_f32 v59, v54, v55
    s_mov_b32 exec_lo, 0x03ff03ff
    s_mov_b32 exec_hi, 0x03ff03ff
    buffer_store_dwordx4 v[56:59], v15, s[16:19], s23 offen nt
    s_mov_b64 exec, -1
    s_add_u32 s23, s23, 40960
Lend:
    s_endpgm
.section .rodata,"a"
.p2align 6
.amdhsa_kernel sequential_preLN__linear_attn_block__glu_gated_swiglu__prompt_kernel
  .amdhsa_next_free_vgpr 512
  .amdhsa_next_free_sgpr 102
  .amdhsa_accum_offset 256
  .amdhsa_group_segment_fixed_size 0
  .amdhsa_kernarg_size 80
  .amdhsa_user_sgpr_count 2
  .amdhsa_user_sgpr_kernarg_segment_ptr 1
  .amdhsa_system_sgpr_workgroup_id_x 1
.end_amdhsa_kernel
```
